```python
import torch

def _softmax(x, axis=-1):
    return torch.softmax(x, dim=axis)
def _gelu(x):
    return torch.nn.functional.gelu(x, approximate="tanh")
def _silu(x):
    return torch.nn.functional.silu(x)
def _sigmoid(x):
    return torch.sigmoid(x)
def _layernorm(x, axis=-1, eps=1e-5):
    m = x.mean(dim=axis, keepdim=True)
    v = x.var(dim=axis, keepdim=True, unbiased=False)
    return (x - m) / torch.sqrt(v + eps)
def _scatter_add(tgt, idx, src, axis=0):
    return tgt.clone().index_add_(axis, idx, src)
def _segment_sum(src, seg, n):
    out = torch.zeros((n,) + src.shape[1:], dtype=src.dtype)
    return out.index_add_(0, seg, src)
def _pad(x, pw):
    flat = tuple(v for pair in reversed(pw) for v in pair)
    return torch.nn.functional.pad(x, flat)

kernel_name = 'standalone__mha_block_cached__near_ridge'

def setup_inputs():

    _w = (lambda a: (lambda t: t.to(torch.bfloat16) if t.is_floating_point() else t)(torch.as_tensor(a)))
    B, Sq, D = 8, 144, 640
    H, Sk, Dh = 32, 1024, 128
    return {
        "x": _w((lambda *s: torch.randn(*s, dtype=torch.bfloat16) * 0.8)(B, Sq, D)),
        "k_cache": _w((lambda *s: torch.randn(*s, dtype=torch.bfloat16) * 0.8)(B, H, Sk, Dh)),
        "v_cache": _w((lambda *s: torch.randn(*s, dtype=torch.bfloat16) * 0.05)(B, H, Sk, Dh)),
        "wq": _w((lambda *s: torch.randn(*s, dtype=torch.bfloat16) * 0.8)(D, H * Dh) * (D ** -0.5)),
        "wo": _w((lambda *s: torch.randn(*s, dtype=torch.bfloat16) * 0.05)(H * Dh, D) * ((H * Dh) ** -0.5)),
    }

def reference(x, k_cache, v_cache, wq, wo):
    B, Sq, D = x.shape
    H, Dh = 32, 128
    q = (lambda x, *d: x.permute(*d))((x @ wq).reshape(B, Sq, H, Dh), 0, 2, 1, 3)
    scores = torch.einsum("bhqd,bhkd->bhqk", q, k_cache) * (Dh ** -0.5)
    p = _softmax(scores, axis=-1)
    o = torch.einsum("bhqk,bhkd->bhqd", p, v_cache)
    return (lambda x, *d: x.permute(*d))(o, 0, 2, 1, 3).reshape(B, Sq, H * Dh) @ wo
```

```asm
; @launch grid=(256,1,1) block=(256,1,1) lds=163840
.amdgcn_target "amdgcn-amd-amdhsa--gfx950"
.text
.globl standalone__mha_block_cached__near_ridge_kernel
.p2align 8
.type standalone__mha_block_cached__near_ridge_kernel,@function
standalone__mha_block_cached__near_ridge_kernel:
    s_load_dwordx16 s[4:19], s[0:1], 0
    s_cmp_ge_u32 s2, 256
    s_cbranch_scc1 L_end
    v_lshrrev_b32 v1, 6, v0
    v_and_b32 v0, 63, v0
    v_readfirstlane_b32 s20, v1
    s_and_b32 s60, s2, 7
    s_lshr_b32 s26, s2, 3
    s_getpc_b64 s[56:57]
L_pc:
    s_mov_b32 s58, L_codeend-L_pc
    s_mov_b32 s59, 0x20000
    s_lshl_b32 s61, s26, 2
    s_add_u32 s61, s61, s20
    s_lshl_b32 s61, s61, 9
    v_lshl_add_u32 v5, v0, 7, s61
    s_mov_b64 exec, 15
    buffer_load_dword v255, v5, s[56:59], 0 offen
    s_mov_b64 exec, -1
    s_lshr_b32 s21, s60, 1
    s_and_b32 s60, s60, 1
    s_and_b32 s22, s26, 3
    s_lshr_b32 s23, s26, 2
    s_lshl_b32 s24, s60, 2
    s_add_u32 s24, s24, s22
    s_lshl_b32 s25, s21, 3
    s_add_u32 s25, s25, s23
    s_lshl_b32 s27, s24, 5
    s_add_u32 s27, s27, s25
    s_lshl_b32 s71, s20, 12
    s_mul_i32 s72, s20, 5120
    s_mul_i32 s60, s22, 10
    s_mul_i32 s61, s23, 5
    s_add_u32 s60, s60, s61
    s_lshr_b32 s70, s60, 2
    s_cmp_ge_u32 s70, 10
    s_cselect_b32 s60, 10, 0
    s_sub_u32 s70, s70, s60
    v_lshrrev_b32 v1, 4, v0
    v_and_b32 v2, 15, v0
    v_lshrrev_b32 v3, 3, v0
    v_and_b32 v4, 7, v0
    s_lshl_b32 s60, s20, 5
    v_add_u32 v5, s60, v3
    v_mul_u32_u24 v5, 1280, v5
    v_xor_b32 v6, 0, v1
    v_xor_b32 v6, v6, v4
    v_lshl_add_u32 v6, v6, 4, v5
    v_add_u32 v206, 0, v6
    v_xor_b32 v6, 4, v1
    v_xor_b32 v6, v6, v4
    v_lshl_add_u32 v6, v6, 4, v5
    v_add_u32 v207, 9216, v6
    v_xor_b32 v6, 0, v1
    v_xor_b32 v6, v6, v4
    v_lshl_add_u32 v6, v6, 4, v5
    v_add_u32 v208, 18432, v6
    v_xor_b32 v6, 4, v1
    v_xor_b32 v6, v6, v4
    v_lshl_add_u32 v6, v6, 4, v5
    v_add_u32 v209, 27648, v6
    s_lshl_b32 s60, s20, 2
    s_add_u32 s60, s60, 128
    v_add_u32 v5, s60, v3
    v_mul_u32_u24 v5, 1280, v5
    s_lshl_b32 s60, s20, 1
    v_add_u32 v6, s60, v1
    v_and_b32 v6, 7, v6
    v_xor_b32 v6, v6, v4
    v_lshl_add_u32 v210, v6, 4, v5
    s_lshl_b32 s60, s20, 4
    v_add_u32 v5, s60, v1
    v_lshlrev_b32 v5, 13, v5
    v_lshlrev_b32 v7, 2, v1
    v_xor_b32 v7, v7, v2
    v_xor_b32 v6, 0, v7
    v_lshl_add_u32 v6, v6, 4, v5
    v_add_u32 v211, 0, v6
    v_xor_b32 v6, 0, v7
    v_lshl_add_u32 v6, v6, 4, v5
    v_add_u32 v212, 31744, v6
    v_xor_b32 v6, 2, v7
    v_lshl_add_u32 v6, v6, 4, v5
    v_add_u32 v213, 63488, v6
    v_xor_b32 v6, 2, v7
    v_lshl_add_u32 v6, v6, 4, v5
    v_add_u32 v214, 95232, v6
    s_waitcnt lgkmcnt(0)
    s_mul_i32 s60, s24, 184320
    s_add_u32 s36, s4, s60
    s_addc_u32 s37, s5, 0
    s_mov_b32 s38, 184320
    s_mov_b32 s39, 0x20000
    s_lshl_b32 s60, s25, 8
    s_add_u32 s40, s10, s60
    s_addc_u32 s41, s11, 0
    s_sub_u32 s42, 5242880, s60
    s_mov_b32 s43, 0x20000
    s_mov_b32 s48, s18
    s_mov_b32 s49, s19
    s_mov_b32 s50, 0x10000000
    s_mov_b32 s51, 0x20000
    s_lshl_b32 s68, s70, 19
    s_add_u32 m0, s71, 55296
    s_nop 0
    buffer_load_dwordx4 v211, s[40:43], s68 offen offset:0  lds
    buffer_load_dwordx4 v212, s[40:43], s68 offen offset:1024  lds
    buffer_load_dwordx4 v213, s[40:43], s68 offen offset:2048  lds
    buffer_load_dwordx4 v214, s[40:43], s68 offen offset:3072  lds
    s_lshl_b32 s69, s70, 7
    s_add_u32 m0, s71, 0
    s_nop 0
    buffer_load_dwordx4 v206, s[36:39], s69 offen offset:0  lds
    buffer_load_dwordx4 v207, s[36:39], s69 offen offset:1024  lds
    buffer_load_dwordx4 v208, s[36:39], s69 offen offset:2048  lds
    buffer_load_dwordx4 v209, s[36:39], s69 offen offset:3072  lds
    s_lshl_b32 s67, s20, 9
    s_add_u32 m0, s67, 16384
    s_mov_b32 exec_hi, 0
    buffer_load_dwordx4 v210, s[36:39], s69 offen  lds
    s_mov_b32 exec_hi, -1
    s_add_u32 s70, s70, 1
    s_cmp_eq_u32 s70, 10
    s_cselect_b32 s70, 0, s70
    s_lshl_b32 s60, s27, 18
    s_lshr_b32 s61, s27, 14
    s_add_u32 s28, s6, s60
    s_addc_u32 s29, s7, s61
    s_mov_b32 s30, 262144
    s_mov_b32 s31, 0x20000
    s_add_u32 s32, s8, s60
    s_addc_u32 s33, s9, s61
    s_mov_b32 s34, 262144
    s_mov_b32 s35, 0x20000
    s_mul_i32 s60, s21, 1310720
    s_mul_i32 s61, s23, 160
    s_add_u32 s60, s60, s61
    s_add_u32 s44, s12, s60
    s_addc_u32 s45, s13, 0
    s_sub_u32 s46, 5242880, s60
    s_mov_b32 s47, 0x20000
    s_mov_b32 s52, s14
    s_mov_b32 s53, s15
    s_mov_b32 s54, 1474560
    s_mov_b32 s55, 0x20000
    s_mov_b32 s56, s16
    s_mov_b32 s57, s17
    s_mov_b32 s58, 256
    s_mov_b32 s59, 0x20000
    s_mov_b32 s73, 0x41000000
    s_mov_b32 s76, 0x3e0293ee
    v_lshlrev_b32 v5, 8, v1
    v_add_u32 v5, s71, v5
    v_xor_b32 v7, v1, v2
    v_xor_b32 v6, 0, v7
    v_lshl_add_u32 v200, v6, 4, v5
    v_xor_b32 v6, 4, v7
    v_lshl_add_u32 v201, v6, 4, v5
    v_xor_b32 v6, 8, v7
    v_lshl_add_u32 v202, v6, 4, v5
    v_xor_b32 v6, 12, v7
    v_lshl_add_u32 v203, v6, 4, v5
    v_lshlrev_b32 v7, 2, v1
    v_xor_b32 v7, v7, v2
    v_xor_b32 v6, 0, v7
    v_lshl_add_u32 v204, v6, 4, v5
    v_xor_b32 v6, 1, v7
    v_lshl_add_u32 v205, v6, 4, v5
    v_lshrrev_b32 v3, 5, v0
    v_and_b32 v4, 31, v0
    v_lshlrev_b32 v5, 7, v4
    v_add_u32 v5, s71, v5
    v_bfe_u32 v7, v0, 1, 3
    v_xor_b32 v7, v7, v3
    v_xor_b32 v6, 0, v7
    v_lshl_add_u32 v215, v6, 4, v5
    v_xor_b32 v6, 2, v7
    v_lshl_add_u32 v216, v6, 4, v5
    v_xor_b32 v6, 4, v7
    v_lshl_add_u32 v217, v6, 4, v5
    v_xor_b32 v6, 6, v7
    v_lshl_add_u32 v218, v6, 4, v5
    v_lshlrev_b32 v5, 7, v2
    v_add_u32 v5, 16384, v5
    v_bfe_u32 v7, v0, 1, 3
    v_xor_b32 v7, v7, v1
    v_xor_b32 v6, 0, v7
    v_lshl_add_u32 v219, v6, 4, v5
    v_xor_b32 v6, 4, v7
    v_lshl_add_u32 v220, v6, 4, v5
    v_bfe_u32 v240, v0, 2, 2
    v_and_b32 v241, 3, v0
    v_and_b32 v242, 1, v1
    v_lshl_add_u32 v5, v3, 3, v240
    v_lshlrev_b32 v5, 8, v5
    v_lshrrev_b32 v6, 1, v241
    v_lshl_add_u32 v5, v6, 3, v5
    v_add_u32 v5, 55296, v5
    v_and_b32 v6, 1, v241
    v_lshl_add_u32 v7, v242, 1, v6
    v_lshlrev_b32 v6, 2, v240
    v_lshl_add_u32 v6, v3, 1, v6
    v_xor_b32 v7, v7, v6
    v_xor_b32 v6, 0, v7
    v_lshl_add_u32 v221, v6, 4, v5
    v_xor_b32 v6, 4, v7
    v_lshl_add_u32 v222, v6, 4, v5
    v_xor_b32 v6, 8, v7
    v_lshl_add_u32 v223, v6, 4, v5
    v_xor_b32 v6, 12, v7
    v_lshl_add_u32 v224, v6, 4, v5
    v_lshl_add_u32 v5, v1, 3, v240
    v_lshlrev_b32 v5, 8, v5
    v_and_b32 v6, 1, v241
    v_lshl_add_u32 v5, v6, 3, v5
    v_add_u32 v5, 55296, v5
    s_lshl_b32 s60, s20, 2
    v_lshrrev_b32 v7, 1, v241
    v_add_u32 v7, s60, v7
    v_lshlrev_b32 v6, 2, v240
    v_lshl_add_u32 v6, v242, 1, v6
    v_xor_b32 v7, v7, v6
    v_xor_b32 v6, 0, v7
    v_lshl_add_u32 v225, v6, 4, v5
    v_xor_b32 v6, 2, v7
    v_lshl_add_u32 v226, v6, 4, v5
    v_lshlrev_b32 v5, 8, v4
    v_xor_b32 v7, v3, v2
    v_add_u32 v5, 114688, v5
    v_xor_b32 v6, 0, v7
    v_lshl_add_u32 v176, v6, 4, v5
    v_xor_b32 v6, 2, v7
    v_lshl_add_u32 v177, v6, 4, v5
    v_xor_b32 v6, 4, v7
    v_lshl_add_u32 v178, v6, 4, v5
    v_xor_b32 v6, 6, v7
    v_lshl_add_u32 v179, v6, 4, v5
    v_xor_b32 v6, 8, v7
    v_lshl_add_u32 v180, v6, 4, v5
    v_xor_b32 v6, 10, v7
    v_lshl_add_u32 v181, v6, 4, v5
    v_xor_b32 v6, 12, v7
    v_lshl_add_u32 v182, v6, 4, v5
    v_xor_b32 v6, 14, v7
    v_lshl_add_u32 v183, v6, 4, v5
    v_lshlrev_b32 v5, 8, v2
    v_add_u32 v5, s71, v5
    v_xor_b32 v7, v1, v2
    v_add_u32 v5, 114688, v5
    v_xor_b32 v6, 0, v7
    v_lshl_add_u32 v184, v6, 4, v5
    v_xor_b32 v6, 4, v7
    v_lshl_add_u32 v185, v6, 4, v5
    v_xor_b32 v6, 8, v7
    v_lshl_add_u32 v186, v6, 4, v5
    v_xor_b32 v6, 12, v7
    v_lshl_add_u32 v187, v6, 4, v5
    v_lshl_add_u32 v5, v3, 2, v240
    v_lshlrev_b32 v5, 8, v5
    v_and_b32 v6, 1, v241
    v_lshl_add_u32 v5, v6, 3, v5
    v_add_u32 v5, 65536, v5
    v_lshrrev_b32 v6, 1, v241
    v_lshl_add_u32 v7, v242, 1, v6
    v_lshl_add_u32 v6, v240, 2, v3
    v_xor_b32 v7, v7, v6
    v_xor_b32 v6, 0, v7
    v_lshl_add_u32 v188, v6, 4, v5
    v_xor_b32 v6, 4, v7
    v_lshl_add_u32 v189, v6, 4, v5
    v_xor_b32 v6, 8, v7
    v_lshl_add_u32 v190, v6, 4, v5
    v_xor_b32 v6, 12, v7
    v_lshl_add_u32 v191, v6, 4, v5
    v_lshl_add_u32 v5, v1, 2, v240
    v_lshlrev_b32 v5, 8, v5
    v_add_u32 v5, s71, v5
    v_and_b32 v6, 1, v241
    v_lshl_add_u32 v5, v6, 3, v5
    v_add_u32 v5, 65536, v5
    v_and_b32 v7, 2, v241
    v_lshl_add_u32 v6, v240, 2, v242
    v_xor_b32 v7, v7, v6
    v_xor_b32 v6, 0, v7
    v_lshl_add_u32 v192, v6, 4, v5
    v_xor_b32 v6, 1, v7
    v_lshl_add_u32 v193, v6, 4, v5
    v_xor_b32 v6, 4, v7
    v_lshl_add_u32 v194, v6, 4, v5
    v_xor_b32 v6, 5, v7
    v_lshl_add_u32 v195, v6, 4, v5
    v_xor_b32 v6, 8, v7
    v_lshl_add_u32 v196, v6, 4, v5
    v_xor_b32 v6, 9, v7
    v_lshl_add_u32 v197, v6, 4, v5
    v_xor_b32 v6, 12, v7
    v_lshl_add_u32 v198, v6, 4, v5
    v_xor_b32 v6, 13, v7
    v_lshl_add_u32 v199, v6, 4, v5
    v_lshlrev_b32 v5, 4, v3
    v_lshl_add_u32 v5, v242, 2, v5
    v_add_u32 v5, v5, v240
    v_mul_u32_u24 v5, 160, v5
    v_mul_u32_u24 v6, 40, v241
    v_add_u32 v232, v5, v6
    s_mul_i32 s60, s20, 40960
    v_add_u32 v5, 0, v0
    v_mul_u32_u24 v6, 6554, v5
    v_lshrrev_b32 v6, 16, v6
    v_mul_u32_u24 v7, 10, v6
    v_sub_u32 v7, v5, v7
    v_mul_u32_u24 v6, 1280, v6
    v_lshl_add_u32 v6, v7, 4, v6
    v_add_u32 v6, s60, v6
    v_subrev_u32 v227, 0, v6
    v_add_u32 v5, 64, v0
    v_mul_u32_u24 v6, 6554, v5
    v_lshrrev_b32 v6, 16, v6
    v_mul_u32_u24 v7, 10, v6
    v_sub_u32 v7, v5, v7
    v_mul_u32_u24 v6, 1280, v6
    v_lshl_add_u32 v6, v7, 4, v6
    v_add_u32 v6, s60, v6
    v_subrev_u32 v228, 1024, v6
    v_add_u32 v5, 128, v0
    v_mul_u32_u24 v6, 6554, v5
    v_lshrrev_b32 v6, 16, v6
    v_mul_u32_u24 v7, 10, v6
    v_sub_u32 v7, v5, v7
    v_mul_u32_u24 v6, 1280, v6
    v_lshl_add_u32 v6, v7, 4, v6
    v_add_u32 v6, s60, v6
    v_subrev_u32 v229, 2048, v6
    v_add_u32 v5, 192, v0
    v_mul_u32_u24 v6, 6554, v5
    v_lshrrev_b32 v6, 16, v6
    v_mul_u32_u24 v7, 10, v6
    v_sub_u32 v7, v5, v7
    v_mul_u32_u24 v6, 1280, v6
    v_lshl_add_u32 v6, v7, 4, v6
    v_add_u32 v6, s60, v6
    v_subrev_u32 v230, 3072, v6
    v_add_u32 v5, 256, v0
    v_mul_u32_u24 v6, 6554, v5
    v_lshrrev_b32 v6, 16, v6
    v_mul_u32_u24 v7, 10, v6
    v_sub_u32 v7, v5, v7
    v_mul_u32_u24 v6, 1280, v6
    v_lshl_add_u32 v6, v7, 4, v6
    v_add_u32 v6, s60, v6
    v_subrev_u32 v231, 0, v6
    v_lshlrev_b32 v5, 12, v242
    v_lshl_add_u32 v6, v3, 4, v2
    v_lshl_add_u32 v5, v6, 4, v5
    s_lshl_b32 s60, s20, 13
    v_add_u32 v235, s60, v5
    v_lshlrev_b32 v236, 4, v0
    v_and_b32 v5, 31, v0
    v_lshl_add_u32 v238, v5, 7, s71
    v_cmp_eq_u32 vcc, 0, v0
    v_mov_b32 v5, 0x7ff00000
    v_mov_b32 v6, 0
    v_cndmask_b32 v237, v5, v6, vcc
    s_lshr_b32 s3, s27, 3
    s_lshl_b32 s3, s3, 2
    s_add_u32 s3, s3, s20
    s_lshl_b32 s3, s3, 6
    s_add_u32 s3, s3, 50331648
    s_getreg_b32 s75, hwreg(HW_REG_XCC_ID, 0, 4)
    s_add_u32 s75, s75, 1
    v_and_b32 v5, 7, v0
    v_lshlrev_b32 v249, 2, v5
    s_lshl_b32 s60, s23, 2
    v_or_b32 v251, s60, v237
    s_lshl_b32 s60, s24, 3
    s_add_u32 s60, s60, s23
    s_lshl_b32 s60, s60, 2
    s_add_u32 s60, s60, s20
    s_lshl_b32 s19, s60, 6
    s_add_u32 s19, s19, 50339840
    s_lshl_b32 s60, s60, 2
    s_add_u32 s60, s60, s21
    s_mul_i32 s18, s60, 4608
    s_add_u32 s18, s18, 16777216
    s_lshl_b32 s60, s21, 2
    v_or_b32 v252, s60, v237
    s_lshl_b32 s68, s70, 19
    s_add_u32 m0, s71, 71680
    s_nop 0
    buffer_load_dwordx4 v211, s[40:43], s68 offen offset:0  lds
    buffer_load_dwordx4 v212, s[40:43], s68 offen offset:1024  lds
    buffer_load_dwordx4 v213, s[40:43], s68 offen offset:2048  lds
    buffer_load_dwordx4 v214, s[40:43], s68 offen offset:3072  lds
    s_lshl_b32 s69, s70, 7
    s_add_u32 m0, s71, 18432
    s_nop 0
    buffer_load_dwordx4 v206, s[36:39], s69 offen offset:0  lds
    buffer_load_dwordx4 v207, s[36:39], s69 offen offset:1024  lds
    buffer_load_dwordx4 v208, s[36:39], s69 offen offset:2048  lds
    buffer_load_dwordx4 v209, s[36:39], s69 offen offset:3072  lds
    s_lshl_b32 s67, s20, 9
    s_add_u32 m0, s67, 34816
    s_mov_b32 exec_hi, 0
    buffer_load_dwordx4 v210, s[36:39], s69 offen  lds
    s_mov_b32 exec_hi, -1
    s_add_u32 s70, s70, 1
    s_cmp_eq_u32 s70, 10
    s_cselect_b32 s70, 0, s70
    s_lshl_b32 s60, s2, 12
    s_add_u32 s60, s60, 50331648
    s_lshl_b32 s61, s20, 10
    s_add_u32 s60, s60, s61
    s_cmp_lt_u32 s2, 8
    s_cselect_b32 s60, s60, 0x7ff00000
    v_add_u32 v1, s60, v236
    v_mov_b32 v4, 0
    v_mov_b32 v5, 0
    v_mov_b32 v6, 0
    v_mov_b32 v7, 0
    buffer_store_dwordx4 v[4:7], v1, s[48:51], 0 offen sc1
    s_waitcnt vmcnt(10)
    s_waitcnt lgkmcnt(0)
    s_barrier
    ds_read_b128 a[216:219], v215 offset:0
    ds_read_b64_tr_b16 a[152:153], v221 offset:0
    ds_read_b64_tr_b16 a[154:155], v221 offset:1024
    ds_read_b64_tr_b16 a[156:157], v222 offset:0
    ds_read_b64_tr_b16 a[158:159], v222 offset:1024
    ds_read_b64_tr_b16 a[160:161], v223 offset:0
    ds_read_b64_tr_b16 a[162:163], v223 offset:1024
    ds_read_b64_tr_b16 a[164:165], v224 offset:0
    ds_read_b64_tr_b16 a[166:167], v224 offset:1024
    ds_read_b128 a[220:223], v216 offset:0
    ds_read_b64_tr_b16 a[168:169], v221 offset:4096
    ds_read_b64_tr_b16 a[170:171], v221 offset:5120
    ds_read_b64_tr_b16 a[172:173], v222 offset:4096
    ds_read_b64_tr_b16 a[174:175], v222 offset:5120
    ds_read_b64_tr_b16 a[176:177], v223 offset:4096
    ds_read_b64_tr_b16 a[178:179], v223 offset:5120
    ds_read_b64_tr_b16 a[180:181], v224 offset:4096
    ds_read_b64_tr_b16 a[182:183], v224 offset:5120
    ds_read_b128 a[224:227], v217 offset:0
    ds_read_b64_tr_b16 a[184:185], v221 offset:8192
    ds_read_b64_tr_b16 a[186:187], v221 offset:9216
    ds_read_b64_tr_b16 a[188:189], v222 offset:8192
    ds_read_b64_tr_b16 a[190:191], v222 offset:9216
    ds_read_b64_tr_b16 a[192:193], v223 offset:8192
    ds_read_b64_tr_b16 a[194:195], v223 offset:9216
    ds_read_b64_tr_b16 a[196:197], v224 offset:8192
    ds_read_b64_tr_b16 a[198:199], v224 offset:9216
    ds_read_b128 a[228:231], v218 offset:0
    ds_read_b64_tr_b16 a[200:201], v221 offset:12288
    ds_read_b64_tr_b16 a[202:203], v221 offset:13312
    ds_read_b64_tr_b16 a[204:205], v222 offset:12288
    ds_read_b64_tr_b16 a[206:207], v222 offset:13312
    ds_read_b64_tr_b16 a[208:209], v223 offset:12288
    ds_read_b64_tr_b16 a[210:211], v223 offset:13312
    ds_read_b64_tr_b16 a[212:213], v224 offset:12288
    ds_read_b64_tr_b16 a[214:215], v224 offset:13312
    ds_read_b128 a[248:251], v219 offset:0
    ds_read_b64_tr_b16 a[232:233], v225 offset:0
    ds_read_b64_tr_b16 a[234:235], v225 offset:1024
    ds_read_b64_tr_b16 a[236:237], v226 offset:0
    ds_read_b64_tr_b16 a[238:239], v226 offset:1024
    ds_read_b128 a[252:255], v220 offset:0
    ds_read_b64_tr_b16 a[240:241], v225 offset:8192
    ds_read_b64_tr_b16 a[242:243], v225 offset:9216
    ds_read_b64_tr_b16 a[244:245], v226 offset:8192
    ds_read_b64_tr_b16 a[246:247], v226 offset:9216
    s_lshl_b32 s68, s70, 19
    s_add_u32 m0, s71, 88064
    s_nop 0
    buffer_load_dwordx4 v211, s[40:43], s68 offen offset:0  lds
    buffer_load_dwordx4 v212, s[40:43], s68 offen offset:1024  lds
    buffer_load_dwordx4 v213, s[40:43], s68 offen offset:2048  lds
    buffer_load_dwordx4 v214, s[40:43], s68 offen offset:3072  lds
    s_lshl_b32 s69, s70, 7
    s_add_u32 m0, s71, 36864
    s_nop 0
    buffer_load_dwordx4 v206, s[36:39], s69 offen offset:0  lds
    buffer_load_dwordx4 v207, s[36:39], s69 offen offset:1024  lds
    buffer_load_dwordx4 v208, s[36:39], s69 offen offset:2048  lds
    buffer_load_dwordx4 v209, s[36:39], s69 offen offset:3072  lds
    s_lshl_b32 s67, s20, 9
    s_add_u32 m0, s67, 53248
    s_mov_b32 exec_hi, 0
    buffer_load_dwordx4 v210, s[36:39], s69 offen  lds
    s_mov_b32 exec_hi, -1
    s_add_u32 s70, s70, 1
    s_cmp_eq_u32 s70, 10
    s_cselect_b32 s70, 0, s70
    s_waitcnt vmcnt(10)
    s_waitcnt lgkmcnt(0)
    s_barrier
    s_lshl_b32 s68, s70, 19
    s_add_u32 m0, s71, 55296
    s_nop 0
    buffer_load_dwordx4 v211, s[40:43], s68 offen offset:0  lds
    v_mfma_f32_32x32x16_bf16 v[56:71], a[152:155], a[216:219], 0
    ds_read_b128 a[64:67], v215 offset:18432
    ds_read_b64_tr_b16 a[0:1], v221 offset:16384
    ds_read_b64_tr_b16 a[2:3], v221 offset:17408
    ds_read_b64_tr_b16 a[4:5], v222 offset:16384
    ds_read_b64_tr_b16 a[6:7], v222 offset:17408
    ds_read_b64_tr_b16 a[8:9], v223 offset:16384
    v_mfma_f32_32x32x16_bf16 v[72:87], a[156:159], a[216:219], 0
    ds_read_b64_tr_b16 a[10:11], v223 offset:17408
    ds_read_b64_tr_b16 a[12:13], v224 offset:16384
    ds_read_b64_tr_b16 a[14:15], v224 offset:17408
    ds_read_b128 a[68:71], v216 offset:18432
    buffer_load_dwordx4 v212, s[40:43], s68 offen offset:1024  lds
    v_mfma_f32_32x32x16_bf16 v[88:103], a[160:163], a[216:219], 0
    ds_read_b64_tr_b16 a[16:17], v221 offset:20480
    ds_read_b64_tr_b16 a[18:19], v221 offset:21504
    ds_read_b64_tr_b16 a[20:21], v222 offset:20480
    v_mfma_f32_32x32x16_bf16 v[104:119], a[164:167], a[216:219], 0
    ds_read_b64_tr_b16 a[22:23], v222 offset:21504
    ds_read_b64_tr_b16 a[24:25], v223 offset:20480
    ds_read_b64_tr_b16 a[26:27], v223 offset:21504
    buffer_load_dwordx4 v213, s[40:43], s68 offen offset:2048  lds
    v_mfma_f32_32x32x16_bf16 v[56:71], a[168:171], a[220:223], v[56:71]
    ds_read_b64_tr_b16 a[28:29], v224 offset:20480
    ds_read_b64_tr_b16 a[30:31], v224 offset:21504
    ds_read_b128 a[72:75], v217 offset:18432
    v_mfma_f32_32x32x16_bf16 v[72:87], a[172:175], a[220:223], v[72:87]
    ds_read_b64_tr_b16 a[32:33], v221 offset:24576
    ds_read_b64_tr_b16 a[34:35], v221 offset:25600
    ds_read_b64_tr_b16 a[36:37], v222 offset:24576
    buffer_load_dwordx4 v214, s[40:43], s68 offen offset:3072  lds
    v_mfma_f32_32x32x16_bf16 v[88:103], a[176:179], a[220:223], v[88:103]
    ds_read_b64_tr_b16 a[38:39], v222 offset:25600
    ds_read_b64_tr_b16 a[40:41], v223 offset:24576
    ds_read_b64_tr_b16 a[42:43], v223 offset:25600
    v_mfma_f32_32x32x16_bf16 v[104:119], a[180:183], a[220:223], v[104:119]
    s_lshl_b32 s69, s70, 7
    s_add_u32 m0, s71, 0
    ds_read_b64_tr_b16 a[44:45], v224 offset:24576
    ds_read_b64_tr_b16 a[46:47], v224 offset:25600
    ds_read_b128 a[76:79], v218 offset:18432
    buffer_load_dwordx4 v206, s[36:39], s69 offen offset:0  lds
    v_mfma_f32_32x32x16_bf16 v[56:71], a[184:187], a[224:227], v[56:71]
    ds_read_b64_tr_b16 a[48:49], v221 offset:28672
    ds_read_b64_tr_b16 a[50:51], v221 offset:29696
    ds_read_b64_tr_b16 a[52:53], v222 offset:28672
    v_mfma_f32_32x32x16_bf16 v[72:87], a[188:191], a[224:227], v[72:87]
    ds_read_b64_tr_b16 a[54:55], v222 offset:29696
    ds_read_b64_tr_b16 a[56:57], v223 offset:28672
    ds_read_b64_tr_b16 a[58:59], v223 offset:29696
    buffer_load_dwordx4 v207, s[36:39], s69 offen offset:1024  lds
    v_mfma_f32_32x32x16_bf16 v[88:103], a[192:195], a[224:227], v[88:103]
    ds_read_b64_tr_b16 a[60:61], v224 offset:28672
    ds_read_b64_tr_b16 a[62:63], v224 offset:29696
    ds_read_b128 a[96:99], v219 offset:18432
    v_mfma_f32_32x32x16_bf16 v[104:119], a[196:199], a[224:227], v[104:119]
    ds_read_b64_tr_b16 a[80:81], v225 offset:16384
    ds_read_b64_tr_b16 a[82:83], v225 offset:17408
    ds_read_b64_tr_b16 a[84:85], v226 offset:16384
    buffer_load_dwordx4 v208, s[36:39], s69 offen offset:2048  lds
    v_mfma_f32_32x32x16_bf16 v[56:71], a[200:203], a[228:231], v[56:71]
    ds_read_b64_tr_b16 a[86:87], v226 offset:17408
    ds_read_b128 a[100:103], v220 offset:18432
    ds_read_b64_tr_b16 a[88:89], v225 offset:24576
    v_mfma_f32_32x32x16_bf16 v[72:87], a[204:207], a[228:231], v[72:87]
    ds_read_b64_tr_b16 a[90:91], v225 offset:25600
    ds_read_b64_tr_b16 a[92:93], v226 offset:24576
    ds_read_b64_tr_b16 a[94:95], v226 offset:25600
    buffer_load_dwordx4 v209, s[36:39], s69 offen offset:3072  lds
    v_mfma_f32_32x32x16_bf16 v[88:103], a[208:211], a[228:231], v[88:103]
    v_mfma_f32_32x32x16_bf16 v[104:119], a[212:215], a[228:231], v[104:119]
    s_lshl_b32 s67, s20, 9
    s_add_u32 m0, s67, 16384
    s_mov_b32 exec_hi, 0
    buffer_load_dwordx4 v210, s[36:39], s69 offen  lds
    s_mov_b32 exec_hi, -1
    v_mfma_f32_16x16x32_bf16 v[120:123], a[232:235], a[248:251], 0
    v_mfma_f32_16x16x32_bf16 v[124:127], a[236:239], a[248:251], 0
    v_mfma_f32_16x16x32_bf16 v[120:123], a[240:243], a[252:255], v[120:123]
    s_add_u32 s70, s70, 1
    s_cmp_eq_u32 s70, 10
    s_cselect_b32 s70, 0, s70
    v_mfma_f32_16x16x32_bf16 v[124:127], a[244:247], a[252:255], v[124:127]
    s_waitcnt vmcnt(9)
    s_waitcnt lgkmcnt(0)
    s_barrier
    s_lshl_b32 s68, s70, 19
    s_add_u32 m0, s71, 71680
    s_nop 0
    buffer_load_dwordx4 v211, s[40:43], s68 offen offset:0  lds
    v_mfma_f32_32x32x16_bf16 v[56:71], a[0:3], a[64:67], v[56:71]
    ds_read_b128 a[216:219], v215 offset:36864
    ds_read_b64_tr_b16 a[152:153], v221 offset:32768
    ds_read_b64_tr_b16 a[154:155], v221 offset:33792
    ds_read_b64_tr_b16 a[156:157], v222 offset:32768
    ds_read_b64_tr_b16 a[158:159], v222 offset:33792
    buffer_load_dwordx4 v212, s[40:43], s68 offen offset:1024  lds
    v_mfma_f32_32x32x16_bf16 v[72:87], a[4:7], a[64:67], v[72:87]
    ds_read_b64_tr_b16 a[160:161], v223 offset:32768
    ds_read_b64_tr_b16 a[162:163], v223 offset:33792
    ds_read_b64_tr_b16 a[164:165], v224 offset:32768
    ds_read_b64_tr_b16 a[166:167], v224 offset:33792
    ds_read_b128 a[220:223], v216 offset:36864
    buffer_load_dwordx4 v213, s[40:43], s68 offen offset:2048  lds
    v_mfma_f32_32x32x16_bf16 v[88:103], a[8:11], a[64:67], v[88:103]
    ds_read_b64_tr_b16 a[168:169], v221 offset:36864
    ds_read_b64_tr_b16 a[170:171], v221 offset:37888
    ds_read_b64_tr_b16 a[172:173], v222 offset:36864
    v_mfma_f32_32x32x16_bf16 v[104:119], a[12:15], a[64:67], v[104:119]
    ds_read_b64_tr_b16 a[174:175], v222 offset:37888
    ds_read_b64_tr_b16 a[176:177], v223 offset:36864
    ds_read_b64_tr_b16 a[178:179], v223 offset:37888
    buffer_load_dwordx4 v214, s[40:43], s68 offen offset:3072  lds
    v_mfma_f32_32x32x16_bf16 v[56:71], a[16:19], a[68:71], v[56:71]
    s_lshl_b32 s69, s70, 7
    s_add_u32 m0, s71, 18432
    ds_read_b64_tr_b16 a[180:181], v224 offset:36864
    ds_read_b64_tr_b16 a[182:183], v224 offset:37888
    ds_read_b128 a[224:227], v217 offset:36864
    buffer_load_dwordx4 v206, s[36:39], s69 offen offset:0  lds
    v_mfma_f32_32x32x16_bf16 v[72:87], a[20:23], a[68:71], v[72:87]
    ds_read_b64_tr_b16 a[184:185], v221 offset:40960
    ds_read_b64_tr_b16 a[186:187], v221 offset:41984
    ds_read_b64_tr_b16 a[188:189], v222 offset:40960
    v_mfma_f32_32x32x16_bf16 v[88:103], a[24:27], a[68:71], v[88:103]
    ds_read_b64_tr_b16 a[190:191], v222 offset:41984
    ds_read_b64_tr_b16 a[192:193], v223 offset:40960
    ds_read_b64_tr_b16 a[194:195], v223 offset:41984
    buffer_load_dwordx4 v207, s[36:39], s69 offen offset:1024  lds
    v_mfma_f32_32x32x16_bf16 v[104:119], a[28:31], a[68:71], v[104:119]
    ds_read_b64_tr_b16 a[196:197], v224 offset:40960
    ds_read_b64_tr_b16 a[198:199], v224 offset:41984
    ds_read_b128 a[228:231], v218 offset:36864
    buffer_load_dwordx4 v208, s[36:39], s69 offen offset:2048  lds
    v_mfma_f32_32x32x16_bf16 v[56:71], a[32:35], a[72:75], v[56:71]
    ds_read_b64_tr_b16 a[200:201], v221 offset:45056
    ds_read_b64_tr_b16 a[202:203], v221 offset:46080
    ds_read_b64_tr_b16 a[204:205], v222 offset:45056
    v_mfma_f32_32x32x16_bf16 v[72:87], a[36:39], a[72:75], v[72:87]
    ds_read_b64_tr_b16 a[206:207], v222 offset:46080
    ds_read_b64_tr_b16 a[208:209], v223 offset:45056
    ds_read_b64_tr_b16 a[210:211], v223 offset:46080
    buffer_load_dwordx4 v209, s[36:39], s69 offen offset:3072  lds
    v_mfma_f32_32x32x16_bf16 v[88:103], a[40:43], a[72:75], v[88:103]
    ds_read_b64_tr_b16 a[212:213], v224 offset:45056
    ds_read_b64_tr_b16 a[214:215], v224 offset:46080
    ds_read_b128 a[248:251], v219 offset:36864
    s_lshl_b32 s67, s20, 9
    s_add_u32 m0, s67, 34816
    s_mov_b32 exec_hi, 0
    buffer_load_dwordx4 v210, s[36:39], s69 offen  lds
    s_mov_b32 exec_hi, -1
    v_mfma_f32_32x32x16_bf16 v[104:119], a[44:47], a[72:75], v[104:119]
    ds_read_b64_tr_b16 a[232:233], v225 offset:32768
    ds_read_b64_tr_b16 a[234:235], v225 offset:33792
    ds_read_b64_tr_b16 a[236:237], v226 offset:32768
    v_mfma_f32_32x32x16_bf16 v[56:71], a[48:51], a[76:79], v[56:71]
    s_add_u32 s70, s70, 1
    s_cmp_eq_u32 s70, 10
    s_cselect_b32 s70, 0, s70
    s_mov_b32 s66, 0
    s_add_u32 m0, s71, 114688
    ds_read_b64_tr_b16 a[238:239], v226 offset:33792
    ds_read_b128 a[252:255], v220 offset:36864
    ds_read_b64_tr_b16 a[240:241], v225 offset:40960
    buffer_load_dwordx4 v200, s[28:31], s66 offen offset:0 nt lds
    v_mfma_f32_32x32x16_bf16 v[72:87], a[52:55], a[76:79], v[72:87]
    ds_read_b64_tr_b16 a[242:243], v225 offset:41984
    ds_read_b64_tr_b16 a[244:245], v226 offset:40960
    ds_read_b64_tr_b16 a[246:247], v226 offset:41984
    buffer_load_dwordx4 v201, s[28:31], s66 offen offset:1024 nt lds
    v_mfma_f32_32x32x16_bf16 v[88:103], a[56:59], a[76:79], v[88:103]
    v_mfma_f32_32x32x16_bf16 v[104:119], a[60:63], a[76:79], v[104:119]
    buffer_load_dwordx4 v202, s[28:31], s66 offen offset:2048 nt lds
    v_mfma_f32_16x16x32_bf16 v[120:123], a[80:83], a[96:99], v[120:123]
    buffer_load_dwordx4 v203, s[28:31], s66 offen offset:3072 nt lds
    v_mfma_f32_16x16x32_bf16 v[124:127], a[84:87], a[96:99], v[124:127]
    v_mfma_f32_16x16x32_bf16 v[120:123], a[88:91], a[100:103], v[120:123]
    v_mfma_f32_16x16x32_bf16 v[124:127], a[92:95], a[100:103], v[124:127]
    s_waitcnt vmcnt(13)
    s_waitcnt lgkmcnt(0)
    s_barrier
    s_lshl_b32 s68, s70, 19
    s_add_u32 m0, s71, 88064
    s_nop 0
    buffer_load_dwordx4 v211, s[40:43], s68 offen offset:0  lds
    v_mfma_f32_32x32x16_bf16 v[56:71], a[152:155], a[216:219], v[56:71]
    ds_read_b128 a[64:67], v215 offset:0
    ds_read_b64_tr_b16 a[0:1], v221 offset:0
    ds_read_b64_tr_b16 a[2:3], v221 offset:1024
    ds_read_b64_tr_b16 a[4:5], v222 offset:0
    ds_read_b64_tr_b16 a[6:7], v222 offset:1024
    buffer_load_dwordx4 v212, s[40:43], s68 offen offset:1024  lds
    v_mfma_f32_32x32x16_bf16 v[72:87], a[156:159], a[216:219], v[72:87]
    ds_read_b64_tr_b16 a[8:9], v223 offset:0
    ds_read_b64_tr_b16 a[10:11], v223 offset:1024
    ds_read_b64_tr_b16 a[12:13], v224 offset:0
    ds_read_b64_tr_b16 a[14:15], v224 offset:1024
    ds_read_b128 a[68:71], v216 offset:0
    buffer_load_dwordx4 v213, s[40:43], s68 offen offset:2048  lds
    v_mfma_f32_32x32x16_bf16 v[88:103], a[160:163], a[216:219], v[88:103]
    ds_read_b64_tr_b16 a[16:17], v221 offset:4096
    ds_read_b64_tr_b16 a[18:19], v221 offset:5120
    ds_read_b64_tr_b16 a[20:21], v222 offset:4096
    v_mfma_f32_32x32x16_bf16 v[104:119], a[164:167], a[216:219], v[104:119]
    ds_read_b64_tr_b16 a[22:23], v222 offset:5120
    ds_read_b64_tr_b16 a[24:25], v223 offset:4096
    ds_read_b64_tr_b16 a[26:27], v223 offset:5120
    buffer_load_dwordx4 v214, s[40:43], s68 offen offset:3072  lds
    v_mfma_f32_32x32x16_bf16 v[56:71], a[168:171], a[220:223], v[56:71]
    s_lshl_b32 s69, s70, 7
    s_add_u32 m0, s71, 36864
    ds_read_b64_tr_b16 a[28:29], v224 offset:4096
    ds_read_b64_tr_b16 a[30:31], v224 offset:5120
    ds_read_b128 a[72:75], v217 offset:0
    buffer_load_dwordx4 v206, s[36:39], s69 offen offset:0  lds
    v_mfma_f32_32x32x16_bf16 v[72:87], a[172:175], a[220:223], v[72:87]
    ds_read_b64_tr_b16 a[32:33], v221 offset:8192
    ds_read_b64_tr_b16 a[34:35], v221 offset:9216
    ds_read_b64_tr_b16 a[36:37], v222 offset:8192
    buffer_load_dwordx4 v207, s[36:39], s69 offen offset:1024  lds
    v_mfma_f32_32x32x16_bf16 v[88:103], a[176:179], a[220:223], v[88:103]
    ds_read_b64_tr_b16 a[38:39], v222 offset:9216
    ds_read_b64_tr_b16 a[40:41], v223 offset:8192
    ds_read_b64_tr_b16 a[42:43], v223 offset:9216
    v_mfma_f32_32x32x16_bf16 v[104:119], a[180:183], a[220:223], v[104:119]
    ds_read_b64_tr_b16 a[44:45], v224 offset:8192
    ds_read_b64_tr_b16 a[46:47], v224 offset:9216
    ds_read_b128 a[76:79], v218 offset:0
    buffer_load_dwordx4 v208, s[36:39], s69 offen offset:2048  lds
    v_mfma_f32_32x32x16_bf16 v[56:71], a[184:187], a[224:227], v[56:71]
    ds_read_b64_tr_b16 a[48:49], v221 offset:12288
    ds_read_b64_tr_b16 a[50:51], v221 offset:13312
    ds_read_b64_tr_b16 a[52:53], v222 offset:12288
    buffer_load_dwordx4 v209, s[36:39], s69 offen offset:3072  lds
    v_mfma_f32_32x32x16_bf16 v[72:87], a[188:191], a[224:227], v[72:87]
    ds_read_b64_tr_b16 a[54:55], v222 offset:13312
    ds_read_b64_tr_b16 a[56:57], v223 offset:12288
    ds_read_b64_tr_b16 a[58:59], v223 offset:13312
    s_lshl_b32 s67, s20, 9
    s_add_u32 m0, s67, 53248
    s_mov_b32 exec_hi, 0
    buffer_load_dwordx4 v210, s[36:39], s69 offen  lds
    s_mov_b32 exec_hi, -1
    v_mfma_f32_32x32x16_bf16 v[88:103], a[192:195], a[224:227], v[88:103]
    ds_read_b64_tr_b16 a[60:61], v224 offset:12288
    ds_read_b64_tr_b16 a[62:63], v224 offset:13312
    ds_read_b128 a[96:99], v219 offset:0
    v_mfma_f32_32x32x16_bf16 v[104:119], a[196:199], a[224:227], v[104:119]
    s_add_u32 s70, s70, 1
    s_cmp_eq_u32 s70, 10
    s_cselect_b32 s70, 0, s70
    ds_read_b64_tr_b16 a[80:81], v225 offset:0
    ds_read_b64_tr_b16 a[82:83], v225 offset:1024
    ds_read_b64_tr_b16 a[84:85], v226 offset:0
    v_mov_b32 v240, -1
    v_mov_b32 v241, -1
    v_mov_b32 v242, -1
    v_mov_b32 v243, -1
    buffer_store_dwordx4 v[240:243], v236, s[48:51], s18 offen offset:0 sc1
    v_mfma_f32_32x32x16_bf16 v[56:71], a[200:203], a[228:231], v[56:71]
    ds_read_b64_tr_b16 a[86:87], v226 offset:1024
    ds_read_b128 a[100:103], v220 offset:0
    ds_read_b64_tr_b16 a[88:89], v225 offset:8192
    buffer_store_dwordx4 v[240:243], v236, s[48:51], s18 offen offset:1024 sc1
    v_mfma_f32_32x32x16_bf16 v[72:87], a[204:207], a[228:231], v[72:87]
    ds_read_b64_tr_b16 a[90:91], v225 offset:9216
    ds_read_b64_tr_b16 a[92:93], v226 offset:8192
    ds_read_b64_tr_b16 a[94:95], v226 offset:9216
    buffer_store_dwordx4 v[240:243], v236, s[48:51], s18 offen offset:2048 sc1
    v_mfma_f32_32x32x16_bf16 v[88:103], a[208:211], a[228:231], v[88:103]
    v_mfma_f32_32x32x16_bf16 v[104:119], a[212:215], a[228:231], v[104:119]
    buffer_store_dwordx4 v[240:243], v236, s[48:51], s18 offen offset:3072 sc1
    v_mfma_f32_16x16x32_bf16 v[120:123], a[232:235], a[248:251], v[120:123]
    s_add_u32 s63, s18, 4096
    s_mov_b32 exec_hi, 0
    buffer_store_dwordx4 v[240:243], v236, s[48:51], s63 offen sc1
    s_mov_b32 exec_hi, -1
    v_mfma_f32_16x16x32_bf16 v[124:127], a[236:239], a[248:251], v[124:127]
    v_mfma_f32_16x16x32_bf16 v[120:123], a[240:243], a[252:255], v[120:123]
    v_mfma_f32_16x16x32_bf16 v[124:127], a[244:247], a[252:255], v[124:127]
    s_waitcnt vmcnt(18)
    s_waitcnt lgkmcnt(0)
    s_barrier
    s_lshl_b32 s68, s70, 19
    s_add_u32 m0, s71, 55296
    s_nop 0
    buffer_load_dwordx4 v211, s[40:43], s68 offen offset:0  lds
    v_mfma_f32_32x32x16_bf16 v[56:71], a[0:3], a[64:67], v[56:71]
    ds_read_b128 a[216:219], v215 offset:18432
    ds_read_b64_tr_b16 a[152:153], v221 offset:16384
    ds_read_b64_tr_b16 a[154:155], v221 offset:17408
    ds_read_b64_tr_b16 a[156:157], v222 offset:16384
    ds_read_b64_tr_b16 a[158:159], v222 offset:17408
    ds_read_b64_tr_b16 a[160:161], v223 offset:16384
    v_mfma_f32_32x32x16_bf16 v[72:87], a[4:7], a[64:67], v[72:87]
    ds_read_b64_tr_b16 a[162:163], v223 offset:17408
    ds_read_b64_tr_b16 a[164:165], v224 offset:16384
    ds_read_b64_tr_b16 a[166:167], v224 offset:17408
    ds_read_b128 a[220:223], v216 offset:18432
    buffer_load_dwordx4 v212, s[40:43], s68 offen offset:1024  lds
    v_mfma_f32_32x32x16_bf16 v[88:103], a[8:11], a[64:67], v[88:103]
    ds_read_b64_tr_b16 a[168:169], v221 offset:20480
    ds_read_b64_tr_b16 a[170:171], v221 offset:21504
    ds_read_b64_tr_b16 a[172:173], v222 offset:20480
    v_mfma_f32_32x32x16_bf16 v[104:119], a[12:15], a[64:67], v[104:119]
    ds_read_b64_tr_b16 a[174:175], v222 offset:21504
    ds_read_b64_tr_b16 a[176:177], v223 offset:20480
    ds_read_b64_tr_b16 a[178:179], v223 offset:21504
    buffer_load_dwordx4 v213, s[40:43], s68 offen offset:2048  lds
    v_mfma_f32_32x32x16_bf16 v[56:71], a[16:19], a[68:71], v[56:71]
    ds_read_b64_tr_b16 a[180:181], v224 offset:20480
    ds_read_b64_tr_b16 a[182:183], v224 offset:21504
    ds_read_b128 a[224:227], v217 offset:18432
    v_mfma_f32_32x32x16_bf16 v[72:87], a[20:23], a[68:71], v[72:87]
    ds_read_b64_tr_b16 a[184:185], v221 offset:24576
    ds_read_b64_tr_b16 a[186:187], v221 offset:25600
    ds_read_b64_tr_b16 a[188:189], v222 offset:24576
    buffer_load_dwordx4 v214, s[40:43], s68 offen offset:3072  lds
    v_mfma_f32_32x32x16_bf16 v[88:103], a[24:27], a[68:71], v[88:103]
    ds_read_b64_tr_b16 a[190:191], v222 offset:25600
    ds_read_b64_tr_b16 a[192:193], v223 offset:24576
    ds_read_b64_tr_b16 a[194:195], v223 offset:25600
    v_mfma_f32_32x32x16_bf16 v[104:119], a[28:31], a[68:71], v[104:119]
    s_lshl_b32 s69, s70, 7
    s_add_u32 m0, s71, 0
    ds_read_b64_tr_b16 a[196:197], v224 offset:24576
    ds_read_b64_tr_b16 a[198:199], v224 offset:25600
    ds_read_b128 a[228:231], v218 offset:18432
    buffer_load_dwordx4 v206, s[36:39], s69 offen offset:0  lds
    v_mfma_f32_32x32x16_bf16 v[56:71], a[32:35], a[72:75], v[56:71]
    ds_read_b64_tr_b16 a[200:201], v221 offset:28672
    ds_read_b64_tr_b16 a[202:203], v221 offset:29696
    ds_read_b64_tr_b16 a[204:205], v222 offset:28672
    v_mfma_f32_32x32x16_bf16 v[72:87], a[36:39], a[72:75], v[72:87]
    ds_read_b64_tr_b16 a[206:207], v222 offset:29696
    ds_read_b64_tr_b16 a[208:209], v223 offset:28672
    ds_read_b64_tr_b16 a[210:211], v223 offset:29696
    buffer_load_dwordx4 v207, s[36:39], s69 offen offset:1024  lds
    v_mfma_f32_32x32x16_bf16 v[88:103], a[40:43], a[72:75], v[88:103]
    ds_read_b64_tr_b16 a[212:213], v224 offset:28672
    ds_read_b64_tr_b16 a[214:215], v224 offset:29696
    ds_read_b128 a[248:251], v219 offset:18432
    v_mfma_f32_32x32x16_bf16 v[104:119], a[44:47], a[72:75], v[104:119]
    ds_read_b64_tr_b16 a[232:233], v225 offset:16384
    ds_read_b64_tr_b16 a[234:235], v225 offset:17408
    ds_read_b64_tr_b16 a[236:237], v226 offset:16384
    buffer_load_dwordx4 v208, s[36:39], s69 offen offset:2048  lds
    v_mfma_f32_32x32x16_bf16 v[56:71], a[48:51], a[76:79], v[56:71]
    ds_read_b64_tr_b16 a[238:239], v226 offset:17408
    ds_read_b128 a[252:255], v220 offset:18432
    ds_read_b64_tr_b16 a[240:241], v225 offset:24576
    v_mfma_f32_32x32x16_bf16 v[72:87], a[52:55], a[76:79], v[72:87]
    ds_read_b64_tr_b16 a[242:243], v225 offset:25600
    ds_read_b64_tr_b16 a[244:245], v226 offset:24576
    ds_read_b64_tr_b16 a[246:247], v226 offset:25600
    buffer_load_dwordx4 v209, s[36:39], s69 offen offset:3072  lds
    v_mfma_f32_32x32x16_bf16 v[88:103], a[56:59], a[76:79], v[88:103]
    v_mfma_f32_32x32x16_bf16 v[104:119], a[60:63], a[76:79], v[104:119]
    s_lshl_b32 s67, s20, 9
    s_add_u32 m0, s67, 16384
    s_mov_b32 exec_hi, 0
    buffer_load_dwordx4 v210, s[36:39], s69 offen  lds
    s_mov_b32 exec_hi, -1
    v_mfma_f32_16x16x32_bf16 v[120:123], a[80:83], a[96:99], v[120:123]
    v_mfma_f32_16x16x32_bf16 v[124:127], a[84:87], a[96:99], v[124:127]
    v_mfma_f32_16x16x32_bf16 v[120:123], a[88:91], a[100:103], v[120:123]
    s_add_u32 s70, s70, 1
    s_cmp_eq_u32 s70, 10
    s_cselect_b32 s70, 0, s70
    v_mfma_f32_16x16x32_bf16 v[124:127], a[92:95], a[100:103], v[124:127]
    s_waitcnt vmcnt(14)
    s_waitcnt lgkmcnt(0)
    s_barrier
    s_lshl_b32 s68, s70, 19
    s_add_u32 m0, s71, 71680
    s_nop 0
    buffer_load_dwordx4 v211, s[40:43], s68 offen offset:0  lds
    v_mfma_f32_32x32x16_bf16 v[56:71], a[152:155], a[216:219], v[56:71]
    ds_read_b128 a[64:67], v215 offset:36864
    ds_read_b64_tr_b16 a[0:1], v221 offset:32768
    ds_read_b64_tr_b16 a[2:3], v221 offset:33792
    ds_read_b64_tr_b16 a[4:5], v222 offset:32768
    ds_read_b64_tr_b16 a[6:7], v222 offset:33792
    buffer_load_dwordx4 v212, s[40:43], s68 offen offset:1024  lds
    v_mfma_f32_32x32x16_bf16 v[72:87], a[156:159], a[216:219], v[72:87]
    ds_read_b64_tr_b16 a[8:9], v223 offset:32768
    ds_read_b64_tr_b16 a[10:11], v223 offset:33792
    ds_read_b64_tr_b16 a[12:13], v224 offset:32768
    ds_read_b64_tr_b16 a[14:15], v224 offset:33792
    ds_read_b128 a[68:71], v216 offset:36864
    buffer_load_dwordx4 v213, s[40:43], s68 offen offset:2048  lds
    v_mfma_f32_32x32x16_bf16 v[88:103], a[160:163], a[216:219], v[88:103]
    ds_read_b64_tr_b16 a[16:17], v221 offset:36864
    ds_read_b64_tr_b16 a[18:19], v221 offset:37888
    ds_read_b64_tr_b16 a[20:21], v222 offset:36864
    v_mfma_f32_32x32x16_bf16 v[104:119], a[164:167], a[216:219], v[104:119]
    ds_read_b64_tr_b16 a[22:23], v222 offset:37888
    ds_read_b64_tr_b16 a[24:25], v223 offset:36864
    ds_read_b64_tr_b16 a[26:27], v223 offset:37888
    buffer_load_dwordx4 v214, s[40:43], s68 offen offset:3072  lds
    v_mfma_f32_32x32x16_bf16 v[56:71], a[168:171], a[220:223], v[56:71]
    s_lshl_b32 s69, s70, 7
    s_add_u32 m0, s71, 18432
    ds_read_b64_tr_b16 a[28:29], v224 offset:36864
    ds_read_b64_tr_b16 a[30:31], v224 offset:37888
    ds_read_b128 a[72:75], v217 offset:36864
    buffer_load_dwordx4 v206, s[36:39], s69 offen offset:0  lds
    v_mfma_f32_32x32x16_bf16 v[72:87], a[172:175], a[220:223], v[72:87]
    ds_read_b64_tr_b16 a[32:33], v221 offset:40960
    ds_read_b64_tr_b16 a[34:35], v221 offset:41984
    ds_read_b64_tr_b16 a[36:37], v222 offset:40960
    buffer_load_dwordx4 v207, s[36:39], s69 offen offset:1024  lds
    v_mfma_f32_32x32x16_bf16 v[88:103], a[176:179], a[220:223], v[88:103]
    ds_read_b64_tr_b16 a[38:39], v222 offset:41984
    ds_read_b64_tr_b16 a[40:41], v223 offset:40960
    ds_read_b64_tr_b16 a[42:43], v223 offset:41984
    v_mfma_f32_32x32x16_bf16 v[104:119], a[180:183], a[220:223], v[104:119]
    ds_read_b64_tr_b16 a[44:45], v224 offset:40960
    ds_read_b64_tr_b16 a[46:47], v224 offset:41984
    ds_read_b128 a[76:79], v218 offset:36864
    buffer_load_dwordx4 v208, s[36:39], s69 offen offset:2048  lds
    v_mfma_f32_32x32x16_bf16 v[56:71], a[184:187], a[224:227], v[56:71]
    ds_read_b64_tr_b16 a[48:49], v221 offset:45056
    ds_read_b64_tr_b16 a[50:51], v221 offset:46080
    ds_read_b64_tr_b16 a[52:53], v222 offset:45056
    buffer_load_dwordx4 v209, s[36:39], s69 offen offset:3072  lds
    v_mfma_f32_32x32x16_bf16 v[72:87], a[188:191], a[224:227], v[72:87]
    ds_read_b64_tr_b16 a[54:55], v222 offset:46080
    ds_read_b64_tr_b16 a[56:57], v223 offset:45056
    ds_read_b64_tr_b16 a[58:59], v223 offset:46080
    s_lshl_b32 s67, s20, 9
    s_add_u32 m0, s67, 34816
    s_mov_b32 exec_hi, 0
    buffer_load_dwordx4 v210, s[36:39], s69 offen  lds
    s_mov_b32 exec_hi, -1
    v_mfma_f32_32x32x16_bf16 v[88:103], a[192:195], a[224:227], v[88:103]
    ds_read_b64_tr_b16 a[60:61], v224 offset:45056
    ds_read_b64_tr_b16 a[62:63], v224 offset:46080
    ds_read_b128 a[96:99], v219 offset:36864
    v_mfma_f32_32x32x16_bf16 v[104:119], a[196:199], a[224:227], v[104:119]
    s_add_u32 s70, s70, 1
    s_cmp_eq_u32 s70, 10
    s_cselect_b32 s70, 0, s70
    s_mov_b32 s66, 16384
    s_add_u32 m0, s71, 131072
    ds_read_b64_tr_b16 a[80:81], v225 offset:32768
    ds_read_b64_tr_b16 a[82:83], v225 offset:33792
    ds_read_b64_tr_b16 a[84:85], v226 offset:32768
    buffer_load_dwordx4 v200, s[28:31], s66 offen offset:0 nt lds
    v_mfma_f32_32x32x16_bf16 v[56:71], a[200:203], a[228:231], v[56:71]
    ds_read_b64_tr_b16 a[86:87], v226 offset:33792
    ds_read_b128 a[100:103], v220 offset:36864
    ds_read_b64_tr_b16 a[88:89], v225 offset:40960
    buffer_load_dwordx4 v201, s[28:31], s66 offen offset:1024 nt lds
    v_mfma_f32_32x32x16_bf16 v[72:87], a[204:207], a[228:231], v[72:87]
    ds_read_b64_tr_b16 a[90:91], v225 offset:41984
    ds_read_b64_tr_b16 a[92:93], v226 offset:40960
    ds_read_b64_tr_b16 a[94:95], v226 offset:41984
    buffer_load_dwordx4 v202, s[28:31], s66 offen offset:2048 nt lds
    v_mfma_f32_32x32x16_bf16 v[88:103], a[208:211], a[228:231], v[88:103]
    v_mfma_f32_32x32x16_bf16 v[104:119], a[212:215], a[228:231], v[104:119]
    buffer_load_dwordx4 v203, s[28:31], s66 offen offset:3072 nt lds
    v_mfma_f32_16x16x32_bf16 v[120:123], a[232:235], a[248:251], v[120:123]
    s_lshl_b32 s63, s20, 3
    s_add_u32 s63, s63, s2
    s_lshl_b32 s64, s2, 2
    s_cmp_lt_u32 s63, 8
    s_cselect_b32 s64, s64, 0x7ff00000
    v_or_b32 v6, s64, v237
    v_mov_b32 v5, 1
    buffer_store_dword v5, v6, s[56:59], 0 offen sc1
    v_mfma_f32_16x16x32_bf16 v[124:127], a[236:239], a[248:251], v[124:127]
    v_mfma_f32_16x16x32_bf16 v[120:123], a[240:243], a[252:255], v[120:123]
    v_mfma_f32_16x16x32_bf16 v[124:127], a[244:247], a[252:255], v[124:127]
    s_waitcnt vmcnt(14)
    s_waitcnt lgkmcnt(0)
    s_barrier
    s_lshl_b32 s68, s70, 19
    s_add_u32 m0, s71, 88064
    s_nop 0
    buffer_load_dwordx4 v211, s[40:43], s68 offen offset:0  lds
    v_mfma_f32_32x32x16_bf16 v[56:71], a[0:3], a[64:67], v[56:71]
    ds_read_b128 a[216:219], v215 offset:0
    ds_read_b64_tr_b16 a[152:153], v221 offset:0
    ds_read_b64_tr_b16 a[154:155], v221 offset:1024
    ds_read_b64_tr_b16 a[156:157], v222 offset:0
    ds_read_b64_tr_b16 a[158:159], v222 offset:1024
    ds_read_b64_tr_b16 a[160:161], v223 offset:0
    v_mfma_f32_32x32x16_bf16 v[72:87], a[4:7], a[64:67], v[72:87]
    ds_read_b64_tr_b16 a[162:163], v223 offset:1024
    ds_read_b64_tr_b16 a[164:165], v224 offset:0
    ds_read_b64_tr_b16 a[166:167], v224 offset:1024
    ds_read_b128 a[220:223], v216 offset:0
    buffer_load_dwordx4 v212, s[40:43], s68 offen offset:1024  lds
    v_mfma_f32_32x32x16_bf16 v[88:103], a[8:11], a[64:67], v[88:103]
    ds_read_b64_tr_b16 a[168:169], v221 offset:4096
    ds_read_b64_tr_b16 a[170:171], v221 offset:5120
    ds_read_b64_tr_b16 a[172:173], v222 offset:4096
    v_mfma_f32_32x32x16_bf16 v[104:119], a[12:15], a[64:67], v[104:119]
    ds_read_b64_tr_b16 a[174:175], v222 offset:5120
    ds_read_b64_tr_b16 a[176:177], v223 offset:4096
    ds_read_b64_tr_b16 a[178:179], v223 offset:5120
    buffer_load_dwordx4 v213, s[40:43], s68 offen offset:2048  lds
    v_mfma_f32_32x32x16_bf16 v[56:71], a[16:19], a[68:71], v[56:71]
    ds_read_b64_tr_b16 a[180:181], v224 offset:4096
    ds_read_b64_tr_b16 a[182:183], v224 offset:5120
    ds_read_b128 a[224:227], v217 offset:0
    v_mfma_f32_32x32x16_bf16 v[72:87], a[20:23], a[68:71], v[72:87]
    ds_read_b64_tr_b16 a[184:185], v221 offset:8192
    ds_read_b64_tr_b16 a[186:187], v221 offset:9216
    ds_read_b64_tr_b16 a[188:189], v222 offset:8192
    buffer_load_dwordx4 v214, s[40:43], s68 offen offset:3072  lds
    v_mfma_f32_32x32x16_bf16 v[88:103], a[24:27], a[68:71], v[88:103]
    ds_read_b64_tr_b16 a[190:191], v222 offset:9216
    ds_read_b64_tr_b16 a[192:193], v223 offset:8192
    ds_read_b64_tr_b16 a[194:195], v223 offset:9216
    v_mfma_f32_32x32x16_bf16 v[104:119], a[28:31], a[68:71], v[104:119]
    s_lshl_b32 s69, s70, 7
    s_add_u32 m0, s71, 36864
    ds_read_b64_tr_b16 a[196:197], v224 offset:8192
    ds_read_b64_tr_b16 a[198:199], v224 offset:9216
    ds_read_b128 a[228:231], v218 offset:0
    buffer_load_dwordx4 v206, s[36:39], s69 offen offset:0  lds
    v_mfma_f32_32x32x16_bf16 v[56:71], a[32:35], a[72:75], v[56:71]
    ds_read_b64_tr_b16 a[200:201], v221 offset:12288
    ds_read_b64_tr_b16 a[202:203], v221 offset:13312
    ds_read_b64_tr_b16 a[204:205], v222 offset:12288
    v_mfma_f32_32x32x16_bf16 v[72:87], a[36:39], a[72:75], v[72:87]
    ds_read_b64_tr_b16 a[206:207], v222 offset:13312
    ds_read_b64_tr_b16 a[208:209], v223 offset:12288
    ds_read_b64_tr_b16 a[210:211], v223 offset:13312
    buffer_load_dwordx4 v207, s[36:39], s69 offen offset:1024  lds
    v_mfma_f32_32x32x16_bf16 v[88:103], a[40:43], a[72:75], v[88:103]
    ds_read_b64_tr_b16 a[212:213], v224 offset:12288
    ds_read_b64_tr_b16 a[214:215], v224 offset:13312
    ds_read_b128 a[248:251], v219 offset:0
    v_mfma_f32_32x32x16_bf16 v[104:119], a[44:47], a[72:75], v[104:119]
    ds_read_b64_tr_b16 a[232:233], v225 offset:0
    ds_read_b64_tr_b16 a[234:235], v225 offset:1024
    ds_read_b64_tr_b16 a[236:237], v226 offset:0
    buffer_load_dwordx4 v208, s[36:39], s69 offen offset:2048  lds
    v_mfma_f32_32x32x16_bf16 v[56:71], a[48:51], a[76:79], v[56:71]
    ds_read_b64_tr_b16 a[238:239], v226 offset:1024
    ds_read_b128 a[252:255], v220 offset:0
    ds_read_b64_tr_b16 a[240:241], v225 offset:8192
    v_mfma_f32_32x32x16_bf16 v[72:87], a[52:55], a[76:79], v[72:87]
    ds_read_b64_tr_b16 a[242:243], v225 offset:9216
    ds_read_b64_tr_b16 a[244:245], v226 offset:8192
    ds_read_b64_tr_b16 a[246:247], v226 offset:9216
    buffer_load_dwordx4 v209, s[36:39], s69 offen offset:3072  lds
    v_mfma_f32_32x32x16_bf16 v[88:103], a[56:59], a[76:79], v[88:103]
    v_mfma_f32_32x32x16_bf16 v[104:119], a[60:63], a[76:79], v[104:119]
    s_lshl_b32 s67, s20, 9
    s_add_u32 m0, s67, 53248
    s_mov_b32 exec_hi, 0
    buffer_load_dwordx4 v210, s[36:39], s69 offen  lds
    s_mov_b32 exec_hi, -1
    v_mfma_f32_16x16x32_bf16 v[120:123], a[80:83], a[96:99], v[120:123]
    v_mfma_f32_16x16x32_bf16 v[124:127], a[84:87], a[96:99], v[124:127]
    v_mfma_f32_16x16x32_bf16 v[120:123], a[88:91], a[100:103], v[120:123]
    s_add_u32 s70, s70, 1
    s_cmp_eq_u32 s70, 10
    s_cselect_b32 s70, 0, s70
    v_mfma_f32_16x16x32_bf16 v[124:127], a[92:95], a[100:103], v[124:127]
    s_waitcnt vmcnt(14)
    s_waitcnt lgkmcnt(0)
    s_barrier
    s_lshl_b32 s68, s70, 19
    s_add_u32 m0, s71, 55296
    s_nop 0
    buffer_load_dwordx4 v211, s[40:43], s68 offen offset:0  lds
    v_mfma_f32_32x32x16_bf16 v[56:71], a[152:155], a[216:219], v[56:71]
    ds_read_b128 a[64:67], v215 offset:18432
    ds_read_b64_tr_b16 a[0:1], v221 offset:16384
    ds_read_b64_tr_b16 a[2:3], v221 offset:17408
    ds_read_b64_tr_b16 a[4:5], v222 offset:16384
    ds_read_b64_tr_b16 a[6:7], v222 offset:17408
    ds_read_b64_tr_b16 a[8:9], v223 offset:16384
    v_mfma_f32_32x32x16_bf16 v[72:87], a[156:159], a[216:219], v[72:87]
    ds_read_b64_tr_b16 a[10:11], v223 offset:17408
    ds_read_b64_tr_b16 a[12:13], v224 offset:16384
    ds_read_b64_tr_b16 a[14:15], v224 offset:17408
    ds_read_b128 a[68:71], v216 offset:18432
    buffer_load_dwordx4 v212, s[40:43], s68 offen offset:1024  lds
    v_mfma_f32_32x32x16_bf16 v[88:103], a[160:163], a[216:219], v[88:103]
    ds_read_b64_tr_b16 a[16:17], v221 offset:20480
    ds_read_b64_tr_b16 a[18:19], v221 offset:21504
    ds_read_b64_tr_b16 a[20:21], v222 offset:20480
    v_mfma_f32_32x32x16_bf16 v[104:119], a[164:167], a[216:219], v[104:119]
    ds_read_b64_tr_b16 a[22:23], v222 offset:21504
    ds_read_b64_tr_b16 a[24:25], v223 offset:20480
    ds_read_b64_tr_b16 a[26:27], v223 offset:21504
    buffer_load_dwordx4 v213, s[40:43], s68 offen offset:2048  lds
    v_mfma_f32_32x32x16_bf16 v[56:71], a[168:171], a[220:223], v[56:71]
    ds_read_b64_tr_b16 a[28:29], v224 offset:20480
    ds_read_b64_tr_b16 a[30:31], v224 offset:21504
    ds_read_b128 a[72:75], v217 offset:18432
    v_mfma_f32_32x32x16_bf16 v[72:87], a[172:175], a[220:223], v[72:87]
    ds_read_b64_tr_b16 a[32:33], v221 offset:24576
    ds_read_b64_tr_b16 a[34:35], v221 offset:25600
    ds_read_b64_tr_b16 a[36:37], v222 offset:24576
    buffer_load_dwordx4 v214, s[40:43], s68 offen offset:3072  lds
    v_mfma_f32_32x32x16_bf16 v[88:103], a[176:179], a[220:223], v[88:103]
    ds_read_b64_tr_b16 a[38:39], v222 offset:25600
    ds_read_b64_tr_b16 a[40:41], v223 offset:24576
    ds_read_b64_tr_b16 a[42:43], v223 offset:25600
    v_mfma_f32_32x32x16_bf16 v[104:119], a[180:183], a[220:223], v[104:119]
    s_lshl_b32 s69, s70, 7
    s_add_u32 m0, s71, 0
    ds_read_b64_tr_b16 a[44:45], v224 offset:24576
    ds_read_b64_tr_b16 a[46:47], v224 offset:25600
    ds_read_b128 a[76:79], v218 offset:18432
    buffer_load_dwordx4 v206, s[36:39], s69 offen offset:0  lds
    v_mfma_f32_32x32x16_bf16 v[56:71], a[184:187], a[224:227], v[56:71]
    ds_read_b64_tr_b16 a[48:49], v221 offset:28672
    ds_read_b64_tr_b16 a[50:51], v221 offset:29696
    ds_read_b64_tr_b16 a[52:53], v222 offset:28672
    v_mfma_f32_32x32x16_bf16 v[72:87], a[188:191], a[224:227], v[72:87]
    ds_read_b64_tr_b16 a[54:55], v222 offset:29696
    ds_read_b64_tr_b16 a[56:57], v223 offset:28672
    ds_read_b64_tr_b16 a[58:59], v223 offset:29696
    buffer_load_dwordx4 v207, s[36:39], s69 offen offset:1024  lds
    v_mfma_f32_32x32x16_bf16 v[88:103], a[192:195], a[224:227], v[88:103]
    ds_read_b64_tr_b16 a[60:61], v224 offset:28672
    ds_read_b64_tr_b16 a[62:63], v224 offset:29696
    ds_read_b128 a[96:99], v219 offset:18432
    v_mfma_f32_32x32x16_bf16 v[104:119], a[196:199], a[224:227], v[104:119]
    ds_read_b64_tr_b16 a[80:81], v225 offset:16384
    ds_read_b64_tr_b16 a[82:83], v225 offset:17408
    ds_read_b64_tr_b16 a[84:85], v226 offset:16384
    buffer_load_dwordx4 v208, s[36:39], s69 offen offset:2048  lds
    v_mfma_f32_32x32x16_bf16 v[56:71], a[200:203], a[228:231], v[56:71]
    ds_read_b64_tr_b16 a[86:87], v226 offset:17408
    ds_read_b128 a[100:103], v220 offset:18432
    ds_read_b64_tr_b16 a[88:89], v225 offset:24576
    v_mfma_f32_32x32x16_bf16 v[72:87], a[204:207], a[228:231], v[72:87]
    ds_read_b64_tr_b16 a[90:91], v225 offset:25600
    ds_read_b64_tr_b16 a[92:93], v226 offset:24576
    ds_read_b64_tr_b16 a[94:95], v226 offset:25600
    buffer_load_dwordx4 v209, s[36:39], s69 offen offset:3072  lds
    v_mfma_f32_32x32x16_bf16 v[88:103], a[208:211], a[228:231], v[88:103]
    v_mfma_f32_32x32x16_bf16 v[104:119], a[212:215], a[228:231], v[104:119]
    s_lshl_b32 s67, s20, 9
    s_add_u32 m0, s67, 16384
    s_mov_b32 exec_hi, 0
    buffer_load_dwordx4 v210, s[36:39], s69 offen  lds
    s_mov_b32 exec_hi, -1
    v_mfma_f32_16x16x32_bf16 v[120:123], a[232:235], a[248:251], v[120:123]
    v_mfma_f32_16x16x32_bf16 v[124:127], a[236:239], a[248:251], v[124:127]
    v_mfma_f32_16x16x32_bf16 v[120:123], a[240:243], a[252:255], v[120:123]
    s_add_u32 s70, s70, 1
    s_cmp_eq_u32 s70, 10
    s_cselect_b32 s70, 0, s70
    v_mfma_f32_16x16x32_bf16 v[124:127], a[244:247], a[252:255], v[124:127]
    s_waitcnt vmcnt(9)
    s_waitcnt lgkmcnt(0)
    s_barrier
    s_mov_b32 s66, 32768
    s_add_u32 m0, s71, 147456
    s_nop 0
    buffer_load_dwordx4 v200, s[28:31], s66 offen offset:0 nt lds
    v_mfma_f32_32x32x16_bf16 v[56:71], a[0:3], a[64:67], v[56:71]
    ds_read_b128 a[216:219], v215 offset:36864
    ds_read_b64_tr_b16 a[152:153], v221 offset:32768
    ds_read_b64_tr_b16 a[154:155], v221 offset:33792
    ds_read_b64_tr_b16 a[156:157], v222 offset:32768
    ds_read_b64_tr_b16 a[158:159], v222 offset:33792
    ds_read_b64_tr_b16 a[160:161], v223 offset:32768
    v_mfma_f32_32x32x16_bf16 v[72:87], a[4:7], a[64:67], v[72:87]
    ds_read_b64_tr_b16 a[162:163], v223 offset:33792
    ds_read_b64_tr_b16 a[164:165], v224 offset:32768
    ds_read_b64_tr_b16 a[166:167], v224 offset:33792
    ds_read_b128 a[220:223], v216 offset:36864
    v_mfma_f32_32x32x16_bf16 v[88:103], a[8:11], a[64:67], v[88:103]
    ds_read_b64_tr_b16 a[168:169], v221 offset:36864
    ds_read_b64_tr_b16 a[170:171], v221 offset:37888
    ds_read_b64_tr_b16 a[172:173], v222 offset:36864
    v_mfma_f32_32x32x16_bf16 v[104:119], a[12:15], a[64:67], v[104:119]
    ds_read_b64_tr_b16 a[174:175], v222 offset:37888
    ds_read_b64_tr_b16 a[176:177], v223 offset:36864
    ds_read_b64_tr_b16 a[178:179], v223 offset:37888
    buffer_load_dwordx4 v201, s[28:31], s66 offen offset:1024 nt lds
    v_mfma_f32_32x32x16_bf16 v[56:71], a[16:19], a[68:71], v[56:71]
    ds_read_b64_tr_b16 a[180:181], v224 offset:36864
    ds_read_b64_tr_b16 a[182:183], v224 offset:37888
    ds_read_b128 a[224:227], v217 offset:36864
    v_mfma_f32_32x32x16_bf16 v[72:87], a[20:23], a[68:71], v[72:87]
    ds_read_b64_tr_b16 a[184:185], v221 offset:40960
    ds_read_b64_tr_b16 a[186:187], v221 offset:41984
    ds_read_b64_tr_b16 a[188:189], v222 offset:40960
    v_mfma_f32_32x32x16_bf16 v[88:103], a[24:27], a[68:71], v[88:103]
    ds_read_b64_tr_b16 a[190:191], v222 offset:41984
    ds_read_b64_tr_b16 a[192:193], v223 offset:40960
    ds_read_b64_tr_b16 a[194:195], v223 offset:41984
    v_mfma_f32_32x32x16_bf16 v[104:119], a[28:31], a[68:71], v[104:119]
    ds_read_b64_tr_b16 a[196:197], v224 offset:40960
    ds_read_b64_tr_b16 a[198:199], v224 offset:41984
    ds_read_b128 a[228:231], v218 offset:36864
    v_mfma_f32_32x32x16_bf16 v[56:71], a[32:35], a[72:75], v[56:71]
    ds_read_b64_tr_b16 a[200:201], v221 offset:45056
    ds_read_b64_tr_b16 a[202:203], v221 offset:46080
    ds_read_b64_tr_b16 a[204:205], v222 offset:45056
    buffer_load_dwordx4 v202, s[28:31], s66 offen offset:2048 nt lds
    v_mfma_f32_32x32x16_bf16 v[72:87], a[36:39], a[72:75], v[72:87]
    ds_read_b64_tr_b16 a[206:207], v222 offset:46080
    ds_read_b64_tr_b16 a[208:209], v223 offset:45056
    ds_read_b64_tr_b16 a[210:211], v223 offset:46080
    v_mfma_f32_32x32x16_bf16 v[88:103], a[40:43], a[72:75], v[88:103]
    ds_read_b64_tr_b16 a[212:213], v224 offset:45056
    ds_read_b64_tr_b16 a[214:215], v224 offset:46080
    ds_read_b128 a[248:251], v219 offset:36864
    v_mfma_f32_32x32x16_bf16 v[104:119], a[44:47], a[72:75], v[104:119]
    ds_read_b64_tr_b16 a[232:233], v225 offset:32768
    ds_read_b64_tr_b16 a[234:235], v225 offset:33792
    ds_read_b64_tr_b16 a[236:237], v226 offset:32768
    v_mfma_f32_32x32x16_bf16 v[56:71], a[48:51], a[76:79], v[56:71]
    ds_read_b64_tr_b16 a[238:239], v226 offset:33792
    ds_read_b128 a[252:255], v220 offset:36864
    ds_read_b64_tr_b16 a[240:241], v225 offset:40960
    v_mfma_f32_32x32x16_bf16 v[72:87], a[52:55], a[76:79], v[72:87]
    ds_read_b64_tr_b16 a[242:243], v225 offset:41984
    ds_read_b64_tr_b16 a[244:245], v226 offset:40960
    ds_read_b64_tr_b16 a[246:247], v226 offset:41984
    buffer_load_dwordx4 v203, s[28:31], s66 offen offset:3072 nt lds
    v_mfma_f32_32x32x16_bf16 v[88:103], a[56:59], a[76:79], v[88:103]
    v_mfma_f32_32x32x16_bf16 v[104:119], a[60:63], a[76:79], v[104:119]
    v_mfma_f32_16x16x32_bf16 v[120:123], a[80:83], a[96:99], v[120:123]
    v_mfma_f32_16x16x32_bf16 v[124:127], a[84:87], a[96:99], v[124:127]
    v_mfma_f32_16x16x32_bf16 v[120:123], a[88:91], a[100:103], v[120:123]
    v_mfma_f32_16x16x32_bf16 v[124:127], a[92:95], a[100:103], v[124:127]
    s_waitcnt vmcnt(4)
    s_waitcnt lgkmcnt(0)
    s_barrier
    v_mfma_f32_32x32x16_bf16 v[56:71], a[152:155], a[216:219], v[56:71]
    ds_read_b128 a[64:67], v215 offset:0
    ds_read_b64_tr_b16 a[0:1], v221 offset:0
    ds_read_b64_tr_b16 a[2:3], v221 offset:1024
    ds_read_b64_tr_b16 a[4:5], v222 offset:0
    ds_read_b64_tr_b16 a[6:7], v222 offset:1024
    ds_read_b64_tr_b16 a[8:9], v223 offset:0
    v_mfma_f32_32x32x16_bf16 v[72:87], a[156:159], a[216:219], v[72:87]
    ds_read_b64_tr_b16 a[10:11], v223 offset:1024
    ds_read_b64_tr_b16 a[12:13], v224 offset:0
    ds_read_b64_tr_b16 a[14:15], v224 offset:1024
    ds_read_b128 a[68:71], v216 offset:0
    v_mfma_f32_32x32x16_bf16 v[88:103], a[160:163], a[216:219], v[88:103]
    ds_read_b64_tr_b16 a[16:17], v221 offset:4096
    ds_read_b64_tr_b16 a[18:19], v221 offset:5120
    ds_read_b64_tr_b16 a[20:21], v222 offset:4096
    v_mfma_f32_32x32x16_bf16 v[104:119], a[164:167], a[216:219], v[104:119]
    ds_read_b64_tr_b16 a[22:23], v222 offset:5120
    ds_read_b64_tr_b16 a[24:25], v223 offset:4096
    ds_read_b64_tr_b16 a[26:27], v223 offset:5120
    v_mfma_f32_32x32x16_bf16 v[56:71], a[168:171], a[220:223], v[56:71]
    ds_read_b64_tr_b16 a[28:29], v224 offset:4096
    ds_read_b64_tr_b16 a[30:31], v224 offset:5120
    ds_read_b128 a[72:75], v217 offset:0
    v_mfma_f32_32x32x16_bf16 v[72:87], a[172:175], a[220:223], v[72:87]
    ds_read_b64_tr_b16 a[32:33], v221 offset:8192
    ds_read_b64_tr_b16 a[34:35], v221 offset:9216
    ds_read_b64_tr_b16 a[36:37], v222 offset:8192
    v_mfma_f32_32x32x16_bf16 v[88:103], a[176:179], a[220:223], v[88:103]
    ds_read_b64_tr_b16 a[38:39], v222 offset:9216
    ds_read_b64_tr_b16 a[40:41], v223 offset:8192
    ds_read_b64_tr_b16 a[42:43], v223 offset:9216
    v_mfma_f32_32x32x16_bf16 v[104:119], a[180:183], a[220:223], v[104:119]
    ds_read_b64_tr_b16 a[44:45], v224 offset:8192
    ds_read_b64_tr_b16 a[46:47], v224 offset:9216
    ds_read_b128 a[76:79], v218 offset:0
    v_mfma_f32_32x32x16_bf16 v[56:71], a[184:187], a[224:227], v[56:71]
    ds_read_b64_tr_b16 a[48:49], v221 offset:12288
    ds_read_b64_tr_b16 a[50:51], v221 offset:13312
    ds_read_b64_tr_b16 a[52:53], v222 offset:12288
    v_mfma_f32_32x32x16_bf16 v[72:87], a[188:191], a[224:227], v[72:87]
    ds_read_b64_tr_b16 a[54:55], v222 offset:13312
    ds_read_b64_tr_b16 a[56:57], v223 offset:12288
    ds_read_b64_tr_b16 a[58:59], v223 offset:13312
    v_mfma_f32_32x32x16_bf16 v[88:103], a[192:195], a[224:227], v[88:103]
    ds_read_b64_tr_b16 a[60:61], v224 offset:12288
    ds_read_b64_tr_b16 a[62:63], v224 offset:13312
    ds_read_b128 a[96:99], v219 offset:0
    v_mfma_f32_32x32x16_bf16 v[104:119], a[196:199], a[224:227], v[104:119]
    ds_read_b64_tr_b16 a[80:81], v225 offset:0
    ds_read_b64_tr_b16 a[82:83], v225 offset:1024
    ds_read_b64_tr_b16 a[84:85], v226 offset:0
    v_mfma_f32_32x32x16_bf16 v[56:71], a[200:203], a[228:231], v[56:71]
    ds_read_b64_tr_b16 a[86:87], v226 offset:1024
    ds_read_b128 a[100:103], v220 offset:0
    ds_read_b64_tr_b16 a[88:89], v225 offset:8192
    v_mfma_f32_32x32x16_bf16 v[72:87], a[204:207], a[228:231], v[72:87]
    ds_read_b64_tr_b16 a[90:91], v225 offset:9216
    ds_read_b64_tr_b16 a[92:93], v226 offset:8192
    ds_read_b64_tr_b16 a[94:95], v226 offset:9216
    v_mfma_f32_32x32x16_bf16 v[88:103], a[208:211], a[228:231], v[88:103]
    v_mfma_f32_32x32x16_bf16 v[104:119], a[212:215], a[228:231], v[104:119]
    v_mfma_f32_16x16x32_bf16 v[120:123], a[232:235], a[248:251], v[120:123]
    v_mfma_f32_16x16x32_bf16 v[124:127], a[236:239], a[248:251], v[124:127]
    v_mfma_f32_16x16x32_bf16 v[120:123], a[240:243], a[252:255], v[120:123]
    v_mfma_f32_16x16x32_bf16 v[124:127], a[244:247], a[252:255], v[124:127]
    s_waitcnt lgkmcnt(7)
    v_mfma_f32_16x16x32_bf16 v[120:123], a[80:83], a[96:99], v[120:123]
    s_waitcnt lgkmcnt(5)
    v_and_b32 v2, 15, v0
    v_lshrrev_b32 v1, 4, v0
    v_mfma_f32_16x16x32_bf16 v[124:127], a[84:87], a[96:99], v[124:127]
    s_waitcnt lgkmcnt(2)
    v_mul_u32_u24 v5, 272, v2
    v_add_u32 v5, 36864, v5
    v_mfma_f32_16x16x32_bf16 v[120:123], a[88:91], a[100:103], v[120:123]
    s_waitcnt lgkmcnt(0)
    v_lshl_add_u32 v6, v1, 3, v5
    s_lshl_b32 s60, s20, 6
    v_mfma_f32_16x16x32_bf16 v[124:127], a[92:95], a[100:103], v[124:127]
    v_add_u32 v6, s60, v6
    v_lshl_add_u32 v7, v1, 4, v5
    v_mfma_f32_32x32x16_bf16 v[56:71], a[0:3], a[64:67], v[56:71]
    s_nop 0
    v_mul_f32 v120, s76, v120
    v_mul_f32 v121, s76, v121
    v_mul_f32 v122, s76, v122
    v_mul_f32 v123, s76, v123
    v_cvt_pk_bf16_f32 v240, v120, v121
    v_cvt_pk_bf16_f32 v241, v122, v123
    v_mfma_f32_32x32x16_bf16 v[56:71], a[16:19], a[68:71], v[56:71]
    v_mul_f32 v124, s76, v124
    v_mul_f32 v125, s76, v125
    v_mul_f32 v126, s76, v126
    v_mul_f32 v127, s76, v127
    v_cvt_pk_bf16_f32 v242, v124, v125
    v_cvt_pk_bf16_f32 v243, v126, v127
    v_mfma_f32_32x32x16_bf16 v[56:71], a[32:35], a[72:75], v[56:71]
    v_mfma_f32_32x32x16_bf16 v[56:71], a[48:51], a[76:79], v[56:71]
    ds_write_b64 v6, v[240:241]
    ds_write_b64 v6, v[242:243] offset:32
    v_mfma_f32_32x32x16_bf16 v[72:87], a[4:7], a[64:67], v[72:87]
    s_waitcnt lgkmcnt(0)
    s_barrier
    s_mov_b32 s66, 0
    s_add_u32 m0, s71, 65536
    s_nop 0
    buffer_load_dwordx4 v204, s[32:35], s66 offen offset:0 nt lds
    v_mfma_f32_32x32x16_bf16 v[72:87], a[20:23], a[68:71], v[72:87]
    ds_read_b128 v[40:43], v7 offset:0
    ds_read_b128 v[44:47], v7 offset:64
    ds_read_b128 v[48:51], v7 offset:128
    ds_read_b128 v[52:55], v7 offset:192
    ds_read_b128 a[96:99], v176 offset:0
    ds_read_b128 a[100:103], v177 offset:0
    v_mfma_f32_32x32x16_bf16 v[72:87], a[36:39], a[72:75], v[72:87]
    ds_read_b128 a[104:107], v178 offset:0
    ds_read_b128 a[108:111], v179 offset:0
    v_mul_f32 v56, s76, v56
    v_mul_f32 v57, s76, v57
    v_mul_f32 v58, s76, v58
    v_mul_f32 v59, s76, v59
    v_mfma_f32_32x32x16_bf16 v[72:87], a[52:55], a[76:79], v[72:87]
    buffer_load_dwordx4 v205, s[32:35], s66 offen offset:1024 nt lds
    v_mul_f32 v60, s76, v60
    v_mul_f32 v61, s76, v61
    v_mul_f32 v62, s76, v62
    v_mul_f32 v63, s76, v63
    v_cvt_pk_bf16_f32 v8, v56, v57
    v_mfma_f32_32x32x16_bf16 v[88:103], a[8:11], a[64:67], v[88:103]
    v_cvt_pk_bf16_f32 v9, v58, v59
    v_cvt_pk_bf16_f32 v10, v60, v61
    v_cvt_pk_bf16_f32 v11, v62, v63
    v_mul_f32 v64, s76, v64
    v_mul_f32 v65, s76, v65
    v_mul_f32 v66, s76, v66
    v_mfma_f32_32x32x16_bf16 v[88:103], a[24:27], a[68:71], v[88:103]
    v_mul_f32 v67, s76, v67
    v_mul_f32 v68, s76, v68
    v_mul_f32 v69, s76, v69
    v_mul_f32 v70, s76, v70
    v_mul_f32 v71, s76, v71
    v_cvt_pk_bf16_f32 v12, v64, v65
    v_mfma_f32_32x32x16_bf16 v[88:103], a[40:43], a[72:75], v[88:103]
    ds_read_b128 a[112:115], v180 offset:0
    ds_read_b128 a[116:119], v181 offset:0
    buffer_load_dwordx4 v204, s[32:35], s66 offen offset:2048 nt lds
    v_cvt_pk_bf16_f32 v13, v66, v67
    v_cvt_pk_bf16_f32 v14, v68, v69
    v_cvt_pk_bf16_f32 v15, v70, v71
    v_mfma_f32_32x32x16_bf16 v[88:103], a[56:59], a[76:79], v[88:103]
    v_mul_f32 v72, s76, v72
    v_mul_f32 v73, s76, v73
    v_mul_f32 v74, s76, v74
    v_mul_f32 v75, s76, v75
    v_mul_f32 v76, s76, v76
    v_mul_f32 v77, s76, v77
    v_mfma_f32_32x32x16_bf16 v[104:119], a[12:15], a[64:67], v[104:119]
    v_mul_f32 v78, s76, v78
    v_mul_f32 v79, s76, v79
    v_cvt_pk_bf16_f32 v16, v72, v73
    v_cvt_pk_bf16_f32 v17, v74, v75
    v_cvt_pk_bf16_f32 v18, v76, v77
    v_cvt_pk_bf16_f32 v19, v78, v79
    v_mfma_f32_32x32x16_bf16 v[104:119], a[28:31], a[68:71], v[104:119]
    v_mul_f32 v80, s76, v80
    v_mul_f32 v81, s76, v81
    v_mul_f32 v82, s76, v82
    v_mul_f32 v83, s76, v83
    v_mul_f32 v84, s76, v84
    v_mul_f32 v85, s76, v85
    v_mfma_f32_32x32x16_bf16 v[104:119], a[44:47], a[72:75], v[104:119]
    buffer_load_dwordx4 v205, s[32:35], s66 offen offset:3072 nt lds
    v_mul_f32 v86, s76, v86
    v_mul_f32 v87, s76, v87
    v_cvt_pk_bf16_f32 v20, v80, v81
    v_cvt_pk_bf16_f32 v21, v82, v83
    v_cvt_pk_bf16_f32 v22, v84, v85
    v_mfma_f32_32x32x16_bf16 v[104:119], a[60:63], a[76:79], v[104:119]
    s_waitcnt lgkmcnt(5)
    ds_read_b128 a[120:123], v182 offset:0
    ds_read_b128 a[124:127], v183 offset:0
    ds_read_b128 a[160:163], v184 offset:0
    ds_read_b128 a[164:167], v185 offset:0
    v_cvt_pk_bf16_f32 v23, v86, v87
    v_mul_f32 v88, s76, v88
    v_mfma_f32_32x32x16_bf16 v[56:71], a[96:99], v[8:11], 0
    s_waitcnt lgkmcnt(8)
    v_mul_f32 v89, s76, v89
    v_mul_f32 v90, s76, v90
    v_mul_f32 v91, s76, v91
    v_mul_f32 v92, s76, v92
    v_mul_f32 v93, s76, v93
    v_mul_f32 v94, s76, v94
    v_mfma_f32_32x32x16_bf16 v[56:71], a[100:103], v[12:15], v[56:71]
    s_waitcnt lgkmcnt(7)
    s_mov_b32 s66, 16384
    s_add_u32 m0, s71, 81920
    s_nop 0
    buffer_load_dwordx4 v204, s[32:35], s66 offen offset:0 nt lds
    v_mul_f32 v95, s76, v95
    v_cvt_pk_bf16_f32 v24, v88, v89
    v_cvt_pk_bf16_f32 v25, v90, v91
    v_cvt_pk_bf16_f32 v26, v92, v93
    v_mfma_f32_32x32x16_bf16 v[56:71], a[104:107], v[16:19], v[56:71]
    s_waitcnt lgkmcnt(6)
    v_cvt_pk_bf16_f32 v27, v94, v95
    v_mul_f32 v96, s76, v96
    v_mul_f32 v97, s76, v97
    v_mul_f32 v98, s76, v98
    v_mul_f32 v99, s76, v99
    v_mul_f32 v100, s76, v100
    v_mul_f32 v101, s76, v101
    v_mul_f32 v102, s76, v102
    v_mul_f32 v103, s76, v103
    v_cvt_pk_bf16_f32 v28, v96, v97
    v_cvt_pk_bf16_f32 v29, v98, v99
    v_cvt_pk_bf16_f32 v30, v100, v101
    v_cvt_pk_bf16_f32 v31, v102, v103
    v_mfma_f32_32x32x16_bf16 v[56:71], a[108:111], v[20:23], v[56:71]
    s_waitcnt lgkmcnt(5)
    ds_read_b128 a[168:171], v186 offset:0
    ds_read_b128 a[172:175], v187 offset:0
    v_mul_f32 v104, s76, v104
    v_mul_f32 v105, s76, v105
    v_mul_f32 v106, s76, v106
    v_mul_f32 v107, s76, v107
    v_mfma_f32_32x32x16_bf16 v[56:71], a[112:115], v[24:27], v[56:71]
    s_waitcnt lgkmcnt(6)
    buffer_load_dwordx4 v205, s[32:35], s66 offen offset:1024 nt lds
    v_mul_f32 v108, s76, v108
    v_mul_f32 v109, s76, v109
    v_mul_f32 v110, s76, v110
    v_mul_f32 v111, s76, v111
    v_cvt_pk_bf16_f32 v32, v104, v105
    v_cvt_pk_bf16_f32 v33, v106, v107
    v_cvt_pk_bf16_f32 v34, v108, v109
    v_cvt_pk_bf16_f32 v35, v110, v111
    v_mul_f32 v112, s76, v112
    v_mul_f32 v113, s76, v113
    v_mul_f32 v114, s76, v114
    v_mul_f32 v115, s76, v115
    v_mul_f32 v116, s76, v116
    v_mul_f32 v117, s76, v117
    v_mul_f32 v118, s76, v118
    v_mul_f32 v119, s76, v119
    v_cvt_pk_bf16_f32 v36, v112, v113
    v_cvt_pk_bf16_f32 v37, v114, v115
    v_cvt_pk_bf16_f32 v38, v116, v117
    v_cvt_pk_bf16_f32 v39, v118, v119
    v_mfma_f32_32x32x16_bf16 v[56:71], a[116:119], v[28:31], v[56:71]
    s_waitcnt lgkmcnt(5)
    ds_read_b128 a[128:131], v176 offset:8192
    ds_read_b128 a[132:135], v177 offset:8192
    ds_read_b128 a[136:139], v178 offset:8192
    ds_read_b128 a[140:143], v179 offset:8192
    ds_read_b128 a[144:147], v180 offset:8192
    ds_read_b128 a[148:151], v181 offset:8192
    v_mfma_f32_32x32x16_bf16 v[56:71], a[120:123], v[32:35], v[56:71]
    s_waitcnt lgkmcnt(10)
    ds_read_b128 a[152:155], v182 offset:8192
    ds_read_b128 a[156:159], v183 offset:8192
    v_mfma_f32_32x32x16_bf16 v[56:71], a[124:127], v[36:39], v[56:71]
    s_waitcnt lgkmcnt(11)
    v_mfma_f32_16x16x32_bf16 v[120:123], a[160:163], v[40:43], 0
    s_waitcnt lgkmcnt(10)
    buffer_load_dwordx4 v204, s[32:35], s66 offen offset:2048 nt lds
    v_mfma_f32_16x16x32_bf16 v[120:123], a[164:167], v[44:47], v[120:123]
    s_waitcnt lgkmcnt(9)
    v_mfma_f32_16x16x32_bf16 v[120:123], a[168:171], v[48:51], v[120:123]
    s_waitcnt lgkmcnt(8)
    v_mfma_f32_16x16x32_bf16 v[120:123], a[172:175], v[52:55], v[120:123]
    s_waitcnt lgkmcnt(7)
    buffer_load_dwordx4 v205, s[32:35], s66 offen offset:3072 nt lds
    v_mfma_f32_32x32x16_bf16 v[72:87], a[128:131], v[8:11], 0
    s_waitcnt lgkmcnt(6)
    v_mfma_f32_32x32x16_bf16 v[72:87], a[132:135], v[12:15], v[72:87]
    s_waitcnt lgkmcnt(5)
    v_mfma_f32_32x32x16_bf16 v[72:87], a[136:139], v[16:19], v[72:87]
    s_waitcnt lgkmcnt(4)
    v_max3_f32 v171, v56, v57, v58
    v_max3_f32 v173, v59, v60, v61
    v_max3_f32 v172, v120, v121, v122
    v_max3_f32 v171, v171, v62, v63
    v_max3_f32 v173, v173, v64, v65
    v_max3_f32 v171, v171, v66, v67
    v_mfma_f32_32x32x16_bf16 v[72:87], a[140:143], v[20:23], v[72:87]
    s_waitcnt lgkmcnt(3)
    v_max3_f32 v173, v173, v68, v69
    v_max3_f32 v171, v171, v70, v71
    v_mfma_f32_32x32x16_bf16 v[72:87], a[144:147], v[24:27], v[72:87]
    s_waitcnt lgkmcnt(2)
    v_mfma_f32_32x32x16_bf16 v[72:87], a[148:151], v[28:31], v[72:87]
    s_waitcnt lgkmcnt(1)
    v_mfma_f32_32x32x16_bf16 v[72:87], a[152:155], v[32:35], v[72:87]
    s_waitcnt lgkmcnt(0)
    v_mfma_f32_32x32x16_bf16 v[72:87], a[156:159], v[36:39], v[72:87]
    s_nop 11
    v_max3_f32 v173, v173, v72, v73
    v_max3_f32 v171, v171, v74, v75
    v_max3_f32 v173, v173, v76, v77
    v_max3_f32 v171, v171, v78, v79
    v_max3_f32 v173, v173, v80, v81
    v_max3_f32 v171, v171, v82, v83
    v_max3_f32 v173, v173, v84, v85
    v_max_f32 v172, v172, v123
    v_max3_f32 v171, v171, v86, v87
    v_max_f32 v171, v171, v173
    v_mov_b32 v173, v171
    v_mov_b32 v240, v172
    s_nop 0
    v_permlane32_swap_b32 v171, v173
    v_permlane32_swap_b32 v172, v240
    v_max_f32 v171, v171, v173
    v_max_f32 v172, v172, v240
    v_mov_b32 v240, v172
    s_nop 1
    v_permlane16_swap_b32 v172, v240
    v_max_f32 v172, v172, v240
    v_sub_f32 v128, 0, v171
    v_sub_f32 v144, 0, v172
    v_mov_b32 v129, v128
    v_mov_b32 v130, v128
    v_mov_b32 v131, v128
    v_mov_b32 v132, v128
    v_mov_b32 v133, v128
    v_mov_b32 v134, v128
    v_mov_b32 v135, v128
    v_mov_b32 v136, v128
    v_mov_b32 v137, v128
    v_mov_b32 v138, v128
    v_mov_b32 v139, v128
    v_mov_b32 v140, v128
    v_mov_b32 v141, v128
    v_mov_b32 v142, v128
    v_mov_b32 v143, v128
    v_mov_b32 v145, v144
    v_mov_b32 v146, v144
    v_mov_b32 v147, v144
    s_waitcnt vmcnt(4)
    s_waitcnt lgkmcnt(0)
    s_barrier
    ds_read_b128 a[96:99], v176 offset:16384
    ds_read_b128 a[100:103], v177 offset:16384
    ds_read_b128 a[104:107], v178 offset:16384
    ds_read_b128 a[108:111], v179 offset:16384
    ds_read_b128 a[112:115], v180 offset:16384
    ds_read_b128 a[116:119], v181 offset:16384
    ds_read_b128 a[120:123], v182 offset:16384
    ds_read_b128 a[124:127], v183 offset:16384
    v_sub_f32 v56, v56, v171
    v_sub_f32 v57, v57, v171
    s_waitcnt lgkmcnt(7)
    v_mfma_f32_32x32x16_bf16 v[88:103], a[96:99], v[8:11], v[128:143]
    s_waitcnt lgkmcnt(6)
    s_mov_b32 s66, 49152
    s_add_u32 m0, s71, 114688
    ds_read_b128 a[160:163], v184 offset:16384
    ds_read_b128 a[164:167], v185 offset:16384
    ds_read_b128 a[168:171], v186 offset:16384
    buffer_load_dwordx4 v200, s[28:31], s66 offen offset:0 nt lds
    v_sub_f32 v58, v58, v171
    v_mfma_f32_32x32x16_bf16 v[88:103], a[100:103], v[12:15], v[88:103]
    s_waitcnt lgkmcnt(8)
    ds_read_b128 a[172:175], v187 offset:16384
    ds_read_b128 a[128:131], v176 offset:24576
    ds_read_b128 a[132:135], v177 offset:24576
    v_sub_f32 v59, v59, v171
    v_sub_f32 v60, v60, v171
    v_sub_f32 v61, v61, v171
    v_mfma_f32_32x32x16_bf16 v[88:103], a[104:107], v[16:19], v[88:103]
    s_waitcnt lgkmcnt(10)
    ds_read_b128 a[136:139], v178 offset:24576
    ds_read_b128 a[140:143], v179 offset:24576
    v_sub_f32 v62, v62, v171
    v_sub_f32 v63, v63, v171
    v_exp_f32 v56, v56
    v_mfma_f32_32x32x16_bf16 v[88:103], a[108:111], v[20:23], v[88:103]
    s_waitcnt lgkmcnt(11)
    ds_read_b128 a[144:147], v180 offset:24576
    ds_read_b128 a[148:151], v181 offset:24576
    v_exp_f32 v57, v57
    v_exp_f32 v58, v58
    v_mfma_f32_32x32x16_bf16 v[88:103], a[112:115], v[24:27], v[88:103]
    s_waitcnt lgkmcnt(12)
    ds_read_b128 a[152:155], v182 offset:24576
    ds_read_b128 a[156:159], v183 offset:24576
    v_mov_b32 v166, v56
    v_exp_f32 v59, v59
    v_mov_b32 v167, v57
    v_mfma_f32_32x32x16_bf16 v[88:103], a[116:119], v[28:31], v[88:103]
    s_waitcnt lgkmcnt(13)
    ds_read_b64_tr_b16 a[176:177], v188 offset:0
    ds_read_b64_tr_b16 a[178:179], v188 offset:2048
    buffer_load_dwordx4 v201, s[28:31], s66 offen offset:1024 nt lds
    v_cvt_pk_bf16_f32 v148, v56, v57
    v_exp_f32 v60, v60
    v_mfma_f32_32x32x16_bf16 v[88:103], a[120:123], v[32:35], v[88:103]
    s_waitcnt lgkmcnt(14)
    ds_read_b64_tr_b16 a[180:181], v189 offset:0
    ds_read_b64_tr_b16 a[182:183], v189 offset:2048
    v_add_f32 v166, v166, v58
    v_exp_f32 v61, v61
    v_add_f32 v167, v167, v59
    v_mfma_f32_32x32x16_bf16 v[88:103], a[124:127], v[36:39], v[88:103]
    s_waitcnt lgkmcnt(14)
    ds_read_b64_tr_b16 a[184:185], v190 offset:0
    ds_read_b64_tr_b16 a[186:187], v190 offset:2048
    v_cvt_pk_bf16_f32 v149, v58, v59
    v_exp_f32 v62, v62
    v_add_f32 v166, v166, v60
    v_mfma_f32_16x16x32_bf16 v[124:127], a[160:163], v[40:43], v[144:147]
    ds_read_b64_tr_b16 a[188:189], v191 offset:0
    v_add_f32 v167, v167, v61
    v_mfma_f32_16x16x32_bf16 v[124:127], a[164:167], v[44:47], v[124:127]
    s_waitcnt lgkmcnt(14)
    ds_read_b64_tr_b16 a[190:191], v191 offset:2048
    v_cvt_pk_bf16_f32 v150, v60, v61
    v_mfma_f32_16x16x32_bf16 v[124:127], a[168:171], v[48:51], v[124:127]
    ds_read_b64_tr_b16 a[192:193], v188 offset:4096
    buffer_load_dwordx4 v202, s[28:31], s66 offen offset:2048 nt lds
    v_mfma_f32_16x16x32_bf16 v[124:127], a[172:175], v[52:55], v[124:127]
    ds_read_b64_tr_b16 a[194:195], v188 offset:6144
    v_add_f32 v166, v166, v62
    v_mfma_f32_32x32x16_bf16 v[104:119], a[128:131], v[8:11], v[128:143]
    s_waitcnt lgkmcnt(14)
    ds_read_b64_tr_b16 a[196:197], v189 offset:4096
    ds_read_b64_tr_b16 a[198:199], v189 offset:6144
    v_exp_f32 v63, v63
    v_sub_f32 v64, v64, v171
    v_add_f32 v167, v167, v63
    v_mfma_f32_32x32x16_bf16 v[104:119], a[132:135], v[12:15], v[104:119]
    ds_read_b64_tr_b16 a[200:201], v190 offset:4096
    ds_read_b64_tr_b16 a[202:203], v190 offset:6144
    v_cvt_pk_bf16_f32 v151, v62, v63
    v_sub_f32 v65, v65, v171
    v_sub_f32 v66, v66, v171
    v_sub_f32 v67, v67, v171
    v_mfma_f32_32x32x16_bf16 v[104:119], a[136:139], v[16:19], v[104:119]
    ds_read_b64_tr_b16 a[204:205], v191 offset:4096
    ds_read_b64_tr_b16 a[206:207], v191 offset:6144
    v_sub_f32 v68, v68, v171
    v_sub_f32 v69, v69, v171
    v_sub_f32 v70, v70, v171
    v_sub_f32 v71, v71, v171
    v_mfma_f32_32x32x16_bf16 v[104:119], a[140:143], v[20:23], v[104:119]
    s_waitcnt lgkmcnt(14)
    ds_read_b64_tr_b16 a[208:209], v188 offset:8192
    ds_read_b64_tr_b16 a[210:211], v188 offset:10240
    buffer_load_dwordx4 v203, s[28:31], s66 offen offset:3072 nt lds
    v_exp_f32 v64, v64
    v_mfma_f32_32x32x16_bf16 v[104:119], a[144:147], v[24:27], v[104:119]
    ds_read_b64_tr_b16 a[212:213], v189 offset:8192
    ds_read_b64_tr_b16 a[214:215], v189 offset:10240
    v_exp_f32 v65, v65
    v_exp_f32 v66, v66
    v_mfma_f32_32x32x16_bf16 v[104:119], a[148:151], v[28:31], v[104:119]
    ds_read_b64_tr_b16 a[216:217], v190 offset:8192
    ds_read_b64_tr_b16 a[218:219], v190 offset:10240
    v_add_f32 v166, v166, v64
    v_exp_f32 v67, v67
    v_add_f32 v167, v167, v65
    v_mfma_f32_32x32x16_bf16 v[104:119], a[152:155], v[32:35], v[104:119]
    ds_read_b64_tr_b16 a[220:221], v191 offset:8192
    ds_read_b64_tr_b16 a[222:223], v191 offset:10240
    v_cvt_pk_bf16_f32 v152, v64, v65
    v_exp_f32 v68, v68
    v_add_f32 v166, v166, v66
    v_mfma_f32_32x32x16_bf16 v[104:119], a[156:159], v[36:39], v[104:119]
    ds_read_b64_tr_b16 a[224:225], v188 offset:12288
    ds_read_b64_tr_b16 a[226:227], v188 offset:14336
    v_exp_f32 v69, v69
    v_add_f32 v167, v167, v67
    v_cvt_pk_bf16_f32 v153, v66, v67
    v_mfma_f32_32x32x16_bf16 a[0:15], a[176:179], v[148:151], 0
    s_waitcnt lgkmcnt(14)
    s_add_u32 s65, s23, 0
    s_and_b32 s65, s65, 7
    s_mul_i32 s65, s65, 163840
    s_add_u32 m0, s72, 0
    ds_read_b64_tr_b16 a[228:229], v189 offset:12288
    ds_read_b64_tr_b16 a[230:231], v189 offset:14336
    buffer_load_dwordx4 v227, s[44:47], s65 offen offset:0 lds
    v_exp_f32 v70, v70
    v_mfma_f32_32x32x16_bf16 a[16:31], a[180:183], v[148:151], 0
    ds_read_b64_tr_b16 a[232:233], v190 offset:12288
    ds_read_b64_tr_b16 a[234:235], v190 offset:14336
    v_add_f32 v166, v166, v68
    v_exp_f32 v71, v71
    v_add_f32 v167, v167, v69
    v_mfma_f32_32x32x16_bf16 a[32:47], a[184:187], v[148:151], 0
    ds_read_b64_tr_b16 a[236:237], v191 offset:12288
    ds_read_b64_tr_b16 a[238:239], v191 offset:14336
    v_cvt_pk_bf16_f32 v154, v68, v69
    v_add_f32 v166, v166, v70
    v_add_f32 v167, v167, v71
    v_cvt_pk_bf16_f32 v155, v70, v71
    v_mfma_f32_32x32x16_bf16 a[48:63], a[188:191], v[148:151], 0
    ds_read_b64_tr_b16 a[240:241], v192 offset:0
    ds_read_b64_tr_b16 a[242:243], v193 offset:0
    v_sub_f32 v72, v72, v171
    v_sub_f32 v73, v73, v171
    v_sub_f32 v74, v74, v171
    v_sub_f32 v75, v75, v171
    v_mfma_f32_32x32x16_bf16 a[0:15], a[192:195], v[152:155], a[0:15]
    ds_read_b64_tr_b16 a[244:245], v194 offset:0
    ds_read_b64_tr_b16 a[246:247], v195 offset:0
    v_sub_f32 v76, v76, v171
    v_sub_f32 v77, v77, v171
    v_sub_f32 v78, v78, v171
    v_sub_f32 v79, v79, v171
    v_mfma_f32_32x32x16_bf16 a[16:31], a[196:199], v[152:155], a[16:31]
    s_waitcnt lgkmcnt(14)
    s_add_u32 s65, s23, 0
    s_and_b32 s65, s65, 7
    s_mul_i32 s65, s65, 163840
    s_add_u32 m0, s72, 0
    ds_read_b64_tr_b16 a[248:249], v196 offset:0
    ds_read_b64_tr_b16 a[250:251], v197 offset:0
    buffer_load_dwordx4 v228, s[44:47], s65 offen offset:1024 lds
    v_exp_f32 v72, v72
    v_mfma_f32_32x32x16_bf16 a[32:47], a[200:203], v[152:155], a[32:47]
    ds_read_b64_tr_b16 a[252:253], v198 offset:0
    ds_read_b64_tr_b16 a[254:255], v199 offset:0
    v_exp_f32 v73, v73
    v_exp_f32 v74, v74
    v_add_f32 v166, v166, v72
    v_exp_f32 v75, v75
    v_add_f32 v167, v167, v73
    v_cvt_pk_bf16_f32 v156, v72, v73
    v_exp_f32 v76, v76
    v_add_f32 v166, v166, v74
    v_exp_f32 v77, v77
    v_add_f32 v167, v167, v75
    v_cvt_pk_bf16_f32 v157, v74, v75
    v_exp_f32 v78, v78
    v_add_f32 v166, v166, v76
    v_exp_f32 v79, v79
    v_add_f32 v167, v167, v77
    v_cvt_pk_bf16_f32 v158, v76, v77
    v_add_f32 v166, v166, v78
    v_add_f32 v167, v167, v79
    v_cvt_pk_bf16_f32 v159, v78, v79
    v_mfma_f32_32x32x16_bf16 a[48:63], a[204:207], v[152:155], a[48:63]
    v_sub_f32 v80, v80, v171
    v_sub_f32 v81, v81, v171
    v_sub_f32 v82, v82, v171
    v_sub_f32 v83, v83, v171
    v_sub_f32 v84, v84, v171
    v_sub_f32 v85, v85, v171
    v_mfma_f32_32x32x16_bf16 a[0:15], a[208:211], v[156:159], a[0:15]
    v_sub_f32 v86, v86, v171
    v_sub_f32 v87, v87, v171
    v_exp_f32 v80, v80
    v_exp_f32 v81, v81
    v_mfma_f32_32x32x16_bf16 a[16:31], a[212:215], v[156:159], a[16:31]
    v_exp_f32 v82, v82
    v_add_f32 v166, v166, v80
    v_exp_f32 v83, v83
    v_add_f32 v167, v167, v81
    v_mfma_f32_32x32x16_bf16 a[32:47], a[216:219], v[156:159], a[32:47]
    s_waitcnt lgkmcnt(14)
    v_cvt_pk_bf16_f32 v160, v80, v81
    v_exp_f32 v84, v84
    v_add_f32 v166, v166, v82
    v_exp_f32 v85, v85
    v_mfma_f32_32x32x16_bf16 a[48:63], a[220:223], v[156:159], a[48:63]
    v_add_f32 v167, v167, v83
    v_cvt_pk_bf16_f32 v161, v82, v83
    v_exp_f32 v86, v86
    v_add_f32 v166, v166, v84
    v_exp_f32 v87, v87
    v_add_f32 v167, v167, v85
    v_cvt_pk_bf16_f32 v162, v84, v85
    v_add_f32 v166, v166, v86
    v_add_f32 v167, v167, v87
    v_cvt_pk_bf16_f32 v163, v86, v87
    v_sub_f32 v120, v120, v172
    v_sub_f32 v121, v121, v172
    v_sub_f32 v122, v122, v172
    v_sub_f32 v123, v123, v172
    v_exp_f32 v120, v120
    v_exp_f32 v121, v121
    v_exp_f32 v122, v122
    v_exp_f32 v123, v123
    v_add_f32 v244, v120, v121
    v_cvt_pk_bf16_f32 v164, v120, v121
    v_add_f32 v245, v122, v123
    v_cvt_pk_bf16_f32 v165, v122, v123
    v_add_f32 v170, v244, v245
    s_waitcnt vmcnt(6)
    s_waitcnt lgkmcnt(0)
    s_barrier
    v_mfma_f32_32x32x16_bf16 a[0:15], a[224:227], v[160:163], a[0:15]
    ds_read_b128 a[96:99], v176 offset:32768
    ds_read_b128 a[100:103], v177 offset:32768
    v_max3_f32 v171, v88, v89, v90
    v_max3_f32 v173, v91, v92, v93
    v_max3_f32 v172, v124, v125, v126
    v_max3_f32 v171, v171, v94, v95
    v_mfma_f32_32x32x16_bf16 a[16:31], a[228:231], v[160:163], a[16:31]
    ds_read_b128 a[104:107], v178 offset:32768
    ds_read_b128 a[108:111], v179 offset:32768
    v_max3_f32 v173, v173, v96, v97
    v_max3_f32 v171, v171, v98, v99
    v_max3_f32 v173, v173, v100, v101
    v_max3_f32 v171, v171, v102, v103
    v_mfma_f32_32x32x16_bf16 a[32:47], a[232:235], v[160:163], a[32:47]
    ds_read_b128 a[112:115], v180 offset:32768
    ds_read_b128 a[116:119], v181 offset:32768
    v_max3_f32 v173, v173, v104, v105
    v_max3_f32 v171, v171, v106, v107
    v_max3_f32 v173, v173, v108, v109
    v_max3_f32 v171, v171, v110, v111
    v_mfma_f32_32x32x16_bf16 a[48:63], a[236:239], v[160:163], a[48:63]
    ds_read_b128 a[120:123], v182 offset:32768
    ds_read_b128 a[124:127], v183 offset:32768
    v_max3_f32 v173, v173, v112, v113
    v_max3_f32 v171, v171, v114, v115
    v_max3_f32 v173, v173, v116, v117
    v_max_f32 v172, v172, v127
    v_mfma_f32_16x16x16_bf16 a[64:67], a[240:241], v[164:165], 0
    ds_read_b128 a[160:163], v184 offset:32768
    v_max3_f32 v171, v171, v118, v119
    v_mfma_f32_16x16x16_bf16 a[68:71], a[242:243], v[164:165], 0
    ds_read_b128 a[164:167], v185 offset:32768
    v_max_f32 v171, v171, v173
    v_mfma_f32_16x16x16_bf16 a[72:75], a[244:245], v[164:165], 0
    ds_read_b128 a[168:171], v186 offset:32768
    v_max_f32 v173, v171, v172
    v_mfma_f32_16x16x16_bf16 a[76:79], a[246:247], v[164:165], 0
    ds_read_b128 a[172:175], v187 offset:32768
    v_cmp_lt_f32 vcc, s73, v173
    v_mfma_f32_16x16x16_bf16 a[80:83], a[248:249], v[164:165], 0
    ds_read_b128 a[128:131], v176 offset:40960
    v_mfma_f32_16x16x16_bf16 a[84:87], a[250:251], v[164:165], 0
    ds_read_b128 a[132:135], v177 offset:40960
    v_mfma_f32_16x16x16_bf16 a[88:91], a[252:253], v[164:165], 0
    ds_read_b128 a[136:139], v178 offset:40960
    v_mfma_f32_16x16x16_bf16 a[92:95], a[254:255], v[164:165], 0
    s_mov_b32 s66, 32768
    s_add_u32 m0, s71, 98304
    ds_read_b128 a[140:143], v179 offset:40960
    buffer_load_dwordx4 v204, s[32:35], s66 offen offset:0 nt lds
    s_cbranch_vccz L_ok_1
    s_call_b64 s[80:81], L_slow1
L_ok_1:
    s_waitcnt lgkmcnt(14)
    v_mfma_f32_32x32x16_bf16 v[56:71], a[96:99], v[8:11], v[128:143]
    ds_read_b128 a[144:147], v180 offset:40960
    ds_read_b128 a[148:151], v181 offset:40960
    v_exp_f32 v88, v88
    v_exp_f32 v89, v89
    v_mfma_f32_32x32x16_bf16 v[56:71], a[100:103], v[12:15], v[56:71]
    s_waitcnt lgkmcnt(14)
    ds_read_b128 a[152:155], v182 offset:40960
    v_exp_f32 v90, v90
    v_add_f32 v166, v166, v88
    v_exp_f32 v91, v91
    v_mfma_f32_32x32x16_bf16 v[56:71], a[104:107], v[16:19], v[56:71]
    ds_read_b128 a[156:159], v183 offset:40960
    ds_read_b64_tr_b16 a[176:177], v188 offset:16384
    buffer_load_dwordx4 v205, s[32:35], s66 offen offset:1024 nt lds
    v_add_f32 v167, v167, v89
    v_cvt_pk_bf16_f32 v148, v88, v89
    v_add_f32 v166, v166, v90
    v_mfma_f32_32x32x16_bf16 v[56:71], a[108:111], v[20:23], v[56:71]
    s_waitcnt lgkmcnt(14)
    ds_read_b64_tr_b16 a[178:179], v188 offset:18432
    v_exp_f32 v92, v92
    v_exp_f32 v93, v93
    v_add_f32 v167, v167, v91
    v_mfma_f32_32x32x16_bf16 v[56:71], a[112:115], v[24:27], v[56:71]
    ds_read_b64_tr_b16 a[180:181], v189 offset:16384
    ds_read_b64_tr_b16 a[182:183], v189 offset:18432
    v_cvt_pk_bf16_f32 v149, v90, v91
    v_exp_f32 v94, v94
    v_add_f32 v166, v166, v92
    v_mfma_f32_32x32x16_bf16 v[56:71], a[116:119], v[28:31], v[56:71]
    ds_read_b64_tr_b16 a[184:185], v190 offset:16384
    buffer_load_dwordx4 v204, s[32:35], s66 offen offset:2048 nt lds
    v_exp_f32 v95, v95
    v_add_f32 v167, v167, v93
    v_cvt_pk_bf16_f32 v150, v92, v93
    v_mfma_f32_32x32x16_bf16 v[56:71], a[120:123], v[32:35], v[56:71]
    s_waitcnt lgkmcnt(14)
    ds_read_b64_tr_b16 a[186:187], v190 offset:18432
    ds_read_b64_tr_b16 a[188:189], v191 offset:16384
    v_add_f32 v166, v166, v94
    v_add_f32 v167, v167, v95
    v_cvt_pk_bf16_f32 v151, v94, v95
    v_mfma_f32_32x32x16_bf16 v[56:71], a[124:127], v[36:39], v[56:71]
    ds_read_b64_tr_b16 a[190:191], v191 offset:18432
    v_exp_f32 v96, v96
    v_exp_f32 v97, v97
    v_add_f32 v166, v166, v96
    v_mfma_f32_16x16x32_bf16 v[120:123], a[160:163], v[40:43], v[144:147]
    ds_read_b64_tr_b16 a[192:193], v188 offset:20480
    buffer_load_dwordx4 v205, s[32:35], s66 offen offset:3072 nt lds
    v_mfma_f32_16x16x32_bf16 v[120:123], a[164:167], v[44:47], v[120:123]
    ds_read_b64_tr_b16 a[194:195], v188 offset:22528
    v_add_f32 v167, v167, v97
    v_mfma_f32_16x16x32_bf16 v[120:123], a[168:171], v[48:51], v[120:123]
    s_waitcnt lgkmcnt(14)
    ds_read_b64_tr_b16 a[196:197], v189 offset:20480
    v_cvt_pk_bf16_f32 v152, v96, v97
    v_mfma_f32_16x16x32_bf16 v[120:123], a[172:175], v[52:55], v[120:123]
    s_mov_b32 s66, 65536
    s_add_u32 m0, s71, 131072
    ds_read_b64_tr_b16 a[198:199], v189 offset:22528
    buffer_load_dwordx4 v200, s[28:31], s66 offen offset:0 nt lds
    v_mfma_f32_32x32x16_bf16 v[72:87], a[128:131], v[8:11], v[128:143]
    ds_read_b64_tr_b16 a[200:201], v190 offset:20480
    ds_read_b64_tr_b16 a[202:203], v190 offset:22528
    v_exp_f32 v98, v98
    v_exp_f32 v99, v99
    v_mfma_f32_32x32x16_bf16 v[72:87], a[132:135], v[12:15], v[72:87]
    ds_read_b64_tr_b16 a[204:205], v191 offset:20480
    v_exp_f32 v100, v100
    v_add_f32 v166, v166, v98
    v_exp_f32 v101, v101
    v_mfma_f32_32x32x16_bf16 v[72:87], a[136:139], v[16:19], v[72:87]
    ds_read_b64_tr_b16 a[206:207], v191 offset:22528
    ds_read_b64_tr_b16 a[208:209], v188 offset:24576
    buffer_load_dwordx4 v201, s[28:31], s66 offen offset:1024 nt lds
    v_add_f32 v167, v167, v99
    v_cvt_pk_bf16_f32 v153, v98, v99
    v_add_f32 v166, v166, v100
    v_mfma_f32_32x32x16_bf16 v[72:87], a[140:143], v[20:23], v[72:87]
    s_waitcnt lgkmcnt(14)
    ds_read_b64_tr_b16 a[210:211], v188 offset:26624
    v_exp_f32 v102, v102
    v_exp_f32 v103, v103
    v_add_f32 v167, v167, v101
    v_mfma_f32_32x32x16_bf16 v[72:87], a[144:147], v[24:27], v[72:87]
    ds_read_b64_tr_b16 a[212:213], v189 offset:24576
    ds_read_b64_tr_b16 a[214:215], v189 offset:26624
    v_cvt_pk_bf16_f32 v154, v100, v101
    v_add_f32 v166, v166, v102
    v_add_f32 v167, v167, v103
    v_cvt_pk_bf16_f32 v155, v102, v103
    v_mfma_f32_32x32x16_bf16 v[72:87], a[148:151], v[28:31], v[72:87]
    ds_read_b64_tr_b16 a[216:217], v190 offset:24576
    buffer_load_dwordx4 v202, s[28:31], s66 offen offset:2048 nt lds
    v_exp_f32 v104, v104
    v_exp_f32 v105, v105
    v_mfma_f32_32x32x16_bf16 v[72:87], a[152:155], v[32:35], v[72:87]
    ds_read_b64_tr_b16 a[218:219], v190 offset:26624
    ds_read_b64_tr_b16 a[220:221], v191 offset:24576
    v_exp_f32 v106, v106
    v_add_f32 v166, v166, v104
    v_add_f32 v167, v167, v105
    v_mfma_f32_32x32x16_bf16 v[72:87], a[156:159], v[36:39], v[72:87]
    ds_read_b64_tr_b16 a[222:223], v191 offset:26624
    v_exp_f32 v107, v107
    v_cvt_pk_bf16_f32 v156, v104, v105
    v_exp_f32 v108, v108
    v_mfma_f32_32x32x16_bf16 a[0:15], a[176:179], v[148:151], a[0:15]
    s_waitcnt lgkmcnt(14)
    ds_read_b64_tr_b16 a[224:225], v188 offset:28672
    ds_read_b64_tr_b16 a[226:227], v188 offset:30720
    buffer_load_dwordx4 v203, s[28:31], s66 offen offset:3072 nt lds
    v_add_f32 v166, v166, v106
    v_exp_f32 v109, v109
    v_mfma_f32_32x32x16_bf16 a[16:31], a[180:183], v[148:151], a[16:31]
    ds_read_b64_tr_b16 a[228:229], v189 offset:28672
    ds_read_b64_tr_b16 a[230:231], v189 offset:30720
    v_add_f32 v167, v167, v107
    v_cvt_pk_bf16_f32 v157, v106, v107
    v_exp_f32 v110, v110
    v_mfma_f32_32x32x16_bf16 a[32:47], a[184:187], v[148:151], a[32:47]
    ds_read_b64_tr_b16 a[232:233], v190 offset:28672
    ds_read_b64_tr_b16 a[234:235], v190 offset:30720
    v_add_f32 v166, v166, v108
    v_exp_f32 v111, v111
    v_add_f32 v167, v167, v109
    v_mfma_f32_32x32x16_bf16 a[48:63], a[188:191], v[148:151], a[48:63]
    s_add_u32 s65, s23, 0
    s_and_b32 s65, s65, 7
    s_mul_i32 s65, s65, 163840
    s_add_u32 m0, s72, 0
    ds_read_b64_tr_b16 a[236:237], v191 offset:28672
    ds_read_b64_tr_b16 a[238:239], v191 offset:30720
    buffer_load_dwordx4 v229, s[44:47], s65 offen offset:2048 lds
    v_cvt_pk_bf16_f32 v158, v108, v109
    v_add_f32 v166, v166, v110
    v_mfma_f32_32x32x16_bf16 a[0:15], a[192:195], v[152:155], a[0:15]
    s_waitcnt lgkmcnt(14)
    ds_read_b64_tr_b16 a[240:241], v192 offset:16384
    ds_read_b64_tr_b16 a[242:243], v193 offset:16384
    v_add_f32 v167, v167, v111
    v_cvt_pk_bf16_f32 v159, v110, v111
    v_exp_f32 v112, v112
    v_mfma_f32_32x32x16_bf16 a[16:31], a[196:199], v[152:155], a[16:31]
    ds_read_b64_tr_b16 a[244:245], v194 offset:16384
    ds_read_b64_tr_b16 a[246:247], v195 offset:16384
    v_exp_f32 v113, v113
    v_exp_f32 v114, v114
    v_mfma_f32_32x32x16_bf16 a[32:47], a[200:203], v[152:155], a[32:47]
    s_add_u32 s65, s23, 0
    s_and_b32 s65, s65, 7
    s_mul_i32 s65, s65, 163840
    s_add_u32 m0, s72, 0
    ds_read_b64_tr_b16 a[248:249], v196 offset:16384
    ds_read_b64_tr_b16 a[250:251], v197 offset:16384
    buffer_load_dwordx4 v230, s[44:47], s65 offen offset:3072 lds
    v_add_f32 v166, v166, v112
    v_add_f32 v167, v167, v113
    v_mfma_f32_32x32x16_bf16 a[48:63], a[204:207], v[152:155], a[48:63]
    ds_read_b64_tr_b16 a[252:253], v198 offset:16384
    ds_read_b64_tr_b16 a[254:255], v199 offset:16384
    v_exp_f32 v115, v115
    v_cvt_pk_bf16_f32 v160, v112, v113
    v_add_f32 v166, v166, v114
    v_mfma_f32_32x32x16_bf16 a[0:15], a[208:211], v[156:159], a[0:15]
    s_waitcnt lgkmcnt(14)
    v_exp_f32 v116, v116
    v_exp_f32 v117, v117
    v_add_f32 v167, v167, v115
    v_cvt_pk_bf16_f32 v161, v114, v115
    v_mfma_f32_32x32x16_bf16 a[16:31], a[212:215], v[156:159], a[16:31]
    v_exp_f32 v118, v118
    v_add_f32 v166, v166, v116
    v_exp_f32 v119, v119
    v_add_f32 v167, v167, v117
    v_mfma_f32_32x32x16_bf16 a[32:47], a[216:219], v[156:159], a[32:47]
    v_cvt_pk_bf16_f32 v162, v116, v117
    v_add_f32 v166, v166, v118
    v_add_f32 v167, v167, v119
    v_cvt_pk_bf16_f32 v163, v118, v119
    v_exp_f32 v124, v124
    v_mfma_f32_32x32x16_bf16 a[48:63], a[220:223], v[156:159], a[48:63]
    v_exp_f32 v125, v125
    v_exp_f32 v126, v126
    v_exp_f32 v127, v127
    v_add_f32 v244, v124, v125
    v_cvt_pk_bf16_f32 v164, v124, v125
    v_add_f32 v245, v126, v127
    v_cvt_pk_bf16_f32 v165, v126, v127
    v_add_f32 v244, v244, v245
    v_add_f32 v170, v170, v244
    s_waitcnt vmcnt(6)
    s_waitcnt lgkmcnt(0)
    s_barrier
    v_mfma_f32_32x32x16_bf16 a[0:15], a[224:227], v[160:163], a[0:15]
    ds_read_b128 a[96:99], v176 offset:0
    ds_read_b128 a[100:103], v177 offset:0
    v_max3_f32 v171, v56, v57, v58
    v_max3_f32 v173, v59, v60, v61
    v_max3_f32 v172, v120, v121, v122
    v_max3_f32 v171, v171, v62, v63
    v_mfma_f32_32x32x16_bf16 a[16:31], a[228:231], v[160:163], a[16:31]
    ds_read_b128 a[104:107], v178 offset:0
    ds_read_b128 a[108:111], v179 offset:0
    v_max3_f32 v173, v173, v64, v65
    v_max3_f32 v171, v171, v66, v67
    v_max3_f32 v173, v173, v68, v69
    v_max3_f32 v171, v171, v70, v71
    v_mfma_f32_32x32x16_bf16 a[32:47], a[232:235], v[160:163], a[32:47]
    ds_read_b128 a[112:115], v180 offset:0
    ds_read_b128 a[116:119], v181 offset:0
    v_max3_f32 v173, v173, v72, v73
    v_max3_f32 v171, v171, v74, v75
    v_max3_f32 v173, v173, v76, v77
    v_max3_f32 v171, v171, v78, v79
    v_mfma_f32_32x32x16_bf16 a[48:63], a[236:239], v[160:163], a[48:63]
    ds_read_b128 a[120:123], v182 offset:0
    ds_read_b128 a[124:127], v183 offset:0
    v_max3_f32 v173, v173, v80, v81
    v_max3_f32 v171, v171, v82, v83
    v_max3_f32 v173, v173, v84, v85
    v_max_f32 v172, v172, v123
    v_mfma_f32_16x16x16_bf16 a[64:67], a[240:241], v[164:165], a[64:67]
    ds_read_b128 a[160:163], v184 offset:0
    v_max3_f32 v171, v171, v86, v87
    v_mfma_f32_16x16x16_bf16 a[68:71], a[242:243], v[164:165], a[68:71]
    ds_read_b128 a[164:167], v185 offset:0
    v_max_f32 v171, v171, v173
    v_mfma_f32_16x16x16_bf16 a[72:75], a[244:245], v[164:165], a[72:75]
    ds_read_b128 a[168:171], v186 offset:0
    v_max_f32 v173, v171, v172
    v_mfma_f32_16x16x16_bf16 a[76:79], a[246:247], v[164:165], a[76:79]
    ds_read_b128 a[172:175], v187 offset:0
    v_cmp_lt_f32 vcc, s73, v173
    v_mfma_f32_16x16x16_bf16 a[80:83], a[248:249], v[164:165], a[80:83]
    ds_read_b128 a[128:131], v176 offset:8192
    v_mfma_f32_16x16x16_bf16 a[84:87], a[250:251], v[164:165], a[84:87]
    ds_read_b128 a[132:135], v177 offset:8192
    v_mfma_f32_16x16x16_bf16 a[88:91], a[252:253], v[164:165], a[88:91]
    ds_read_b128 a[136:139], v178 offset:8192
    v_mfma_f32_16x16x16_bf16 a[92:95], a[254:255], v[164:165], a[92:95]
    s_mov_b32 s66, 49152
    s_add_u32 m0, s71, 65536
    ds_read_b128 a[140:143], v179 offset:8192
    buffer_load_dwordx4 v204, s[32:35], s66 offen offset:0 nt lds
    s_cbranch_vccz L_ok_2
    s_call_b64 s[80:81], L_slow0
L_ok_2:
    s_waitcnt lgkmcnt(14)
    v_mfma_f32_32x32x16_bf16 v[88:103], a[96:99], v[8:11], v[128:143]
    ds_read_b128 a[144:147], v180 offset:8192
    ds_read_b128 a[148:151], v181 offset:8192
    v_exp_f32 v56, v56
    v_exp_f32 v57, v57
    v_mfma_f32_32x32x16_bf16 v[88:103], a[100:103], v[12:15], v[88:103]
    s_waitcnt lgkmcnt(14)
    ds_read_b128 a[152:155], v182 offset:8192
    v_exp_f32 v58, v58
    v_add_f32 v166, v166, v56
    v_exp_f32 v59, v59
    v_mfma_f32_32x32x16_bf16 v[88:103], a[104:107], v[16:19], v[88:103]
    ds_read_b128 a[156:159], v183 offset:8192
    ds_read_b64_tr_b16 a[176:177], v188 offset:32768
    buffer_load_dwordx4 v205, s[32:35], s66 offen offset:1024 nt lds
    v_add_f32 v167, v167, v57
    v_cvt_pk_bf16_f32 v148, v56, v57
    v_add_f32 v166, v166, v58
    v_mfma_f32_32x32x16_bf16 v[88:103], a[108:111], v[20:23], v[88:103]
    s_waitcnt lgkmcnt(14)
    ds_read_b64_tr_b16 a[178:179], v188 offset:34816
    v_exp_f32 v60, v60
    v_exp_f32 v61, v61
    v_add_f32 v167, v167, v59
    v_mfma_f32_32x32x16_bf16 v[88:103], a[112:115], v[24:27], v[88:103]
    ds_read_b64_tr_b16 a[180:181], v189 offset:32768
    ds_read_b64_tr_b16 a[182:183], v189 offset:34816
    v_cvt_pk_bf16_f32 v149, v58, v59
    v_exp_f32 v62, v62
    v_add_f32 v166, v166, v60
    v_mfma_f32_32x32x16_bf16 v[88:103], a[116:119], v[28:31], v[88:103]
    ds_read_b64_tr_b16 a[184:185], v190 offset:32768
    buffer_load_dwordx4 v204, s[32:35], s66 offen offset:2048 nt lds
    v_exp_f32 v63, v63
    v_add_f32 v167, v167, v61
    v_cvt_pk_bf16_f32 v150, v60, v61
    v_mfma_f32_32x32x16_bf16 v[88:103], a[120:123], v[32:35], v[88:103]
    s_waitcnt lgkmcnt(14)
    ds_read_b64_tr_b16 a[186:187], v190 offset:34816
    ds_read_b64_tr_b16 a[188:189], v191 offset:32768
    v_add_f32 v166, v166, v62
    v_add_f32 v167, v167, v63
    v_cvt_pk_bf16_f32 v151, v62, v63
    v_mfma_f32_32x32x16_bf16 v[88:103], a[124:127], v[36:39], v[88:103]
    ds_read_b64_tr_b16 a[190:191], v191 offset:34816
    v_exp_f32 v64, v64
    v_exp_f32 v65, v65
    v_add_f32 v166, v166, v64
    v_mfma_f32_16x16x32_bf16 v[124:127], a[160:163], v[40:43], v[144:147]
    ds_read_b64_tr_b16 a[192:193], v188 offset:36864
    buffer_load_dwordx4 v205, s[32:35], s66 offen offset:3072 nt lds
    v_mfma_f32_16x16x32_bf16 v[124:127], a[164:167], v[44:47], v[124:127]
    ds_read_b64_tr_b16 a[194:195], v188 offset:38912
    v_add_f32 v167, v167, v65
    v_mfma_f32_16x16x32_bf16 v[124:127], a[168:171], v[48:51], v[124:127]
    s_waitcnt lgkmcnt(14)
    ds_read_b64_tr_b16 a[196:197], v189 offset:36864
    v_cvt_pk_bf16_f32 v152, v64, v65
    v_mfma_f32_16x16x32_bf16 v[124:127], a[172:175], v[52:55], v[124:127]
    s_mov_b32 s66, 81920
    s_add_u32 m0, s71, 147456
    ds_read_b64_tr_b16 a[198:199], v189 offset:38912
    buffer_load_dwordx4 v200, s[28:31], s66 offen offset:0 nt lds
    v_mfma_f32_32x32x16_bf16 v[104:119], a[128:131], v[8:11], v[128:143]
    ds_read_b64_tr_b16 a[200:201], v190 offset:36864
    ds_read_b64_tr_b16 a[202:203], v190 offset:38912
    v_exp_f32 v66, v66
    v_exp_f32 v67, v67
    v_mfma_f32_32x32x16_bf16 v[104:119], a[132:135], v[12:15], v[104:119]
    ds_read_b64_tr_b16 a[204:205], v191 offset:36864
    v_exp_f32 v68, v68
    v_add_f32 v166, v166, v66
    v_exp_f32 v69, v69
    v_mfma_f32_32x32x16_bf16 v[104:119], a[136:139], v[16:19], v[104:119]
    ds_read_b64_tr_b16 a[206:207], v191 offset:38912
    ds_read_b64_tr_b16 a[208:209], v188 offset:40960
    buffer_load_dwordx4 v201, s[28:31], s66 offen offset:1024 nt lds
    v_add_f32 v167, v167, v67
    v_cvt_pk_bf16_f32 v153, v66, v67
    v_add_f32 v166, v166, v68
    v_mfma_f32_32x32x16_bf16 v[104:119], a[140:143], v[20:23], v[104:119]
    s_waitcnt lgkmcnt(14)
    ds_read_b64_tr_b16 a[210:211], v188 offset:43008
    v_exp_f32 v70, v70
    v_exp_f32 v71, v71
    v_add_f32 v167, v167, v69
    v_mfma_f32_32x32x16_bf16 v[104:119], a[144:147], v[24:27], v[104:119]
    ds_read_b64_tr_b16 a[212:213], v189 offset:40960
    ds_read_b64_tr_b16 a[214:215], v189 offset:43008
    v_cvt_pk_bf16_f32 v154, v68, v69
    v_add_f32 v166, v166, v70
    v_add_f32 v167, v167, v71
    v_cvt_pk_bf16_f32 v155, v70, v71
    v_mfma_f32_32x32x16_bf16 v[104:119], a[148:151], v[28:31], v[104:119]
    ds_read_b64_tr_b16 a[216:217], v190 offset:40960
    buffer_load_dwordx4 v202, s[28:31], s66 offen offset:2048 nt lds
    v_exp_f32 v72, v72
    v_exp_f32 v73, v73
    v_mfma_f32_32x32x16_bf16 v[104:119], a[152:155], v[32:35], v[104:119]
    ds_read_b64_tr_b16 a[218:219], v190 offset:43008
    ds_read_b64_tr_b16 a[220:221], v191 offset:40960
    v_exp_f32 v74, v74
    v_add_f32 v166, v166, v72
    v_add_f32 v167, v167, v73
    v_mfma_f32_32x32x16_bf16 v[104:119], a[156:159], v[36:39], v[104:119]
    ds_read_b64_tr_b16 a[222:223], v191 offset:43008
    v_exp_f32 v75, v75
    v_cvt_pk_bf16_f32 v156, v72, v73
    v_exp_f32 v76, v76
    v_mfma_f32_32x32x16_bf16 a[0:15], a[176:179], v[148:151], a[0:15]
    s_waitcnt lgkmcnt(14)
    ds_read_b64_tr_b16 a[224:225], v188 offset:45056
    ds_read_b64_tr_b16 a[226:227], v188 offset:47104
    buffer_load_dwordx4 v203, s[28:31], s66 offen offset:3072 nt lds
    v_add_f32 v166, v166, v74
    v_exp_f32 v77, v77
    v_mfma_f32_32x32x16_bf16 a[16:31], a[180:183], v[148:151], a[16:31]
    ds_read_b64_tr_b16 a[228:229], v189 offset:45056
    ds_read_b64_tr_b16 a[230:231], v189 offset:47104
    v_add_f32 v167, v167, v75
    v_cvt_pk_bf16_f32 v157, v74, v75
    v_exp_f32 v78, v78
    v_mfma_f32_32x32x16_bf16 a[32:47], a[184:187], v[148:151], a[32:47]
    ds_read_b64_tr_b16 a[232:233], v190 offset:45056
    ds_read_b64_tr_b16 a[234:235], v190 offset:47104
    v_add_f32 v166, v166, v76
    v_exp_f32 v79, v79
    v_add_f32 v167, v167, v77
    v_mfma_f32_32x32x16_bf16 a[48:63], a[188:191], v[148:151], a[48:63]
    s_add_u32 s65, s23, 0
    s_and_b32 s65, s65, 7
    s_mul_i32 s65, s65, 163840
    s_add_u32 m0, s72, 4096
    ds_read_b64_tr_b16 a[236:237], v191 offset:45056
    ds_read_b64_tr_b16 a[238:239], v191 offset:47104
    buffer_load_dwordx4 v231, s[44:47], s65 offen offset:0 lds
    v_cvt_pk_bf16_f32 v158, v76, v77
    v_add_f32 v166, v166, v78
    v_mfma_f32_32x32x16_bf16 a[0:15], a[192:195], v[152:155], a[0:15]
    s_waitcnt lgkmcnt(14)
    ds_read_b64_tr_b16 a[240:241], v192 offset:32768
    ds_read_b64_tr_b16 a[242:243], v193 offset:32768
    v_add_f32 v167, v167, v79
    v_cvt_pk_bf16_f32 v159, v78, v79
    v_exp_f32 v80, v80
    v_mfma_f32_32x32x16_bf16 a[16:31], a[196:199], v[152:155], a[16:31]
    ds_read_b64_tr_b16 a[244:245], v194 offset:32768
    ds_read_b64_tr_b16 a[246:247], v195 offset:32768
    v_exp_f32 v81, v81
    v_exp_f32 v82, v82
    v_mfma_f32_32x32x16_bf16 a[32:47], a[200:203], v[152:155], a[32:47]
    s_add_u32 s65, s23, 1
    s_and_b32 s65, s65, 7
    s_mul_i32 s65, s65, 163840
    s_add_u32 m0, s72, 20480
    ds_read_b64_tr_b16 a[248:249], v196 offset:32768
    ds_read_b64_tr_b16 a[250:251], v197 offset:32768
    buffer_load_dwordx4 v227, s[44:47], s65 offen offset:0 lds
    v_add_f32 v166, v166, v80
    v_add_f32 v167, v167, v81
    v_mfma_f32_32x32x16_bf16 a[48:63], a[204:207], v[152:155], a[48:63]
    ds_read_b64_tr_b16 a[252:253], v198 offset:32768
    ds_read_b64_tr_b16 a[254:255], v199 offset:32768
    v_exp_f32 v83, v83
    v_cvt_pk_bf16_f32 v160, v80, v81
    v_add_f32 v166, v166, v82
    v_mfma_f32_32x32x16_bf16 a[0:15], a[208:211], v[156:159], a[0:15]
    s_waitcnt lgkmcnt(14)
    v_exp_f32 v84, v84
    v_exp_f32 v85, v85
    v_add_f32 v167, v167, v83
    v_cvt_pk_bf16_f32 v161, v82, v83
    v_mfma_f32_32x32x16_bf16 a[16:31], a[212:215], v[156:159], a[16:31]
    v_exp_f32 v86, v86
    v_add_f32 v166, v166, v84
    v_exp_f32 v87, v87
    v_add_f32 v167, v167, v85
    v_mfma_f32_32x32x16_bf16 a[32:47], a[216:219], v[156:159], a[32:47]
    v_cvt_pk_bf16_f32 v162, v84, v85
    v_add_f32 v166, v166, v86
    v_add_f32 v167, v167, v87
    v_cvt_pk_bf16_f32 v163, v86, v87
    v_exp_f32 v120, v120
    v_mfma_f32_32x32x16_bf16 a[48:63], a[220:223], v[156:159], a[48:63]
    v_exp_f32 v121, v121
    v_exp_f32 v122, v122
    v_exp_f32 v123, v123
    v_add_f32 v244, v120, v121
    v_cvt_pk_bf16_f32 v164, v120, v121
    v_add_f32 v245, v122, v123
    v_cvt_pk_bf16_f32 v165, v122, v123
    v_add_f32 v244, v244, v245
    v_add_f32 v170, v170, v244
    s_waitcnt vmcnt(6)
    s_waitcnt lgkmcnt(0)
    s_barrier
    v_mfma_f32_32x32x16_bf16 a[0:15], a[224:227], v[160:163], a[0:15]
    ds_read_b128 a[96:99], v176 offset:16384
    ds_read_b128 a[100:103], v177 offset:16384
    v_max3_f32 v171, v88, v89, v90
    v_max3_f32 v173, v91, v92, v93
    v_max3_f32 v172, v124, v125, v126
    v_max3_f32 v171, v171, v94, v95
    v_mfma_f32_32x32x16_bf16 a[16:31], a[228:231], v[160:163], a[16:31]
    ds_read_b128 a[104:107], v178 offset:16384
    ds_read_b128 a[108:111], v179 offset:16384
    v_max3_f32 v173, v173, v96, v97
    v_max3_f32 v171, v171, v98, v99
    v_max3_f32 v173, v173, v100, v101
    v_max3_f32 v171, v171, v102, v103
    v_mfma_f32_32x32x16_bf16 a[32:47], a[232:235], v[160:163], a[32:47]
    ds_read_b128 a[112:115], v180 offset:16384
    ds_read_b128 a[116:119], v181 offset:16384
    v_max3_f32 v173, v173, v104, v105
    v_max3_f32 v171, v171, v106, v107
    v_max3_f32 v173, v173, v108, v109
    v_max3_f32 v171, v171, v110, v111
    v_mfma_f32_32x32x16_bf16 a[48:63], a[236:239], v[160:163], a[48:63]
    ds_read_b128 a[120:123], v182 offset:16384
    ds_read_b128 a[124:127], v183 offset:16384
    v_max3_f32 v173, v173, v112, v113
    v_max3_f32 v171, v171, v114, v115
    v_max3_f32 v173, v173, v116, v117
    v_max_f32 v172, v172, v127
    v_mfma_f32_16x16x16_bf16 a[64:67], a[240:241], v[164:165], a[64:67]
    ds_read_b128 a[160:163], v184 offset:16384
    v_max3_f32 v171, v171, v118, v119
    v_mfma_f32_16x16x16_bf16 a[68:71], a[242:243], v[164:165], a[68:71]
    ds_read_b128 a[164:167], v185 offset:16384
    v_max_f32 v171, v171, v173
    v_mfma_f32_16x16x16_bf16 a[72:75], a[244:245], v[164:165], a[72:75]
    ds_read_b128 a[168:171], v186 offset:16384
    v_max_f32 v173, v171, v172
    v_mfma_f32_16x16x16_bf16 a[76:79], a[246:247], v[164:165], a[76:79]
    ds_read_b128 a[172:175], v187 offset:16384
    v_cmp_lt_f32 vcc, s73, v173
    v_mfma_f32_16x16x16_bf16 a[80:83], a[248:249], v[164:165], a[80:83]
    ds_read_b128 a[128:131], v176 offset:24576
    v_mfma_f32_16x16x16_bf16 a[84:87], a[250:251], v[164:165], a[84:87]
    ds_read_b128 a[132:135], v177 offset:24576
    v_mfma_f32_16x16x16_bf16 a[88:91], a[252:253], v[164:165], a[88:91]
    ds_read_b128 a[136:139], v178 offset:24576
    v_mfma_f32_16x16x16_bf16 a[92:95], a[254:255], v[164:165], a[92:95]
    s_mov_b32 s66, 65536
    s_add_u32 m0, s71, 81920
    ds_read_b128 a[140:143], v179 offset:24576
    buffer_load_dwordx4 v204, s[32:35], s66 offen offset:0 nt lds
    s_cbranch_vccz L_ok_3
    s_call_b64 s[80:81], L_slow1
L_ok_3:
    s_waitcnt lgkmcnt(14)
    v_mfma_f32_32x32x16_bf16 v[56:71], a[96:99], v[8:11], v[128:143]
    ds_read_b128 a[144:147], v180 offset:24576
    ds_read_b128 a[148:151], v181 offset:24576
    v_exp_f32 v88, v88
    v_exp_f32 v89, v89
    v_mfma_f32_32x32x16_bf16 v[56:71], a[100:103], v[12:15], v[56:71]
    s_waitcnt lgkmcnt(14)
    ds_read_b128 a[152:155], v182 offset:24576
    buffer_load_dwordx4 v205, s[32:35], s66 offen offset:1024 nt lds
    v_exp_f32 v90, v90
    v_add_f32 v166, v166, v88
    v_add_f32 v167, v167, v89
    v_mfma_f32_32x32x16_bf16 v[56:71], a[104:107], v[16:19], v[56:71]
    ds_read_b128 a[156:159], v183 offset:24576
    ds_read_b64_tr_b16 a[176:177], v188 offset:0
    v_exp_f32 v91, v91
    v_cvt_pk_bf16_f32 v148, v88, v89
    v_add_f32 v166, v166, v90
    v_mfma_f32_32x32x16_bf16 v[56:71], a[108:111], v[20:23], v[56:71]
    s_waitcnt lgkmcnt(14)
    ds_read_b64_tr_b16 a[178:179], v188 offset:2048
    buffer_load_dwordx4 v204, s[32:35], s66 offen offset:2048 nt lds
    v_exp_f32 v92, v92
    v_exp_f32 v93, v93
    v_mfma_f32_32x32x16_bf16 v[56:71], a[112:115], v[24:27], v[56:71]
    ds_read_b64_tr_b16 a[180:181], v189 offset:0
    ds_read_b64_tr_b16 a[182:183], v189 offset:2048
    v_add_f32 v167, v167, v91
    v_cvt_pk_bf16_f32 v149, v90, v91
    v_exp_f32 v94, v94
    v_mfma_f32_32x32x16_bf16 v[56:71], a[116:119], v[28:31], v[56:71]
    ds_read_b64_tr_b16 a[184:185], v190 offset:0
    v_add_f32 v166, v166, v92
    v_exp_f32 v95, v95
    v_add_f32 v167, v167, v93
    v_cvt_pk_bf16_f32 v150, v92, v93
    v_mfma_f32_32x32x16_bf16 v[56:71], a[120:123], v[32:35], v[56:71]
    s_waitcnt lgkmcnt(14)
    ds_read_b64_tr_b16 a[186:187], v190 offset:2048
    ds_read_b64_tr_b16 a[188:189], v191 offset:0
    buffer_load_dwordx4 v205, s[32:35], s66 offen offset:3072 nt lds
    v_add_f32 v166, v166, v94
    v_add_f32 v167, v167, v95
    v_cvt_pk_bf16_f32 v151, v94, v95
    v_mfma_f32_32x32x16_bf16 v[56:71], a[124:127], v[36:39], v[56:71]
    ds_read_b64_tr_b16 a[190:191], v191 offset:2048
    v_exp_f32 v96, v96
    v_exp_f32 v97, v97
    v_add_f32 v166, v166, v96
    v_mfma_f32_16x16x32_bf16 v[120:123], a[160:163], v[40:43], v[144:147]
    s_mov_b32 s66, 98304
    s_add_u32 m0, s71, 114688
    ds_read_b64_tr_b16 a[192:193], v188 offset:4096
    buffer_load_dwordx4 v200, s[28:31], s66 offen offset:0 nt lds
    v_mfma_f32_16x16x32_bf16 v[120:123], a[164:167], v[44:47], v[120:123]
    ds_read_b64_tr_b16 a[194:195], v188 offset:6144
    v_add_f32 v167, v167, v97
    v_mfma_f32_16x16x32_bf16 v[120:123], a[168:171], v[48:51], v[120:123]
    s_waitcnt lgkmcnt(14)
    ds_read_b64_tr_b16 a[196:197], v189 offset:4096
    buffer_load_dwordx4 v201, s[28:31], s66 offen offset:1024 nt lds
    v_mfma_f32_16x16x32_bf16 v[120:123], a[172:175], v[52:55], v[120:123]
    ds_read_b64_tr_b16 a[198:199], v189 offset:6144
    v_cvt_pk_bf16_f32 v152, v96, v97
    v_mfma_f32_32x32x16_bf16 v[72:87], a[128:131], v[8:11], v[128:143]
    ds_read_b64_tr_b16 a[200:201], v190 offset:4096
    ds_read_b64_tr_b16 a[202:203], v190 offset:6144
    v_exp_f32 v98, v98
    v_exp_f32 v99, v99
    v_mfma_f32_32x32x16_bf16 v[72:87], a[132:135], v[12:15], v[72:87]
    ds_read_b64_tr_b16 a[204:205], v191 offset:4096
    buffer_load_dwordx4 v202, s[28:31], s66 offen offset:2048 nt lds
    v_exp_f32 v100, v100
    v_add_f32 v166, v166, v98
    v_add_f32 v167, v167, v99
    v_mfma_f32_32x32x16_bf16 v[72:87], a[136:139], v[16:19], v[72:87]
    ds_read_b64_tr_b16 a[206:207], v191 offset:6144
    ds_read_b64_tr_b16 a[208:209], v188 offset:8192
    v_exp_f32 v101, v101
    v_cvt_pk_bf16_f32 v153, v98, v99
    v_add_f32 v166, v166, v100
    v_mfma_f32_32x32x16_bf16 v[72:87], a[140:143], v[20:23], v[72:87]
    s_waitcnt lgkmcnt(14)
    ds_read_b64_tr_b16 a[210:211], v188 offset:10240
    buffer_load_dwordx4 v203, s[28:31], s66 offen offset:3072 nt lds
    v_exp_f32 v102, v102
    v_exp_f32 v103, v103
    v_mfma_f32_32x32x16_bf16 v[72:87], a[144:147], v[24:27], v[72:87]
    ds_read_b64_tr_b16 a[212:213], v189 offset:8192
    ds_read_b64_tr_b16 a[214:215], v189 offset:10240
    v_add_f32 v167, v167, v101
    v_cvt_pk_bf16_f32 v154, v100, v101
    v_add_f32 v166, v166, v102
    v_add_f32 v167, v167, v103
    v_mfma_f32_32x32x16_bf16 v[72:87], a[148:151], v[28:31], v[72:87]
    ds_read_b64_tr_b16 a[216:217], v190 offset:8192
    v_cvt_pk_bf16_f32 v155, v102, v103
    v_exp_f32 v104, v104
    v_exp_f32 v105, v105
    v_mfma_f32_32x32x16_bf16 v[72:87], a[152:155], v[32:35], v[72:87]
    ds_read_b64_tr_b16 a[218:219], v190 offset:10240
    ds_read_b64_tr_b16 a[220:221], v191 offset:8192
    s_and_b32 s63, s27, 0xf8
    s_mul_i32 s63, s63, 36864
    v_mul_u32_u24 v1, 294908, v0
    s_mov_b64 exec, 3
    buffer_load_dword v254, v1, s[48:51], s63 offen
    s_mov_b64 exec, -1
    v_exp_f32 v106, v106
    v_add_f32 v166, v166, v104
    v_mfma_f32_32x32x16_bf16 v[72:87], a[156:159], v[36:39], v[72:87]
    ds_read_b64_tr_b16 a[222:223], v191 offset:10240
    v_exp_f32 v107, v107
    v_add_f32 v167, v167, v105
    v_cvt_pk_bf16_f32 v156, v104, v105
    v_add_f32 v166, v166, v106
    v_mfma_f32_32x32x16_bf16 a[0:15], a[176:179], v[148:151], a[0:15]
    s_waitcnt lgkmcnt(14)
    ds_read_b64_tr_b16 a[224:225], v188 offset:12288
    ds_read_b64_tr_b16 a[226:227], v188 offset:14336
    s_mul_i32 s63, s24, 184320
    v_mul_u32_u24 v1, 184316, v0
    s_mov_b64 exec, 3
    buffer_load_dword v254, v1, s[52:55], s63 offen
    s_mov_b64 exec, -1
    v_exp_f32 v108, v108
    v_add_f32 v167, v167, v107
    v_mfma_f32_32x32x16_bf16 a[16:31], a[180:183], v[148:151], a[16:31]
    ds_read_b64_tr_b16 a[228:229], v189 offset:12288
    ds_read_b64_tr_b16 a[230:231], v189 offset:14336
    v_exp_f32 v109, v109
    v_cvt_pk_bf16_f32 v157, v106, v107
    v_add_f32 v166, v166, v108
    v_mfma_f32_32x32x16_bf16 a[32:47], a[184:187], v[148:151], a[32:47]
    ds_read_b64_tr_b16 a[232:233], v190 offset:12288
    ds_read_b64_tr_b16 a[234:235], v190 offset:14336
    v_mul_u32_u24 v1, 1309440, v0
    s_mov_b64 exec, 3
    buffer_load_dword v254, v1, s[44:47], 0 offen
    s_mov_b64 exec, -1
    v_exp_f32 v110, v110
    v_add_f32 v167, v167, v109
    v_mfma_f32_32x32x16_bf16 a[48:63], a[188:191], v[148:151], a[48:63]
    ds_read_b64_tr_b16 a[236:237], v191 offset:12288
    ds_read_b64_tr_b16 a[238:239], v191 offset:14336
    v_exp_f32 v111, v111
    v_cvt_pk_bf16_f32 v158, v108, v109
    v_add_f32 v166, v166, v110
    v_mfma_f32_32x32x16_bf16 a[0:15], a[192:195], v[152:155], a[0:15]
    s_waitcnt lgkmcnt(14)
    ds_read_b64_tr_b16 a[240:241], v192 offset:0
    ds_read_b64_tr_b16 a[242:243], v193 offset:0
    v_add_f32 v167, v167, v111
    v_cvt_pk_bf16_f32 v159, v110, v111
    v_exp_f32 v112, v112
    v_mfma_f32_32x32x16_bf16 a[16:31], a[196:199], v[152:155], a[16:31]
    s_add_u32 s65, s23, 1
    s_and_b32 s65, s65, 7
    s_mul_i32 s65, s65, 163840
    s_add_u32 m0, s72, 20480
    ds_read_b64_tr_b16 a[244:245], v194 offset:0
    ds_read_b64_tr_b16 a[246:247], v195 offset:0
    buffer_load_dwordx4 v228, s[44:47], s65 offen offset:1024 lds
    v_exp_f32 v113, v113
    v_mfma_f32_32x32x16_bf16 a[32:47], a[200:203], v[152:155], a[32:47]
    ds_read_b64_tr_b16 a[248:249], v196 offset:0
    ds_read_b64_tr_b16 a[250:251], v197 offset:0
    v_exp_f32 v114, v114
    v_add_f32 v166, v166, v112
    v_add_f32 v167, v167, v113
    v_mfma_f32_32x32x16_bf16 a[48:63], a[204:207], v[152:155], a[48:63]
    s_add_u32 s65, s23, 1
    s_and_b32 s65, s65, 7
    s_mul_i32 s65, s65, 163840
    s_add_u32 m0, s72, 20480
    ds_read_b64_tr_b16 a[252:253], v198 offset:0
    ds_read_b64_tr_b16 a[254:255], v199 offset:0
    buffer_load_dwordx4 v229, s[44:47], s65 offen offset:2048 lds
    v_exp_f32 v115, v115
    v_mfma_f32_32x32x16_bf16 a[0:15], a[208:211], v[156:159], a[0:15]
    s_waitcnt lgkmcnt(14)
    v_cvt_pk_bf16_f32 v160, v112, v113
    v_exp_f32 v116, v116
    v_add_f32 v166, v166, v114
    v_exp_f32 v117, v117
    v_mfma_f32_32x32x16_bf16 a[16:31], a[212:215], v[156:159], a[16:31]
    v_add_f32 v167, v167, v115
    v_cvt_pk_bf16_f32 v161, v114, v115
    v_exp_f32 v118, v118
    v_add_f32 v166, v166, v116
    v_add_f32 v167, v167, v117
    v_mfma_f32_32x32x16_bf16 a[32:47], a[216:219], v[156:159], a[32:47]
    v_exp_f32 v119, v119
    v_cvt_pk_bf16_f32 v162, v116, v117
    v_add_f32 v166, v166, v118
    v_add_f32 v167, v167, v119
    v_cvt_pk_bf16_f32 v163, v118, v119
    v_mfma_f32_32x32x16_bf16 a[48:63], a[220:223], v[156:159], a[48:63]
    v_exp_f32 v124, v124
    v_exp_f32 v125, v125
    v_exp_f32 v126, v126
    v_exp_f32 v127, v127
    v_add_f32 v244, v124, v125
    v_cvt_pk_bf16_f32 v164, v124, v125
    v_add_f32 v245, v126, v127
    v_cvt_pk_bf16_f32 v165, v126, v127
    v_add_f32 v244, v244, v245
    v_add_f32 v170, v170, v244
    s_waitcnt vmcnt(9)
    s_waitcnt lgkmcnt(0)
    s_barrier
    v_mfma_f32_32x32x16_bf16 a[0:15], a[224:227], v[160:163], a[0:15]
    ds_read_b128 a[96:99], v176 offset:32768
    ds_read_b128 a[100:103], v177 offset:32768
    v_max3_f32 v171, v56, v57, v58
    v_max3_f32 v173, v59, v60, v61
    v_max3_f32 v172, v120, v121, v122
    v_max3_f32 v171, v171, v62, v63
    v_mfma_f32_32x32x16_bf16 a[16:31], a[228:231], v[160:163], a[16:31]
    ds_read_b128 a[104:107], v178 offset:32768
    ds_read_b128 a[108:111], v179 offset:32768
    v_max3_f32 v173, v173, v64, v65
    v_max3_f32 v171, v171, v66, v67
    v_max3_f32 v173, v173, v68, v69
    v_max3_f32 v171, v171, v70, v71
    v_mfma_f32_32x32x16_bf16 a[32:47], a[232:235], v[160:163], a[32:47]
    ds_read_b128 a[112:115], v180 offset:32768
    ds_read_b128 a[116:119], v181 offset:32768
    v_max3_f32 v173, v173, v72, v73
    v_max3_f32 v171, v171, v74, v75
    v_max3_f32 v173, v173, v76, v77
    v_max3_f32 v171, v171, v78, v79
    v_mfma_f32_32x32x16_bf16 a[48:63], a[236:239], v[160:163], a[48:63]
    ds_read_b128 a[120:123], v182 offset:32768
    ds_read_b128 a[124:127], v183 offset:32768
    v_max3_f32 v173, v173, v80, v81
    v_max3_f32 v171, v171, v82, v83
    v_max3_f32 v173, v173, v84, v85
    v_max_f32 v172, v172, v123
    v_mfma_f32_16x16x16_bf16 a[64:67], a[240:241], v[164:165], a[64:67]
    ds_read_b128 a[160:163], v184 offset:32768
    v_max3_f32 v171, v171, v86, v87
    v_mfma_f32_16x16x16_bf16 a[68:71], a[242:243], v[164:165], a[68:71]
    ds_read_b128 a[164:167], v185 offset:32768
    v_max_f32 v171, v171, v173
    v_mfma_f32_16x16x16_bf16 a[72:75], a[244:245], v[164:165], a[72:75]
    ds_read_b128 a[168:171], v186 offset:32768
    v_max_f32 v173, v171, v172
    v_mfma_f32_16x16x16_bf16 a[76:79], a[246:247], v[164:165], a[76:79]
    ds_read_b128 a[172:175], v187 offset:32768
    v_cmp_lt_f32 vcc, s73, v173
    v_mfma_f32_16x16x16_bf16 a[80:83], a[248:249], v[164:165], a[80:83]
    ds_read_b128 a[128:131], v176 offset:40960
    v_mfma_f32_16x16x16_bf16 a[84:87], a[250:251], v[164:165], a[84:87]
    ds_read_b128 a[132:135], v177 offset:40960
    v_mfma_f32_16x16x16_bf16 a[88:91], a[252:253], v[164:165], a[88:91]
    ds_read_b128 a[136:139], v178 offset:40960
    v_mfma_f32_16x16x16_bf16 a[92:95], a[254:255], v[164:165], a[92:95]
    s_mov_b32 s66, 81920
    s_add_u32 m0, s71, 98304
    ds_read_b128 a[140:143], v179 offset:40960
    buffer_load_dwordx4 v204, s[32:35], s66 offen offset:0 nt lds
    s_cbranch_vccz L_ok_4
    s_call_b64 s[80:81], L_slow0
L_ok_4:
    s_waitcnt lgkmcnt(14)
    v_mfma_f32_32x32x16_bf16 v[88:103], a[96:99], v[8:11], v[128:143]
    ds_read_b128 a[144:147], v180 offset:40960
    ds_read_b128 a[148:151], v181 offset:40960
    v_exp_f32 v56, v56
    v_exp_f32 v57, v57
    v_mfma_f32_32x32x16_bf16 v[88:103], a[100:103], v[12:15], v[88:103]
    s_waitcnt lgkmcnt(14)
    ds_read_b128 a[152:155], v182 offset:40960
    buffer_load_dwordx4 v205, s[32:35], s66 offen offset:1024 nt lds
    v_exp_f32 v58, v58
    v_add_f32 v166, v166, v56
    v_add_f32 v167, v167, v57
    v_mfma_f32_32x32x16_bf16 v[88:103], a[104:107], v[16:19], v[88:103]
    ds_read_b128 a[156:159], v183 offset:40960
    ds_read_b64_tr_b16 a[176:177], v188 offset:16384
    v_exp_f32 v59, v59
    v_cvt_pk_bf16_f32 v148, v56, v57
    v_add_f32 v166, v166, v58
    v_mfma_f32_32x32x16_bf16 v[88:103], a[108:111], v[20:23], v[88:103]
    s_waitcnt lgkmcnt(14)
    ds_read_b64_tr_b16 a[178:179], v188 offset:18432
    v_exp_f32 v60, v60
    v_exp_f32 v61, v61
    v_add_f32 v167, v167, v59
    v_mfma_f32_32x32x16_bf16 v[88:103], a[112:115], v[24:27], v[88:103]
    ds_read_b64_tr_b16 a[180:181], v189 offset:16384
    ds_read_b64_tr_b16 a[182:183], v189 offset:18432
    buffer_load_dwordx4 v204, s[32:35], s66 offen offset:2048 nt lds
    v_cvt_pk_bf16_f32 v149, v58, v59
    v_exp_f32 v62, v62
    v_mfma_f32_32x32x16_bf16 v[88:103], a[116:119], v[28:31], v[88:103]
    ds_read_b64_tr_b16 a[184:185], v190 offset:16384
    v_add_f32 v166, v166, v60
    v_exp_f32 v63, v63
    v_add_f32 v167, v167, v61
    v_cvt_pk_bf16_f32 v150, v60, v61
    v_mfma_f32_32x32x16_bf16 v[88:103], a[120:123], v[32:35], v[88:103]
    s_waitcnt lgkmcnt(14)
    ds_read_b64_tr_b16 a[186:187], v190 offset:18432
    ds_read_b64_tr_b16 a[188:189], v191 offset:16384
    v_add_f32 v166, v166, v62
    v_add_f32 v167, v167, v63
    v_cvt_pk_bf16_f32 v151, v62, v63
    v_mfma_f32_32x32x16_bf16 v[88:103], a[124:127], v[36:39], v[88:103]
    ds_read_b64_tr_b16 a[190:191], v191 offset:18432
    buffer_load_dwordx4 v205, s[32:35], s66 offen offset:3072 nt lds
    v_exp_f32 v64, v64
    v_exp_f32 v65, v65
    v_mfma_f32_16x16x32_bf16 v[124:127], a[160:163], v[40:43], v[144:147]
    ds_read_b64_tr_b16 a[192:193], v188 offset:20480
    v_add_f32 v166, v166, v64
    v_mfma_f32_16x16x32_bf16 v[124:127], a[164:167], v[44:47], v[124:127]
    ds_read_b64_tr_b16 a[194:195], v188 offset:22528
    v_add_f32 v167, v167, v65
    v_mfma_f32_16x16x32_bf16 v[124:127], a[168:171], v[48:51], v[124:127]
    s_waitcnt lgkmcnt(14)
    s_mov_b32 s66, 114688
    s_add_u32 m0, s71, 131072
    ds_read_b64_tr_b16 a[196:197], v189 offset:20480
    buffer_load_dwordx4 v200, s[28:31], s66 offen offset:0 nt lds
    v_mfma_f32_16x16x32_bf16 v[124:127], a[172:175], v[52:55], v[124:127]
    ds_read_b64_tr_b16 a[198:199], v189 offset:22528
    v_cvt_pk_bf16_f32 v152, v64, v65
    v_mfma_f32_32x32x16_bf16 v[104:119], a[128:131], v[8:11], v[128:143]
    ds_read_b64_tr_b16 a[200:201], v190 offset:20480
    ds_read_b64_tr_b16 a[202:203], v190 offset:22528
    v_exp_f32 v66, v66
    v_exp_f32 v67, v67
    v_mfma_f32_32x32x16_bf16 v[104:119], a[132:135], v[12:15], v[104:119]
    ds_read_b64_tr_b16 a[204:205], v191 offset:20480
    buffer_load_dwordx4 v201, s[28:31], s66 offen offset:1024 nt lds
    v_exp_f32 v68, v68
    v_add_f32 v166, v166, v66
    v_add_f32 v167, v167, v67
    v_mfma_f32_32x32x16_bf16 v[104:119], a[136:139], v[16:19], v[104:119]
    ds_read_b64_tr_b16 a[206:207], v191 offset:22528
    ds_read_b64_tr_b16 a[208:209], v188 offset:24576
    v_exp_f32 v69, v69
    v_cvt_pk_bf16_f32 v153, v66, v67
    v_add_f32 v166, v166, v68
    v_mfma_f32_32x32x16_bf16 v[104:119], a[140:143], v[20:23], v[104:119]
    s_waitcnt lgkmcnt(14)
    ds_read_b64_tr_b16 a[210:211], v188 offset:26624
    buffer_load_dwordx4 v202, s[28:31], s66 offen offset:2048 nt lds
    v_exp_f32 v70, v70
    v_exp_f32 v71, v71
    v_mfma_f32_32x32x16_bf16 v[104:119], a[144:147], v[24:27], v[104:119]
    ds_read_b64_tr_b16 a[212:213], v189 offset:24576
    ds_read_b64_tr_b16 a[214:215], v189 offset:26624
    v_add_f32 v167, v167, v69
    v_cvt_pk_bf16_f32 v154, v68, v69
    v_add_f32 v166, v166, v70
    v_add_f32 v167, v167, v71
    v_mfma_f32_32x32x16_bf16 v[104:119], a[148:151], v[28:31], v[104:119]
    ds_read_b64_tr_b16 a[216:217], v190 offset:24576
    v_cvt_pk_bf16_f32 v155, v70, v71
    v_exp_f32 v72, v72
    v_exp_f32 v73, v73
    v_mfma_f32_32x32x16_bf16 v[104:119], a[152:155], v[32:35], v[104:119]
    ds_read_b64_tr_b16 a[218:219], v190 offset:26624
    ds_read_b64_tr_b16 a[220:221], v191 offset:24576
    buffer_load_dwordx4 v203, s[28:31], s66 offen offset:3072 nt lds
    v_exp_f32 v74, v74
    v_add_f32 v166, v166, v72
    v_mfma_f32_32x32x16_bf16 v[104:119], a[156:159], v[36:39], v[104:119]
    ds_read_b64_tr_b16 a[222:223], v191 offset:26624
    v_exp_f32 v75, v75
    v_add_f32 v167, v167, v73
    v_cvt_pk_bf16_f32 v156, v72, v73
    v_add_f32 v166, v166, v74
    v_mfma_f32_32x32x16_bf16 a[0:15], a[176:179], v[148:151], a[0:15]
    s_waitcnt lgkmcnt(14)
    ds_read_b64_tr_b16 a[224:225], v188 offset:28672
    ds_read_b64_tr_b16 a[226:227], v188 offset:30720
    v_exp_f32 v76, v76
    v_exp_f32 v77, v77
    v_mfma_f32_32x32x16_bf16 a[16:31], a[180:183], v[148:151], a[16:31]
    ds_read_b64_tr_b16 a[228:229], v189 offset:28672
    ds_read_b64_tr_b16 a[230:231], v189 offset:30720
    buffer_load_dword v248, v249, s[56:59], 0 offen sc1
    v_add_f32 v167, v167, v75
    v_cvt_pk_bf16_f32 v157, v74, v75
    v_add_f32 v166, v166, v76
    v_mfma_f32_32x32x16_bf16 a[32:47], a[184:187], v[148:151], a[32:47]
    ds_read_b64_tr_b16 a[232:233], v190 offset:28672
    ds_read_b64_tr_b16 a[234:235], v190 offset:30720
    v_exp_f32 v78, v78
    v_exp_f32 v79, v79
    v_mfma_f32_32x32x16_bf16 a[48:63], a[188:191], v[148:151], a[48:63]
    ds_read_b64_tr_b16 a[236:237], v191 offset:28672
    ds_read_b64_tr_b16 a[238:239], v191 offset:30720
    v_add_f32 v167, v167, v77
    v_cvt_pk_bf16_f32 v158, v76, v77
    v_add_f32 v166, v166, v78
    v_add_f32 v167, v167, v79
    v_mfma_f32_32x32x16_bf16 a[0:15], a[192:195], v[152:155], a[0:15]
    s_waitcnt lgkmcnt(14)
    s_add_u32 s65, s23, 1
    s_and_b32 s65, s65, 7
    s_mul_i32 s65, s65, 163840
    s_add_u32 m0, s72, 20480
    ds_read_b64_tr_b16 a[240:241], v192 offset:16384
    ds_read_b64_tr_b16 a[242:243], v193 offset:16384
    buffer_load_dwordx4 v230, s[44:47], s65 offen offset:3072 lds
    v_cvt_pk_bf16_f32 v159, v78, v79
    v_mfma_f32_32x32x16_bf16 a[16:31], a[196:199], v[152:155], a[16:31]
    ds_read_b64_tr_b16 a[244:245], v194 offset:16384
    ds_read_b64_tr_b16 a[246:247], v195 offset:16384
    v_exp_f32 v80, v80
    v_exp_f32 v81, v81
    v_mfma_f32_32x32x16_bf16 a[32:47], a[200:203], v[152:155], a[32:47]
    ds_read_b64_tr_b16 a[248:249], v196 offset:16384
    ds_read_b64_tr_b16 a[250:251], v197 offset:16384
    v_exp_f32 v82, v82
    v_add_f32 v166, v166, v80
    v_add_f32 v167, v167, v81
    v_mfma_f32_32x32x16_bf16 a[48:63], a[204:207], v[152:155], a[48:63]
    s_add_u32 s65, s23, 1
    s_and_b32 s65, s65, 7
    s_mul_i32 s65, s65, 163840
    s_add_u32 m0, s72, 24576
    ds_read_b64_tr_b16 a[252:253], v198 offset:16384
    ds_read_b64_tr_b16 a[254:255], v199 offset:16384
    buffer_load_dwordx4 v231, s[44:47], s65 offen offset:0 lds
    v_exp_f32 v83, v83
    v_mfma_f32_32x32x16_bf16 a[0:15], a[208:211], v[156:159], a[0:15]
    s_waitcnt lgkmcnt(14)
    v_cvt_pk_bf16_f32 v160, v80, v81
    v_exp_f32 v84, v84
    v_add_f32 v166, v166, v82
    v_exp_f32 v85, v85
    v_mfma_f32_32x32x16_bf16 a[16:31], a[212:215], v[156:159], a[16:31]
    v_add_f32 v167, v167, v83
    v_cvt_pk_bf16_f32 v161, v82, v83
    v_exp_f32 v86, v86
    v_add_f32 v166, v166, v84
    v_add_f32 v167, v167, v85
    v_mfma_f32_32x32x16_bf16 a[32:47], a[216:219], v[156:159], a[32:47]
    v_exp_f32 v87, v87
    v_cvt_pk_bf16_f32 v162, v84, v85
    v_add_f32 v166, v166, v86
    v_add_f32 v167, v167, v87
    v_cvt_pk_bf16_f32 v163, v86, v87
    v_mfma_f32_32x32x16_bf16 a[48:63], a[220:223], v[156:159], a[48:63]
    v_exp_f32 v120, v120
    v_exp_f32 v121, v121
    v_exp_f32 v122, v122
    v_exp_f32 v123, v123
    v_add_f32 v244, v120, v121
    v_cvt_pk_bf16_f32 v164, v120, v121
    v_add_f32 v245, v122, v123
    v_cvt_pk_bf16_f32 v165, v122, v123
    v_add_f32 v244, v244, v245
    v_add_f32 v170, v170, v244
    s_waitcnt vmcnt(7)
    s_waitcnt lgkmcnt(0)
    s_barrier
    v_mfma_f32_32x32x16_bf16 a[0:15], a[224:227], v[160:163], a[0:15]
    ds_read_b128 a[96:99], v176 offset:0
    ds_read_b128 a[100:103], v177 offset:0
    v_max3_f32 v171, v88, v89, v90
    v_max3_f32 v173, v91, v92, v93
    v_max3_f32 v172, v124, v125, v126
    v_max3_f32 v171, v171, v94, v95
    v_mfma_f32_32x32x16_bf16 a[16:31], a[228:231], v[160:163], a[16:31]
    ds_read_b128 a[104:107], v178 offset:0
    ds_read_b128 a[108:111], v179 offset:0
    v_max3_f32 v173, v173, v96, v97
    v_max3_f32 v171, v171, v98, v99
    v_max3_f32 v173, v173, v100, v101
    v_max3_f32 v171, v171, v102, v103
    v_mfma_f32_32x32x16_bf16 a[32:47], a[232:235], v[160:163], a[32:47]
    ds_read_b128 a[112:115], v180 offset:0
    ds_read_b128 a[116:119], v181 offset:0
    v_max3_f32 v173, v173, v104, v105
    v_max3_f32 v171, v171, v106, v107
    v_max3_f32 v173, v173, v108, v109
    v_max3_f32 v171, v171, v110, v111
    v_mfma_f32_32x32x16_bf16 a[48:63], a[236:239], v[160:163], a[48:63]
    ds_read_b128 a[120:123], v182 offset:0
    ds_read_b128 a[124:127], v183 offset:0
    v_max3_f32 v173, v173, v112, v113
    v_max3_f32 v171, v171, v114, v115
    v_max3_f32 v173, v173, v116, v117
    v_max_f32 v172, v172, v127
    v_mfma_f32_16x16x16_bf16 a[64:67], a[240:241], v[164:165], a[64:67]
    ds_read_b128 a[160:163], v184 offset:0
    v_max3_f32 v171, v171, v118, v119
    v_mfma_f32_16x16x16_bf16 a[68:71], a[242:243], v[164:165], a[68:71]
    ds_read_b128 a[164:167], v185 offset:0
    v_max_f32 v171, v171, v173
    v_mfma_f32_16x16x16_bf16 a[72:75], a[244:245], v[164:165], a[72:75]
    ds_read_b128 a[168:171], v186 offset:0
    v_max_f32 v173, v171, v172
    v_mfma_f32_16x16x16_bf16 a[76:79], a[246:247], v[164:165], a[76:79]
    ds_read_b128 a[172:175], v187 offset:0
    v_cmp_lt_f32 vcc, s73, v173
    v_mfma_f32_16x16x16_bf16 a[80:83], a[248:249], v[164:165], a[80:83]
    ds_read_b128 a[128:131], v176 offset:8192
    v_mfma_f32_16x16x16_bf16 a[84:87], a[250:251], v[164:165], a[84:87]
    ds_read_b128 a[132:135], v177 offset:8192
    v_mfma_f32_16x16x16_bf16 a[88:91], a[252:253], v[164:165], a[88:91]
    ds_read_b128 a[136:139], v178 offset:8192
    v_mfma_f32_16x16x16_bf16 a[92:95], a[254:255], v[164:165], a[92:95]
    s_mov_b32 s66, 98304
    s_add_u32 m0, s71, 65536
    ds_read_b128 a[140:143], v179 offset:8192
    buffer_load_dwordx4 v204, s[32:35], s66 offen offset:0 nt lds
    s_cbranch_vccz L_ok_5
    s_call_b64 s[80:81], L_slow1
L_ok_5:
    s_waitcnt lgkmcnt(14)
    v_mfma_f32_32x32x16_bf16 v[56:71], a[96:99], v[8:11], v[128:143]
    ds_read_b128 a[144:147], v180 offset:8192
    ds_read_b128 a[148:151], v181 offset:8192
    v_exp_f32 v88, v88
    v_exp_f32 v89, v89
    v_mfma_f32_32x32x16_bf16 v[56:71], a[100:103], v[12:15], v[56:71]
    s_waitcnt lgkmcnt(14)
    ds_read_b128 a[152:155], v182 offset:8192
    v_exp_f32 v90, v90
    v_add_f32 v166, v166, v88
    v_exp_f32 v91, v91
    v_mfma_f32_32x32x16_bf16 v[56:71], a[104:107], v[16:19], v[56:71]
    ds_read_b128 a[156:159], v183 offset:8192
    ds_read_b64_tr_b16 a[176:177], v188 offset:32768
    buffer_load_dwordx4 v205, s[32:35], s66 offen offset:1024 nt lds
    v_add_f32 v167, v167, v89
    v_cvt_pk_bf16_f32 v148, v88, v89
    v_add_f32 v166, v166, v90
    v_mfma_f32_32x32x16_bf16 v[56:71], a[108:111], v[20:23], v[56:71]
    s_waitcnt lgkmcnt(14)
    ds_read_b64_tr_b16 a[178:179], v188 offset:34816
    v_exp_f32 v92, v92
    v_exp_f32 v93, v93
    v_add_f32 v167, v167, v91
    v_mfma_f32_32x32x16_bf16 v[56:71], a[112:115], v[24:27], v[56:71]
    ds_read_b64_tr_b16 a[180:181], v189 offset:32768
    ds_read_b64_tr_b16 a[182:183], v189 offset:34816
    v_cvt_pk_bf16_f32 v149, v90, v91
    v_exp_f32 v94, v94
    v_add_f32 v166, v166, v92
    v_mfma_f32_32x32x16_bf16 v[56:71], a[116:119], v[28:31], v[56:71]
    ds_read_b64_tr_b16 a[184:185], v190 offset:32768
    buffer_load_dwordx4 v204, s[32:35], s66 offen offset:2048 nt lds
    v_exp_f32 v95, v95
    v_add_f32 v167, v167, v93
    v_cvt_pk_bf16_f32 v150, v92, v93
    v_mfma_f32_32x32x16_bf16 v[56:71], a[120:123], v[32:35], v[56:71]
    s_waitcnt lgkmcnt(14)
    ds_read_b64_tr_b16 a[186:187], v190 offset:34816
    ds_read_b64_tr_b16 a[188:189], v191 offset:32768
    v_add_f32 v166, v166, v94
    v_add_f32 v167, v167, v95
    v_cvt_pk_bf16_f32 v151, v94, v95
    v_mfma_f32_32x32x16_bf16 v[56:71], a[124:127], v[36:39], v[56:71]
    ds_read_b64_tr_b16 a[190:191], v191 offset:34816
    v_exp_f32 v96, v96
    v_exp_f32 v97, v97
    v_add_f32 v166, v166, v96
    v_mfma_f32_16x16x32_bf16 v[120:123], a[160:163], v[40:43], v[144:147]
    ds_read_b64_tr_b16 a[192:193], v188 offset:36864
    buffer_load_dwordx4 v205, s[32:35], s66 offen offset:3072 nt lds
    v_mfma_f32_16x16x32_bf16 v[120:123], a[164:167], v[44:47], v[120:123]
    ds_read_b64_tr_b16 a[194:195], v188 offset:38912
    v_add_f32 v167, v167, v97
    v_mfma_f32_16x16x32_bf16 v[120:123], a[168:171], v[48:51], v[120:123]
    s_waitcnt lgkmcnt(14)
    ds_read_b64_tr_b16 a[196:197], v189 offset:36864
    v_cvt_pk_bf16_f32 v152, v96, v97
    v_mfma_f32_16x16x32_bf16 v[120:123], a[172:175], v[52:55], v[120:123]
    s_mov_b32 s66, 131072
    s_add_u32 m0, s71, 147456
    ds_read_b64_tr_b16 a[198:199], v189 offset:38912
    buffer_load_dwordx4 v200, s[28:31], s66 offen offset:0 nt lds
    v_mfma_f32_32x32x16_bf16 v[72:87], a[128:131], v[8:11], v[128:143]
    ds_read_b64_tr_b16 a[200:201], v190 offset:36864
    ds_read_b64_tr_b16 a[202:203], v190 offset:38912
    v_exp_f32 v98, v98
    v_exp_f32 v99, v99
    v_mfma_f32_32x32x16_bf16 v[72:87], a[132:135], v[12:15], v[72:87]
    ds_read_b64_tr_b16 a[204:205], v191 offset:36864
    v_exp_f32 v100, v100
    v_add_f32 v166, v166, v98
    v_exp_f32 v101, v101
    v_mfma_f32_32x32x16_bf16 v[72:87], a[136:139], v[16:19], v[72:87]
    ds_read_b64_tr_b16 a[206:207], v191 offset:38912
    ds_read_b64_tr_b16 a[208:209], v188 offset:40960
    buffer_load_dwordx4 v201, s[28:31], s66 offen offset:1024 nt lds
    v_add_f32 v167, v167, v99
    v_cvt_pk_bf16_f32 v153, v98, v99
    v_add_f32 v166, v166, v100
    v_mfma_f32_32x32x16_bf16 v[72:87], a[140:143], v[20:23], v[72:87]
    s_waitcnt lgkmcnt(14)
    ds_read_b64_tr_b16 a[210:211], v188 offset:43008
    v_exp_f32 v102, v102
    v_exp_f32 v103, v103
    v_add_f32 v167, v167, v101
    v_mfma_f32_32x32x16_bf16 v[72:87], a[144:147], v[24:27], v[72:87]
    ds_read_b64_tr_b16 a[212:213], v189 offset:40960
    ds_read_b64_tr_b16 a[214:215], v189 offset:43008
    v_cvt_pk_bf16_f32 v154, v100, v101
    v_add_f32 v166, v166, v102
    v_add_f32 v167, v167, v103
    v_cvt_pk_bf16_f32 v155, v102, v103
    v_mfma_f32_32x32x16_bf16 v[72:87], a[148:151], v[28:31], v[72:87]
    ds_read_b64_tr_b16 a[216:217], v190 offset:40960
    buffer_load_dwordx4 v202, s[28:31], s66 offen offset:2048 nt lds
    v_exp_f32 v104, v104
    v_exp_f32 v105, v105
    v_mfma_f32_32x32x16_bf16 v[72:87], a[152:155], v[32:35], v[72:87]
    ds_read_b64_tr_b16 a[218:219], v190 offset:43008
    ds_read_b64_tr_b16 a[220:221], v191 offset:40960
    v_exp_f32 v106, v106
    v_add_f32 v166, v166, v104
    v_add_f32 v167, v167, v105
    v_mfma_f32_32x32x16_bf16 v[72:87], a[156:159], v[36:39], v[72:87]
    ds_read_b64_tr_b16 a[222:223], v191 offset:43008
    v_exp_f32 v107, v107
    v_cvt_pk_bf16_f32 v156, v104, v105
    v_exp_f32 v108, v108
    v_mfma_f32_32x32x16_bf16 a[0:15], a[176:179], v[148:151], a[0:15]
    s_waitcnt lgkmcnt(14)
    ds_read_b64_tr_b16 a[224:225], v188 offset:45056
    ds_read_b64_tr_b16 a[226:227], v188 offset:47104
    buffer_load_dwordx4 v203, s[28:31], s66 offen offset:3072 nt lds
    v_add_f32 v166, v166, v106
    v_exp_f32 v109, v109
    v_mfma_f32_32x32x16_bf16 a[16:31], a[180:183], v[148:151], a[16:31]
    ds_read_b64_tr_b16 a[228:229], v189 offset:45056
    ds_read_b64_tr_b16 a[230:231], v189 offset:47104
    v_add_f32 v167, v167, v107
    v_cvt_pk_bf16_f32 v157, v106, v107
    v_exp_f32 v110, v110
    v_mfma_f32_32x32x16_bf16 a[32:47], a[184:187], v[148:151], a[32:47]
    ds_read_b64_tr_b16 a[232:233], v190 offset:45056
    ds_read_b64_tr_b16 a[234:235], v190 offset:47104
    v_add_f32 v166, v166, v108
    v_exp_f32 v111, v111
    v_add_f32 v167, v167, v109
    v_mfma_f32_32x32x16_bf16 a[48:63], a[188:191], v[148:151], a[48:63]
    s_add_u32 s65, s23, 2
    s_and_b32 s65, s65, 7
    s_mul_i32 s65, s65, 163840
    s_add_u32 m0, s72, 40960
    ds_read_b64_tr_b16 a[236:237], v191 offset:45056
    ds_read_b64_tr_b16 a[238:239], v191 offset:47104
    buffer_load_dwordx4 v227, s[44:47], s65 offen offset:0 lds
    v_cvt_pk_bf16_f32 v158, v108, v109
    v_add_f32 v166, v166, v110
    v_mfma_f32_32x32x16_bf16 a[0:15], a[192:195], v[152:155], a[0:15]
    s_waitcnt lgkmcnt(14)
    ds_read_b64_tr_b16 a[240:241], v192 offset:32768
    ds_read_b64_tr_b16 a[242:243], v193 offset:32768
    v_add_f32 v167, v167, v111
    v_cvt_pk_bf16_f32 v159, v110, v111
    v_exp_f32 v112, v112
    v_mfma_f32_32x32x16_bf16 a[16:31], a[196:199], v[152:155], a[16:31]
    ds_read_b64_tr_b16 a[244:245], v194 offset:32768
    ds_read_b64_tr_b16 a[246:247], v195 offset:32768
    v_exp_f32 v113, v113
    v_exp_f32 v114, v114
    v_mfma_f32_32x32x16_bf16 a[32:47], a[200:203], v[152:155], a[32:47]
    s_add_u32 s65, s23, 2
    s_and_b32 s65, s65, 7
    s_mul_i32 s65, s65, 163840
    s_add_u32 m0, s72, 40960
    ds_read_b64_tr_b16 a[248:249], v196 offset:32768
    ds_read_b64_tr_b16 a[250:251], v197 offset:32768
    buffer_load_dwordx4 v228, s[44:47], s65 offen offset:1024 lds
    v_add_f32 v166, v166, v112
    v_add_f32 v167, v167, v113
    v_mfma_f32_32x32x16_bf16 a[48:63], a[204:207], v[152:155], a[48:63]
    ds_read_b64_tr_b16 a[252:253], v198 offset:32768
    ds_read_b64_tr_b16 a[254:255], v199 offset:32768
    v_exp_f32 v115, v115
    v_cvt_pk_bf16_f32 v160, v112, v113
    v_add_f32 v166, v166, v114
    v_mfma_f32_32x32x16_bf16 a[0:15], a[208:211], v[156:159], a[0:15]
    s_waitcnt lgkmcnt(14)
    v_exp_f32 v116, v116
    v_exp_f32 v117, v117
    v_add_f32 v167, v167, v115
    v_cvt_pk_bf16_f32 v161, v114, v115
    v_mfma_f32_32x32x16_bf16 a[16:31], a[212:215], v[156:159], a[16:31]
    v_exp_f32 v118, v118
    v_add_f32 v166, v166, v116
    v_exp_f32 v119, v119
    v_add_f32 v167, v167, v117
    v_mfma_f32_32x32x16_bf16 a[32:47], a[216:219], v[156:159], a[32:47]
    v_cvt_pk_bf16_f32 v162, v116, v117
    v_add_f32 v166, v166, v118
    v_add_f32 v167, v167, v119
    v_cvt_pk_bf16_f32 v163, v118, v119
    v_exp_f32 v124, v124
    v_mfma_f32_32x32x16_bf16 a[48:63], a[220:223], v[156:159], a[48:63]
    v_exp_f32 v125, v125
    v_exp_f32 v126, v126
    v_exp_f32 v127, v127
    v_add_f32 v244, v124, v125
    v_cvt_pk_bf16_f32 v164, v124, v125
    v_add_f32 v245, v126, v127
    v_cvt_pk_bf16_f32 v165, v126, v127
    v_add_f32 v244, v244, v245
    v_add_f32 v170, v170, v244
    s_waitcnt vmcnt(6)
    s_waitcnt lgkmcnt(0)
    s_barrier
    v_mfma_f32_32x32x16_bf16 a[0:15], a[224:227], v[160:163], a[0:15]
    ds_read_b128 a[96:99], v176 offset:16384
    ds_read_b128 a[100:103], v177 offset:16384
    v_max3_f32 v171, v56, v57, v58
    v_max3_f32 v173, v59, v60, v61
    v_max3_f32 v172, v120, v121, v122
    v_max3_f32 v171, v171, v62, v63
    v_mfma_f32_32x32x16_bf16 a[16:31], a[228:231], v[160:163], a[16:31]
    ds_read_b128 a[104:107], v178 offset:16384
    ds_read_b128 a[108:111], v179 offset:16384
    v_max3_f32 v173, v173, v64, v65
    v_max3_f32 v171, v171, v66, v67
    v_max3_f32 v173, v173, v68, v69
    v_max3_f32 v171, v171, v70, v71
    v_mfma_f32_32x32x16_bf16 a[32:47], a[232:235], v[160:163], a[32:47]
    ds_read_b128 a[112:115], v180 offset:16384
    ds_read_b128 a[116:119], v181 offset:16384
    v_max3_f32 v173, v173, v72, v73
    v_max3_f32 v171, v171, v74, v75
    v_max3_f32 v173, v173, v76, v77
    v_max3_f32 v171, v171, v78, v79
    v_mfma_f32_32x32x16_bf16 a[48:63], a[236:239], v[160:163], a[48:63]
    ds_read_b128 a[120:123], v182 offset:16384
    ds_read_b128 a[124:127], v183 offset:16384
    v_max3_f32 v173, v173, v80, v81
    v_max3_f32 v171, v171, v82, v83
    v_max3_f32 v173, v173, v84, v85
    v_max_f32 v172, v172, v123
    v_mfma_f32_16x16x16_bf16 a[64:67], a[240:241], v[164:165], a[64:67]
    ds_read_b128 a[160:163], v184 offset:16384
    v_max3_f32 v171, v171, v86, v87
    v_mfma_f32_16x16x16_bf16 a[68:71], a[242:243], v[164:165], a[68:71]
    ds_read_b128 a[164:167], v185 offset:16384
    v_max_f32 v171, v171, v173
    v_mfma_f32_16x16x16_bf16 a[72:75], a[244:245], v[164:165], a[72:75]
    ds_read_b128 a[168:171], v186 offset:16384
    v_max_f32 v173, v171, v172
    v_mfma_f32_16x16x16_bf16 a[76:79], a[246:247], v[164:165], a[76:79]
    ds_read_b128 a[172:175], v187 offset:16384
    v_cmp_lt_f32 vcc, s73, v173
    v_mfma_f32_16x16x16_bf16 a[80:83], a[248:249], v[164:165], a[80:83]
    ds_read_b128 a[128:131], v176 offset:24576
    v_mfma_f32_16x16x16_bf16 a[84:87], a[250:251], v[164:165], a[84:87]
    ds_read_b128 a[132:135], v177 offset:24576
    v_mfma_f32_16x16x16_bf16 a[88:91], a[252:253], v[164:165], a[88:91]
    ds_read_b128 a[136:139], v178 offset:24576
    v_mfma_f32_16x16x16_bf16 a[92:95], a[254:255], v[164:165], a[92:95]
    s_mov_b32 s66, 114688
    s_add_u32 m0, s71, 81920
    ds_read_b128 a[140:143], v179 offset:24576
    buffer_load_dwordx4 v204, s[32:35], s66 offen offset:0 nt lds
    s_cbranch_vccz L_ok_6
    s_call_b64 s[80:81], L_slow0
L_ok_6:
    s_waitcnt lgkmcnt(14)
    v_mfma_f32_32x32x16_bf16 v[88:103], a[96:99], v[8:11], v[128:143]
    ds_read_b128 a[144:147], v180 offset:24576
    ds_read_b128 a[148:151], v181 offset:24576
    v_exp_f32 v56, v56
    v_exp_f32 v57, v57
    v_mfma_f32_32x32x16_bf16 v[88:103], a[100:103], v[12:15], v[88:103]
    s_waitcnt lgkmcnt(14)
    ds_read_b128 a[152:155], v182 offset:24576
    v_exp_f32 v58, v58
    v_add_f32 v166, v166, v56
    v_exp_f32 v59, v59
    v_mfma_f32_32x32x16_bf16 v[88:103], a[104:107], v[16:19], v[88:103]
    ds_read_b128 a[156:159], v183 offset:24576
    ds_read_b64_tr_b16 a[176:177], v188 offset:0
    buffer_load_dwordx4 v205, s[32:35], s66 offen offset:1024 nt lds
    v_add_f32 v167, v167, v57
    v_cvt_pk_bf16_f32 v148, v56, v57
    v_add_f32 v166, v166, v58
    v_mfma_f32_32x32x16_bf16 v[88:103], a[108:111], v[20:23], v[88:103]
    s_waitcnt lgkmcnt(14)
    ds_read_b64_tr_b16 a[178:179], v188 offset:2048
    v_exp_f32 v60, v60
    v_exp_f32 v61, v61
    v_add_f32 v167, v167, v59
    v_mfma_f32_32x32x16_bf16 v[88:103], a[112:115], v[24:27], v[88:103]
    ds_read_b64_tr_b16 a[180:181], v189 offset:0
    ds_read_b64_tr_b16 a[182:183], v189 offset:2048
    v_cvt_pk_bf16_f32 v149, v58, v59
    v_exp_f32 v62, v62
    v_add_f32 v166, v166, v60
    v_mfma_f32_32x32x16_bf16 v[88:103], a[116:119], v[28:31], v[88:103]
    ds_read_b64_tr_b16 a[184:185], v190 offset:0
    buffer_load_dwordx4 v204, s[32:35], s66 offen offset:2048 nt lds
    v_exp_f32 v63, v63
    v_add_f32 v167, v167, v61
    v_cvt_pk_bf16_f32 v150, v60, v61
    v_mfma_f32_32x32x16_bf16 v[88:103], a[120:123], v[32:35], v[88:103]
    s_waitcnt lgkmcnt(14)
    ds_read_b64_tr_b16 a[186:187], v190 offset:2048
    ds_read_b64_tr_b16 a[188:189], v191 offset:0
    v_add_f32 v166, v166, v62
    v_add_f32 v167, v167, v63
    v_cvt_pk_bf16_f32 v151, v62, v63
    v_mfma_f32_32x32x16_bf16 v[88:103], a[124:127], v[36:39], v[88:103]
    ds_read_b64_tr_b16 a[190:191], v191 offset:2048
    v_exp_f32 v64, v64
    v_exp_f32 v65, v65
    v_add_f32 v166, v166, v64
    v_mfma_f32_16x16x32_bf16 v[124:127], a[160:163], v[40:43], v[144:147]
    ds_read_b64_tr_b16 a[192:193], v188 offset:4096
    buffer_load_dwordx4 v205, s[32:35], s66 offen offset:3072 nt lds
    v_mfma_f32_16x16x32_bf16 v[124:127], a[164:167], v[44:47], v[124:127]
    ds_read_b64_tr_b16 a[194:195], v188 offset:6144
    v_add_f32 v167, v167, v65
    v_mfma_f32_16x16x32_bf16 v[124:127], a[168:171], v[48:51], v[124:127]
    s_waitcnt lgkmcnt(14)
    ds_read_b64_tr_b16 a[196:197], v189 offset:4096
    v_cvt_pk_bf16_f32 v152, v64, v65
    v_mfma_f32_16x16x32_bf16 v[124:127], a[172:175], v[52:55], v[124:127]
    s_mov_b32 s66, 147456
    s_add_u32 m0, s71, 114688
    ds_read_b64_tr_b16 a[198:199], v189 offset:6144
    buffer_load_dwordx4 v200, s[28:31], s66 offen offset:0 nt lds
    v_mfma_f32_32x32x16_bf16 v[104:119], a[128:131], v[8:11], v[128:143]
    ds_read_b64_tr_b16 a[200:201], v190 offset:4096
    ds_read_b64_tr_b16 a[202:203], v190 offset:6144
    v_exp_f32 v66, v66
    v_exp_f32 v67, v67
    v_mfma_f32_32x32x16_bf16 v[104:119], a[132:135], v[12:15], v[104:119]
    ds_read_b64_tr_b16 a[204:205], v191 offset:4096
    v_exp_f32 v68, v68
    v_add_f32 v166, v166, v66
    v_exp_f32 v69, v69
    v_mfma_f32_32x32x16_bf16 v[104:119], a[136:139], v[16:19], v[104:119]
    ds_read_b64_tr_b16 a[206:207], v191 offset:6144
    ds_read_b64_tr_b16 a[208:209], v188 offset:8192
    buffer_load_dwordx4 v201, s[28:31], s66 offen offset:1024 nt lds
    v_add_f32 v167, v167, v67
    v_cvt_pk_bf16_f32 v153, v66, v67
    v_add_f32 v166, v166, v68
    v_mfma_f32_32x32x16_bf16 v[104:119], a[140:143], v[20:23], v[104:119]
    s_waitcnt lgkmcnt(14)
    ds_read_b64_tr_b16 a[210:211], v188 offset:10240
    v_exp_f32 v70, v70
    v_exp_f32 v71, v71
    v_add_f32 v167, v167, v69
    v_mfma_f32_32x32x16_bf16 v[104:119], a[144:147], v[24:27], v[104:119]
    ds_read_b64_tr_b16 a[212:213], v189 offset:8192
    ds_read_b64_tr_b16 a[214:215], v189 offset:10240
    v_cvt_pk_bf16_f32 v154, v68, v69
    v_add_f32 v166, v166, v70
    v_add_f32 v167, v167, v71
    v_cvt_pk_bf16_f32 v155, v70, v71
    v_mfma_f32_32x32x16_bf16 v[104:119], a[148:151], v[28:31], v[104:119]
    ds_read_b64_tr_b16 a[216:217], v190 offset:8192
    buffer_load_dwordx4 v202, s[28:31], s66 offen offset:2048 nt lds
    v_exp_f32 v72, v72
    v_exp_f32 v73, v73
    v_mfma_f32_32x32x16_bf16 v[104:119], a[152:155], v[32:35], v[104:119]
    ds_read_b64_tr_b16 a[218:219], v190 offset:10240
    ds_read_b64_tr_b16 a[220:221], v191 offset:8192
    v_exp_f32 v74, v74
    v_add_f32 v166, v166, v72
    v_add_f32 v167, v167, v73
    v_mfma_f32_32x32x16_bf16 v[104:119], a[156:159], v[36:39], v[104:119]
    ds_read_b64_tr_b16 a[222:223], v191 offset:10240
    v_exp_f32 v75, v75
    v_cvt_pk_bf16_f32 v156, v72, v73
    v_exp_f32 v76, v76
    v_mfma_f32_32x32x16_bf16 a[0:15], a[176:179], v[148:151], a[0:15]
    s_waitcnt lgkmcnt(14)
    ds_read_b64_tr_b16 a[224:225], v188 offset:12288
    ds_read_b64_tr_b16 a[226:227], v188 offset:14336
    buffer_load_dwordx4 v203, s[28:31], s66 offen offset:3072 nt lds
    v_add_f32 v166, v166, v74
    v_exp_f32 v77, v77
    v_mfma_f32_32x32x16_bf16 a[16:31], a[180:183], v[148:151], a[16:31]
    ds_read_b64_tr_b16 a[228:229], v189 offset:12288
    ds_read_b64_tr_b16 a[230:231], v189 offset:14336
    v_add_f32 v167, v167, v75
    v_cvt_pk_bf16_f32 v157, v74, v75
    v_exp_f32 v78, v78
    v_mfma_f32_32x32x16_bf16 a[32:47], a[184:187], v[148:151], a[32:47]
    ds_read_b64_tr_b16 a[232:233], v190 offset:12288
    ds_read_b64_tr_b16 a[234:235], v190 offset:14336
    v_add_f32 v166, v166, v76
    v_exp_f32 v79, v79
    v_add_f32 v167, v167, v77
    v_mfma_f32_32x32x16_bf16 a[48:63], a[188:191], v[148:151], a[48:63]
    s_add_u32 s65, s23, 2
    s_and_b32 s65, s65, 7
    s_mul_i32 s65, s65, 163840
    s_add_u32 m0, s72, 40960
    ds_read_b64_tr_b16 a[236:237], v191 offset:12288
    ds_read_b64_tr_b16 a[238:239], v191 offset:14336
    buffer_load_dwordx4 v229, s[44:47], s65 offen offset:2048 lds
    v_cvt_pk_bf16_f32 v158, v76, v77
    v_add_f32 v166, v166, v78
    v_mfma_f32_32x32x16_bf16 a[0:15], a[192:195], v[152:155], a[0:15]
    s_waitcnt lgkmcnt(14)
    ds_read_b64_tr_b16 a[240:241], v192 offset:0
    ds_read_b64_tr_b16 a[242:243], v193 offset:0
    v_add_f32 v167, v167, v79
    v_cvt_pk_bf16_f32 v159, v78, v79
    v_exp_f32 v80, v80
    v_mfma_f32_32x32x16_bf16 a[16:31], a[196:199], v[152:155], a[16:31]
    ds_read_b64_tr_b16 a[244:245], v194 offset:0
    ds_read_b64_tr_b16 a[246:247], v195 offset:0
    v_exp_f32 v81, v81
    v_exp_f32 v82, v82
    v_mfma_f32_32x32x16_bf16 a[32:47], a[200:203], v[152:155], a[32:47]
    s_add_u32 s65, s23, 2
    s_and_b32 s65, s65, 7
    s_mul_i32 s65, s65, 163840
    s_add_u32 m0, s72, 40960
    ds_read_b64_tr_b16 a[248:249], v196 offset:0
    ds_read_b64_tr_b16 a[250:251], v197 offset:0
    buffer_load_dwordx4 v230, s[44:47], s65 offen offset:3072 lds
    v_add_f32 v166, v166, v80
    v_add_f32 v167, v167, v81
    v_mfma_f32_32x32x16_bf16 a[48:63], a[204:207], v[152:155], a[48:63]
    ds_read_b64_tr_b16 a[252:253], v198 offset:0
    ds_read_b64_tr_b16 a[254:255], v199 offset:0
    v_exp_f32 v83, v83
    v_cvt_pk_bf16_f32 v160, v80, v81
    v_add_f32 v166, v166, v82
    v_mfma_f32_32x32x16_bf16 a[0:15], a[208:211], v[156:159], a[0:15]
    s_waitcnt lgkmcnt(14)
    v_exp_f32 v84, v84
    v_exp_f32 v85, v85
    v_add_f32 v167, v167, v83
    v_cvt_pk_bf16_f32 v161, v82, v83
    v_mfma_f32_32x32x16_bf16 a[16:31], a[212:215], v[156:159], a[16:31]
    v_exp_f32 v86, v86
    v_add_f32 v166, v166, v84
    v_exp_f32 v87, v87
    v_add_f32 v167, v167, v85
    v_mfma_f32_32x32x16_bf16 a[32:47], a[216:219], v[156:159], a[32:47]
    v_cvt_pk_bf16_f32 v162, v84, v85
    v_add_f32 v166, v166, v86
    v_add_f32 v167, v167, v87
    v_cvt_pk_bf16_f32 v163, v86, v87
    v_exp_f32 v120, v120
    v_mfma_f32_32x32x16_bf16 a[48:63], a[220:223], v[156:159], a[48:63]
    v_exp_f32 v121, v121
    v_exp_f32 v122, v122
    v_exp_f32 v123, v123
    v_add_f32 v244, v120, v121
    v_cvt_pk_bf16_f32 v164, v120, v121
    v_add_f32 v245, v122, v123
    v_cvt_pk_bf16_f32 v165, v122, v123
    v_add_f32 v244, v244, v245
    v_add_f32 v170, v170, v244
    v_cmp_eq_u32 vcc, 1, v248
    s_cmp_eq_u64 vcc, exec
    s_cbranch_scc1 L_rdy_x
    s_mov_b32 s69, 0
L_rdy:
    buffer_load_dword v248, v249, s[56:59], 0 offen sc1
    s_waitcnt vmcnt(0)
    v_cmp_eq_u32 vcc, 1, v248
    s_cmp_eq_u64 vcc, exec
    s_cbranch_scc1 L_rdy_x
    s_add_u32 s69, s69, 1
    s_cmp_lt_u32 s69, 200000
    s_cbranch_scc1 L_rdy
L_rdy_x:
    s_waitcnt vmcnt(6)
    s_waitcnt lgkmcnt(0)
    s_barrier
    v_mfma_f32_32x32x16_bf16 a[0:15], a[224:227], v[160:163], a[0:15]
    ds_read_b128 a[96:99], v176 offset:32768
    ds_read_b128 a[100:103], v177 offset:32768
    v_max3_f32 v171, v88, v89, v90
    v_max3_f32 v173, v91, v92, v93
    v_max3_f32 v172, v124, v125, v126
    v_max3_f32 v171, v171, v94, v95
    v_mfma_f32_32x32x16_bf16 a[16:31], a[228:231], v[160:163], a[16:31]
    ds_read_b128 a[104:107], v178 offset:32768
    ds_read_b128 a[108:111], v179 offset:32768
    v_max3_f32 v173, v173, v96, v97
    v_max3_f32 v171, v171, v98, v99
    v_max3_f32 v173, v173, v100, v101
    v_max3_f32 v171, v171, v102, v103
    v_mfma_f32_32x32x16_bf16 a[32:47], a[232:235], v[160:163], a[32:47]
    ds_read_b128 a[112:115], v180 offset:32768
    ds_read_b128 a[116:119], v181 offset:32768
    v_max3_f32 v173, v173, v104, v105
    v_max3_f32 v171, v171, v106, v107
    v_max3_f32 v173, v173, v108, v109
    v_max3_f32 v171, v171, v110, v111
    v_mfma_f32_32x32x16_bf16 a[48:63], a[236:239], v[160:163], a[48:63]
    ds_read_b128 a[120:123], v182 offset:32768
    ds_read_b128 a[124:127], v183 offset:32768
    v_max3_f32 v173, v173, v112, v113
    v_max3_f32 v171, v171, v114, v115
    v_max3_f32 v173, v173, v116, v117
    v_max_f32 v172, v172, v127
    v_mfma_f32_16x16x16_bf16 a[64:67], a[240:241], v[164:165], a[64:67]
    ds_read_b128 a[160:163], v184 offset:32768
    v_max3_f32 v171, v171, v118, v119
    v_mfma_f32_16x16x16_bf16 a[68:71], a[242:243], v[164:165], a[68:71]
    ds_read_b128 a[164:167], v185 offset:32768
    v_max_f32 v171, v171, v173
    v_mfma_f32_16x16x16_bf16 a[72:75], a[244:245], v[164:165], a[72:75]
    ds_read_b128 a[168:171], v186 offset:32768
    v_max_f32 v173, v171, v172
    v_mfma_f32_16x16x16_bf16 a[76:79], a[246:247], v[164:165], a[76:79]
    ds_read_b128 a[172:175], v187 offset:32768
    v_cmp_lt_f32 vcc, s73, v173
    v_mfma_f32_16x16x16_bf16 a[80:83], a[248:249], v[164:165], a[80:83]
    ds_read_b128 a[128:131], v176 offset:40960
    v_mfma_f32_16x16x16_bf16 a[84:87], a[250:251], v[164:165], a[84:87]
    ds_read_b128 a[132:135], v177 offset:40960
    v_mfma_f32_16x16x16_bf16 a[88:91], a[252:253], v[164:165], a[88:91]
    ds_read_b128 a[136:139], v178 offset:40960
    v_mfma_f32_16x16x16_bf16 a[92:95], a[254:255], v[164:165], a[92:95]
    s_mov_b32 s66, 131072
    s_add_u32 m0, s71, 98304
    ds_read_b128 a[140:143], v179 offset:40960
    buffer_load_dwordx4 v204, s[32:35], s66 offen offset:0 nt lds
    s_cbranch_vccz L_ok_7
    s_call_b64 s[80:81], L_slow1
L_ok_7:
    s_waitcnt lgkmcnt(14)
    v_mfma_f32_32x32x16_bf16 v[56:71], a[96:99], v[8:11], v[128:143]
    ds_read_b128 a[144:147], v180 offset:40960
    ds_read_b128 a[148:151], v181 offset:40960
    v_exp_f32 v88, v88
    v_exp_f32 v89, v89
    v_mfma_f32_32x32x16_bf16 v[56:71], a[100:103], v[12:15], v[56:71]
    s_waitcnt lgkmcnt(14)
    ds_read_b128 a[152:155], v182 offset:40960
    buffer_load_dwordx4 v205, s[32:35], s66 offen offset:1024 nt lds
    v_exp_f32 v90, v90
    v_add_f32 v166, v166, v88
    v_add_f32 v167, v167, v89
    v_mfma_f32_32x32x16_bf16 v[56:71], a[104:107], v[16:19], v[56:71]
    ds_read_b128 a[156:159], v183 offset:40960
    ds_read_b64_tr_b16 a[176:177], v188 offset:16384
    v_exp_f32 v91, v91
    v_cvt_pk_bf16_f32 v148, v88, v89
    v_add_f32 v166, v166, v90
    v_mfma_f32_32x32x16_bf16 v[56:71], a[108:111], v[20:23], v[56:71]
    s_waitcnt lgkmcnt(14)
    ds_read_b64_tr_b16 a[178:179], v188 offset:18432
    v_exp_f32 v92, v92
    v_exp_f32 v93, v93
    v_add_f32 v167, v167, v91
    v_mfma_f32_32x32x16_bf16 v[56:71], a[112:115], v[24:27], v[56:71]
    ds_read_b64_tr_b16 a[180:181], v189 offset:16384
    ds_read_b64_tr_b16 a[182:183], v189 offset:18432
    buffer_load_dwordx4 v204, s[32:35], s66 offen offset:2048 nt lds
    v_cvt_pk_bf16_f32 v149, v90, v91
    v_exp_f32 v94, v94
    v_mfma_f32_32x32x16_bf16 v[56:71], a[116:119], v[28:31], v[56:71]
    ds_read_b64_tr_b16 a[184:185], v190 offset:16384
    v_add_f32 v166, v166, v92
    v_exp_f32 v95, v95
    v_add_f32 v167, v167, v93
    v_cvt_pk_bf16_f32 v150, v92, v93
    v_mfma_f32_32x32x16_bf16 v[56:71], a[120:123], v[32:35], v[56:71]
    s_waitcnt lgkmcnt(14)
    ds_read_b64_tr_b16 a[186:187], v190 offset:18432
    ds_read_b64_tr_b16 a[188:189], v191 offset:16384
    v_add_f32 v166, v166, v94
    v_add_f32 v167, v167, v95
    v_cvt_pk_bf16_f32 v151, v94, v95
    v_mfma_f32_32x32x16_bf16 v[56:71], a[124:127], v[36:39], v[56:71]
    ds_read_b64_tr_b16 a[190:191], v191 offset:18432
    buffer_load_dwordx4 v205, s[32:35], s66 offen offset:3072 nt lds
    v_exp_f32 v96, v96
    v_exp_f32 v97, v97
    v_mfma_f32_16x16x32_bf16 v[120:123], a[160:163], v[40:43], v[144:147]
    ds_read_b64_tr_b16 a[192:193], v188 offset:20480
    v_add_f32 v166, v166, v96
    v_mfma_f32_16x16x32_bf16 v[120:123], a[164:167], v[44:47], v[120:123]
    ds_read_b64_tr_b16 a[194:195], v188 offset:22528
    v_add_f32 v167, v167, v97
    v_mfma_f32_16x16x32_bf16 v[120:123], a[168:171], v[48:51], v[120:123]
    s_waitcnt lgkmcnt(14)
    s_mov_b32 s66, 163840
    s_add_u32 m0, s71, 131072
    ds_read_b64_tr_b16 a[196:197], v189 offset:20480
    buffer_load_dwordx4 v200, s[28:31], s66 offen offset:0 nt lds
    v_mfma_f32_16x16x32_bf16 v[120:123], a[172:175], v[52:55], v[120:123]
    ds_read_b64_tr_b16 a[198:199], v189 offset:22528
    v_cvt_pk_bf16_f32 v152, v96, v97
    v_mfma_f32_32x32x16_bf16 v[72:87], a[128:131], v[8:11], v[128:143]
    ds_read_b64_tr_b16 a[200:201], v190 offset:20480
    ds_read_b64_tr_b16 a[202:203], v190 offset:22528
    v_exp_f32 v98, v98
    v_exp_f32 v99, v99
    v_mfma_f32_32x32x16_bf16 v[72:87], a[132:135], v[12:15], v[72:87]
    ds_read_b64_tr_b16 a[204:205], v191 offset:20480
    buffer_load_dwordx4 v201, s[28:31], s66 offen offset:1024 nt lds
    v_exp_f32 v100, v100
    v_add_f32 v166, v166, v98
    v_add_f32 v167, v167, v99
    v_mfma_f32_32x32x16_bf16 v[72:87], a[136:139], v[16:19], v[72:87]
    ds_read_b64_tr_b16 a[206:207], v191 offset:22528
    ds_read_b64_tr_b16 a[208:209], v188 offset:24576
    v_exp_f32 v101, v101
    v_cvt_pk_bf16_f32 v153, v98, v99
    v_add_f32 v166, v166, v100
    v_mfma_f32_32x32x16_bf16 v[72:87], a[140:143], v[20:23], v[72:87]
    s_waitcnt lgkmcnt(14)
    ds_read_b64_tr_b16 a[210:211], v188 offset:26624
    buffer_load_dwordx4 v202, s[28:31], s66 offen offset:2048 nt lds
    v_exp_f32 v102, v102
    v_exp_f32 v103, v103
    v_mfma_f32_32x32x16_bf16 v[72:87], a[144:147], v[24:27], v[72:87]
    ds_read_b64_tr_b16 a[212:213], v189 offset:24576
    ds_read_b64_tr_b16 a[214:215], v189 offset:26624
    v_add_f32 v167, v167, v101
    v_cvt_pk_bf16_f32 v154, v100, v101
    v_add_f32 v166, v166, v102
    v_add_f32 v167, v167, v103
    v_mfma_f32_32x32x16_bf16 v[72:87], a[148:151], v[28:31], v[72:87]
    ds_read_b64_tr_b16 a[216:217], v190 offset:24576
    v_cvt_pk_bf16_f32 v155, v102, v103
    v_exp_f32 v104, v104
    v_exp_f32 v105, v105
    v_mfma_f32_32x32x16_bf16 v[72:87], a[152:155], v[32:35], v[72:87]
    ds_read_b64_tr_b16 a[218:219], v190 offset:26624
    ds_read_b64_tr_b16 a[220:221], v191 offset:24576
    buffer_load_dwordx4 v203, s[28:31], s66 offen offset:3072 nt lds
    v_exp_f32 v106, v106
    v_add_f32 v166, v166, v104
    v_mfma_f32_32x32x16_bf16 v[72:87], a[156:159], v[36:39], v[72:87]
    ds_read_b64_tr_b16 a[222:223], v191 offset:26624
    v_exp_f32 v107, v107
    v_add_f32 v167, v167, v105
    v_cvt_pk_bf16_f32 v156, v104, v105
    v_add_f32 v166, v166, v106
    v_mfma_f32_32x32x16_bf16 a[0:15], a[176:179], v[148:151], a[0:15]
    s_waitcnt lgkmcnt(14)
    ds_read_b64_tr_b16 a[224:225], v188 offset:28672
    ds_read_b64_tr_b16 a[226:227], v188 offset:30720
    v_exp_f32 v108, v108
    v_exp_f32 v109, v109
    v_mfma_f32_32x32x16_bf16 a[16:31], a[180:183], v[148:151], a[16:31]
    ds_read_b64_tr_b16 a[228:229], v189 offset:28672
    ds_read_b64_tr_b16 a[230:231], v189 offset:30720
    s_lshl_b32 s63, s75, 1
    v_mov_b32 v248, s63
    buffer_store_dword v248, v251, s[48:51], s3 offen sc1
    v_add_f32 v167, v167, v107
    v_cvt_pk_bf16_f32 v157, v106, v107
    v_add_f32 v166, v166, v108
    v_mfma_f32_32x32x16_bf16 a[32:47], a[184:187], v[148:151], a[32:47]
    ds_read_b64_tr_b16 a[232:233], v190 offset:28672
    ds_read_b64_tr_b16 a[234:235], v190 offset:30720
    v_exp_f32 v110, v110
    v_exp_f32 v111, v111
    v_mfma_f32_32x32x16_bf16 a[48:63], a[188:191], v[148:151], a[48:63]
    ds_read_b64_tr_b16 a[236:237], v191 offset:28672
    ds_read_b64_tr_b16 a[238:239], v191 offset:30720
    v_add_f32 v167, v167, v109
    v_cvt_pk_bf16_f32 v158, v108, v109
    v_add_f32 v166, v166, v110
    v_add_f32 v167, v167, v111
    v_mfma_f32_32x32x16_bf16 a[0:15], a[192:195], v[152:155], a[0:15]
    s_waitcnt lgkmcnt(14)
    ds_read_b64_tr_b16 a[240:241], v192 offset:16384
    ds_read_b64_tr_b16 a[242:243], v193 offset:16384
    buffer_store_dword v248, v252, s[48:51], s19 offen sc1
    v_cvt_pk_bf16_f32 v159, v110, v111
    v_exp_f32 v112, v112
    v_mfma_f32_32x32x16_bf16 a[16:31], a[196:199], v[152:155], a[16:31]
    ds_read_b64_tr_b16 a[244:245], v194 offset:16384
    ds_read_b64_tr_b16 a[246:247], v195 offset:16384
    v_exp_f32 v113, v113
    v_exp_f32 v114, v114
    v_mfma_f32_32x32x16_bf16 a[32:47], a[200:203], v[152:155], a[32:47]
    ds_read_b64_tr_b16 a[248:249], v196 offset:16384
    ds_read_b64_tr_b16 a[250:251], v197 offset:16384
    v_add_f32 v166, v166, v112
    v_exp_f32 v115, v115
    v_add_f32 v167, v167, v113
    v_mfma_f32_32x32x16_bf16 a[48:63], a[204:207], v[152:155], a[48:63]
    s_add_u32 s65, s23, 2
    s_and_b32 s65, s65, 7
    s_mul_i32 s65, s65, 163840
    s_add_u32 m0, s72, 45056
    ds_read_b64_tr_b16 a[252:253], v198 offset:16384
    ds_read_b64_tr_b16 a[254:255], v199 offset:16384
    buffer_load_dwordx4 v231, s[44:47], s65 offen offset:0 lds
    v_cvt_pk_bf16_f32 v160, v112, v113
    v_add_f32 v166, v166, v114
    v_mfma_f32_32x32x16_bf16 a[0:15], a[208:211], v[156:159], a[0:15]
    s_waitcnt lgkmcnt(14)
    v_exp_f32 v116, v116
    v_exp_f32 v117, v117
    v_add_f32 v167, v167, v115
    v_cvt_pk_bf16_f32 v161, v114, v115
    v_mfma_f32_32x32x16_bf16 a[16:31], a[212:215], v[156:159], a[16:31]
    v_exp_f32 v118, v118
    v_add_f32 v166, v166, v116
    v_exp_f32 v119, v119
    v_add_f32 v167, v167, v117
    v_mfma_f32_32x32x16_bf16 a[32:47], a[216:219], v[156:159], a[32:47]
    v_cvt_pk_bf16_f32 v162, v116, v117
    v_add_f32 v166, v166, v118
    v_add_f32 v167, v167, v119
    v_cvt_pk_bf16_f32 v163, v118, v119
    v_exp_f32 v124, v124
    v_mfma_f32_32x32x16_bf16 a[48:63], a[220:223], v[156:159], a[48:63]
    v_exp_f32 v125, v125
    v_exp_f32 v126, v126
    v_exp_f32 v127, v127
    v_add_f32 v244, v124, v125
    v_cvt_pk_bf16_f32 v164, v124, v125
    v_add_f32 v245, v126, v127
    v_cvt_pk_bf16_f32 v165, v126, v127
    v_add_f32 v244, v244, v245
    v_add_f32 v170, v170, v244
    s_waitcnt vmcnt(7)
    s_waitcnt lgkmcnt(0)
    s_barrier
    v_mfma_f32_32x32x16_bf16 a[0:15], a[224:227], v[160:163], a[0:15]
    ds_read_b128 a[96:99], v176 offset:0
    ds_read_b128 a[100:103], v177 offset:0
    v_max3_f32 v171, v56, v57, v58
    v_max3_f32 v173, v59, v60, v61
    v_max3_f32 v172, v120, v121, v122
    v_max3_f32 v171, v171, v62, v63
    v_mfma_f32_32x32x16_bf16 a[16:31], a[228:231], v[160:163], a[16:31]
    ds_read_b128 a[104:107], v178 offset:0
    ds_read_b128 a[108:111], v179 offset:0
    v_max3_f32 v173, v173, v64, v65
    v_max3_f32 v171, v171, v66, v67
    v_max3_f32 v173, v173, v68, v69
    v_max3_f32 v171, v171, v70, v71
    v_mfma_f32_32x32x16_bf16 a[32:47], a[232:235], v[160:163], a[32:47]
    ds_read_b128 a[112:115], v180 offset:0
    ds_read_b128 a[116:119], v181 offset:0
    v_max3_f32 v173, v173, v72, v73
    v_max3_f32 v171, v171, v74, v75
    v_max3_f32 v173, v173, v76, v77
    v_max3_f32 v171, v171, v78, v79
    v_mfma_f32_32x32x16_bf16 a[48:63], a[236:239], v[160:163], a[48:63]
    ds_read_b128 a[120:123], v182 offset:0
    ds_read_b128 a[124:127], v183 offset:0
    v_max3_f32 v173, v173, v80, v81
    v_max3_f32 v171, v171, v82, v83
    v_max3_f32 v173, v173, v84, v85
    v_max_f32 v172, v172, v123
    v_mfma_f32_16x16x16_bf16 a[64:67], a[240:241], v[164:165], a[64:67]
    ds_read_b128 a[160:163], v184 offset:0
    v_max3_f32 v171, v171, v86, v87
    v_mfma_f32_16x16x16_bf16 a[68:71], a[242:243], v[164:165], a[68:71]
    ds_read_b128 a[164:167], v185 offset:0
    v_max_f32 v171, v171, v173
    v_mfma_f32_16x16x16_bf16 a[72:75], a[244:245], v[164:165], a[72:75]
    ds_read_b128 a[168:171], v186 offset:0
    v_max_f32 v173, v171, v172
    v_mfma_f32_16x16x16_bf16 a[76:79], a[246:247], v[164:165], a[76:79]
    ds_read_b128 a[172:175], v187 offset:0
    v_cmp_lt_f32 vcc, s73, v173
    v_mfma_f32_16x16x16_bf16 a[80:83], a[248:249], v[164:165], a[80:83]
    ds_read_b128 a[128:131], v176 offset:8192
    v_mfma_f32_16x16x16_bf16 a[84:87], a[250:251], v[164:165], a[84:87]
    ds_read_b128 a[132:135], v177 offset:8192
    v_mfma_f32_16x16x16_bf16 a[88:91], a[252:253], v[164:165], a[88:91]
    ds_read_b128 a[136:139], v178 offset:8192
    v_mfma_f32_16x16x16_bf16 a[92:95], a[254:255], v[164:165], a[92:95]
    s_mov_b32 s66, 147456
    s_add_u32 m0, s71, 65536
    ds_read_b128 a[140:143], v179 offset:8192
    buffer_load_dwordx4 v204, s[32:35], s66 offen offset:0 nt lds
    s_cbranch_vccz L_ok_8
    s_call_b64 s[80:81], L_slow0
L_ok_8:
    s_waitcnt lgkmcnt(14)
    v_mfma_f32_32x32x16_bf16 v[88:103], a[96:99], v[8:11], v[128:143]
    ds_read_b128 a[144:147], v180 offset:8192
    ds_read_b128 a[148:151], v181 offset:8192
    v_exp_f32 v56, v56
    v_exp_f32 v57, v57
    v_mfma_f32_32x32x16_bf16 v[88:103], a[100:103], v[12:15], v[88:103]
    s_waitcnt lgkmcnt(14)
    ds_read_b128 a[152:155], v182 offset:8192
    v_exp_f32 v58, v58
    v_add_f32 v166, v166, v56
    v_exp_f32 v59, v59
    v_mfma_f32_32x32x16_bf16 v[88:103], a[104:107], v[16:19], v[88:103]
    ds_read_b128 a[156:159], v183 offset:8192
    ds_read_b64_tr_b16 a[176:177], v188 offset:32768
    buffer_load_dwordx4 v205, s[32:35], s66 offen offset:1024 nt lds
    v_add_f32 v167, v167, v57
    v_cvt_pk_bf16_f32 v148, v56, v57
    v_add_f32 v166, v166, v58
    v_mfma_f32_32x32x16_bf16 v[88:103], a[108:111], v[20:23], v[88:103]
    s_waitcnt lgkmcnt(14)
    ds_read_b64_tr_b16 a[178:179], v188 offset:34816
    v_exp_f32 v60, v60
    v_exp_f32 v61, v61
    v_add_f32 v167, v167, v59
    v_mfma_f32_32x32x16_bf16 v[88:103], a[112:115], v[24:27], v[88:103]
    ds_read_b64_tr_b16 a[180:181], v189 offset:32768
    ds_read_b64_tr_b16 a[182:183], v189 offset:34816
    v_cvt_pk_bf16_f32 v149, v58, v59
    v_exp_f32 v62, v62
    v_add_f32 v166, v166, v60
    v_mfma_f32_32x32x16_bf16 v[88:103], a[116:119], v[28:31], v[88:103]
    ds_read_b64_tr_b16 a[184:185], v190 offset:32768
    v_exp_f32 v63, v63
    v_add_f32 v167, v167, v61
    v_cvt_pk_bf16_f32 v150, v60, v61
    v_add_f32 v166, v166, v62
    v_mfma_f32_32x32x16_bf16 v[88:103], a[120:123], v[32:35], v[88:103]
    s_waitcnt lgkmcnt(14)
    ds_read_b64_tr_b16 a[186:187], v190 offset:34816
    ds_read_b64_tr_b16 a[188:189], v191 offset:32768
    buffer_load_dwordx4 v204, s[32:35], s66 offen offset:2048 nt lds
    v_add_f32 v167, v167, v63
    v_cvt_pk_bf16_f32 v151, v62, v63
    v_mfma_f32_32x32x16_bf16 v[88:103], a[124:127], v[36:39], v[88:103]
    ds_read_b64_tr_b16 a[190:191], v191 offset:34816
    v_exp_f32 v64, v64
    v_exp_f32 v65, v65
    v_add_f32 v166, v166, v64
    v_mfma_f32_16x16x32_bf16 v[124:127], a[160:163], v[40:43], v[144:147]
    ds_read_b64_tr_b16 a[192:193], v188 offset:36864
    v_add_f32 v167, v167, v65
    v_mfma_f32_16x16x32_bf16 v[124:127], a[164:167], v[44:47], v[124:127]
    ds_read_b64_tr_b16 a[194:195], v188 offset:38912
    v_cvt_pk_bf16_f32 v152, v64, v65
    v_mfma_f32_16x16x32_bf16 v[124:127], a[168:171], v[48:51], v[124:127]
    s_waitcnt lgkmcnt(14)
    ds_read_b64_tr_b16 a[196:197], v189 offset:36864
    buffer_load_dwordx4 v205, s[32:35], s66 offen offset:3072 nt lds
    v_mfma_f32_16x16x32_bf16 v[124:127], a[172:175], v[52:55], v[124:127]
    ds_read_b64_tr_b16 a[198:199], v189 offset:38912
    v_mfma_f32_32x32x16_bf16 v[104:119], a[128:131], v[8:11], v[128:143]
    ds_read_b64_tr_b16 a[200:201], v190 offset:36864
    ds_read_b64_tr_b16 a[202:203], v190 offset:38912
    v_exp_f32 v66, v66
    v_exp_f32 v67, v67
    v_mfma_f32_32x32x16_bf16 v[104:119], a[132:135], v[12:15], v[104:119]
    ds_read_b64_tr_b16 a[204:205], v191 offset:36864
    v_exp_f32 v68, v68
    v_add_f32 v166, v166, v66
    v_exp_f32 v69, v69
    v_mfma_f32_32x32x16_bf16 v[104:119], a[136:139], v[16:19], v[104:119]
    s_mov_b32 s66, 180224
    s_add_u32 m0, s71, 147456
    ds_read_b64_tr_b16 a[206:207], v191 offset:38912
    ds_read_b64_tr_b16 a[208:209], v188 offset:40960
    buffer_load_dwordx4 v200, s[28:31], s66 offen offset:0 nt lds
    v_add_f32 v167, v167, v67
    v_cvt_pk_bf16_f32 v153, v66, v67
    v_mfma_f32_32x32x16_bf16 v[104:119], a[140:143], v[20:23], v[104:119]
    s_waitcnt lgkmcnt(14)
    ds_read_b64_tr_b16 a[210:211], v188 offset:43008
    v_exp_f32 v70, v70
    v_add_f32 v166, v166, v68
    v_exp_f32 v71, v71
    v_mfma_f32_32x32x16_bf16 v[104:119], a[144:147], v[24:27], v[104:119]
    ds_read_b64_tr_b16 a[212:213], v189 offset:40960
    ds_read_b64_tr_b16 a[214:215], v189 offset:43008
    v_add_f32 v167, v167, v69
    v_cvt_pk_bf16_f32 v154, v68, v69
    v_add_f32 v166, v166, v70
    v_add_f32 v167, v167, v71
    v_mfma_f32_32x32x16_bf16 v[104:119], a[148:151], v[28:31], v[104:119]
    ds_read_b64_tr_b16 a[216:217], v190 offset:40960
    v_cvt_pk_bf16_f32 v155, v70, v71
    v_exp_f32 v72, v72
    v_exp_f32 v73, v73
    v_mfma_f32_32x32x16_bf16 v[104:119], a[152:155], v[32:35], v[104:119]
    ds_read_b64_tr_b16 a[218:219], v190 offset:43008
    ds_read_b64_tr_b16 a[220:221], v191 offset:40960
    buffer_load_dwordx4 v201, s[28:31], s66 offen offset:1024 nt lds
    v_exp_f32 v74, v74
    v_add_f32 v166, v166, v72
    v_mfma_f32_32x32x16_bf16 v[104:119], a[156:159], v[36:39], v[104:119]
    ds_read_b64_tr_b16 a[222:223], v191 offset:43008
    v_exp_f32 v75, v75
    v_add_f32 v167, v167, v73
    v_cvt_pk_bf16_f32 v156, v72, v73
    v_add_f32 v166, v166, v74
    v_mfma_f32_32x32x16_bf16 a[0:15], a[176:179], v[148:151], a[0:15]
    s_waitcnt lgkmcnt(14)
    ds_read_b64_tr_b16 a[224:225], v188 offset:45056
    ds_read_b64_tr_b16 a[226:227], v188 offset:47104
    v_exp_f32 v76, v76
    v_exp_f32 v77, v77
    v_mfma_f32_32x32x16_bf16 a[16:31], a[180:183], v[148:151], a[16:31]
    ds_read_b64_tr_b16 a[228:229], v189 offset:45056
    ds_read_b64_tr_b16 a[230:231], v189 offset:47104
    v_add_f32 v167, v167, v75
    v_cvt_pk_bf16_f32 v157, v74, v75
    v_exp_f32 v78, v78
    v_mfma_f32_32x32x16_bf16 a[32:47], a[184:187], v[148:151], a[32:47]
    ds_read_b64_tr_b16 a[232:233], v190 offset:45056
    ds_read_b64_tr_b16 a[234:235], v190 offset:47104
    buffer_load_dwordx4 v202, s[28:31], s66 offen offset:2048 nt lds
    v_add_f32 v166, v166, v76
    v_exp_f32 v79, v79
    v_mfma_f32_32x32x16_bf16 a[48:63], a[188:191], v[148:151], a[48:63]
    ds_read_b64_tr_b16 a[236:237], v191 offset:45056
    ds_read_b64_tr_b16 a[238:239], v191 offset:47104
    v_add_f32 v167, v167, v77
    v_cvt_pk_bf16_f32 v158, v76, v77
    v_add_f32 v166, v166, v78
    v_add_f32 v167, v167, v79
    v_mfma_f32_32x32x16_bf16 a[0:15], a[192:195], v[152:155], a[0:15]
    s_waitcnt lgkmcnt(14)
    ds_read_b64_tr_b16 a[240:241], v192 offset:32768
    ds_read_b64_tr_b16 a[242:243], v193 offset:32768
    v_cvt_pk_bf16_f32 v159, v78, v79
    v_exp_f32 v80, v80
    v_mfma_f32_32x32x16_bf16 a[16:31], a[196:199], v[152:155], a[16:31]
    ds_read_b64_tr_b16 a[244:245], v194 offset:32768
    ds_read_b64_tr_b16 a[246:247], v195 offset:32768
    v_exp_f32 v81, v81
    v_exp_f32 v82, v82
    v_mfma_f32_32x32x16_bf16 a[32:47], a[200:203], v[152:155], a[32:47]
    ds_read_b64_tr_b16 a[248:249], v196 offset:32768
    ds_read_b64_tr_b16 a[250:251], v197 offset:32768
    buffer_load_dwordx4 v203, s[28:31], s66 offen offset:3072 nt lds
    v_add_f32 v166, v166, v80
    v_exp_f32 v83, v83
    v_mfma_f32_32x32x16_bf16 a[48:63], a[204:207], v[152:155], a[48:63]
    ds_read_b64_tr_b16 a[252:253], v198 offset:32768
    ds_read_b64_tr_b16 a[254:255], v199 offset:32768
    v_add_f32 v167, v167, v81
    v_cvt_pk_bf16_f32 v160, v80, v81
    v_exp_f32 v84, v84
    v_mfma_f32_32x32x16_bf16 a[0:15], a[208:211], v[156:159], a[0:15]
    s_waitcnt lgkmcnt(14)
    v_add_f32 v166, v166, v82
    v_exp_f32 v85, v85
    v_add_f32 v167, v167, v83
    v_cvt_pk_bf16_f32 v161, v82, v83
    v_add_f32 v166, v166, v84
    v_mfma_f32_32x32x16_bf16 a[16:31], a[212:215], v[156:159], a[16:31]
    v_exp_f32 v86, v86
    v_exp_f32 v87, v87
    v_add_f32 v167, v167, v85
    v_cvt_pk_bf16_f32 v162, v84, v85
    v_mfma_f32_32x32x16_bf16 a[32:47], a[216:219], v[156:159], a[32:47]
    v_add_f32 v166, v166, v86
    v_add_f32 v167, v167, v87
    v_cvt_pk_bf16_f32 v163, v86, v87
    v_exp_f32 v120, v120
    v_mfma_f32_32x32x16_bf16 a[48:63], a[220:223], v[156:159], a[48:63]
    v_exp_f32 v121, v121
    v_exp_f32 v122, v122
    v_exp_f32 v123, v123
    v_add_f32 v244, v120, v121
    v_cvt_pk_bf16_f32 v164, v120, v121
    v_add_f32 v245, v122, v123
    v_cvt_pk_bf16_f32 v165, v122, v123
    v_add_f32 v244, v244, v245
    v_add_f32 v170, v170, v244
    s_waitcnt vmcnt(4)
    s_waitcnt lgkmcnt(0)
    s_barrier
    v_mfma_f32_32x32x16_bf16 a[0:15], a[224:227], v[160:163], a[0:15]
    ds_read_b128 a[96:99], v176 offset:16384
    ds_read_b128 a[100:103], v177 offset:16384
    v_max3_f32 v171, v88, v89, v90
    v_max3_f32 v173, v91, v92, v93
    v_max3_f32 v172, v124, v125, v126
    v_max3_f32 v171, v171, v94, v95
    v_mfma_f32_32x32x16_bf16 a[16:31], a[228:231], v[160:163], a[16:31]
    ds_read_b128 a[104:107], v178 offset:16384
    ds_read_b128 a[108:111], v179 offset:16384
    v_max3_f32 v173, v173, v96, v97
    v_max3_f32 v171, v171, v98, v99
    v_max3_f32 v173, v173, v100, v101
    v_max3_f32 v171, v171, v102, v103
    v_mfma_f32_32x32x16_bf16 a[32:47], a[232:235], v[160:163], a[32:47]
    ds_read_b128 a[112:115], v180 offset:16384
    ds_read_b128 a[116:119], v181 offset:16384
    v_max3_f32 v173, v173, v104, v105
    v_max3_f32 v171, v171, v106, v107
    v_max3_f32 v173, v173, v108, v109
    v_max3_f32 v171, v171, v110, v111
    v_mfma_f32_32x32x16_bf16 a[48:63], a[236:239], v[160:163], a[48:63]
    ds_read_b128 a[120:123], v182 offset:16384
    ds_read_b128 a[124:127], v183 offset:16384
    v_max3_f32 v173, v173, v112, v113
    v_max3_f32 v171, v171, v114, v115
    v_max3_f32 v173, v173, v116, v117
    v_max_f32 v172, v172, v127
    v_mfma_f32_16x16x16_bf16 a[64:67], a[240:241], v[164:165], a[64:67]
    ds_read_b128 a[160:163], v184 offset:16384
    v_max3_f32 v171, v171, v118, v119
    v_mfma_f32_16x16x16_bf16 a[68:71], a[242:243], v[164:165], a[68:71]
    ds_read_b128 a[164:167], v185 offset:16384
    v_max_f32 v171, v171, v173
    v_mfma_f32_16x16x16_bf16 a[72:75], a[244:245], v[164:165], a[72:75]
    ds_read_b128 a[168:171], v186 offset:16384
    v_max_f32 v173, v171, v172
    v_mfma_f32_16x16x16_bf16 a[76:79], a[246:247], v[164:165], a[76:79]
    ds_read_b128 a[172:175], v187 offset:16384
    v_cmp_lt_f32 vcc, s73, v173
    v_mfma_f32_16x16x16_bf16 a[80:83], a[248:249], v[164:165], a[80:83]
    ds_read_b128 a[128:131], v176 offset:24576
    v_mfma_f32_16x16x16_bf16 a[84:87], a[250:251], v[164:165], a[84:87]
    ds_read_b128 a[132:135], v177 offset:24576
    v_mfma_f32_16x16x16_bf16 a[88:91], a[252:253], v[164:165], a[88:91]
    ds_read_b128 a[136:139], v178 offset:24576
    v_mfma_f32_16x16x16_bf16 a[92:95], a[254:255], v[164:165], a[92:95]
    s_mov_b32 s66, 163840
    s_add_u32 m0, s71, 81920
    ds_read_b128 a[140:143], v179 offset:24576
    buffer_load_dwordx4 v204, s[32:35], s66 offen offset:0 nt lds
    s_cbranch_vccz L_ok_9
    s_call_b64 s[80:81], L_slow1
L_ok_9:
    s_waitcnt lgkmcnt(14)
    v_mfma_f32_32x32x16_bf16 v[56:71], a[96:99], v[8:11], v[128:143]
    ds_read_b128 a[144:147], v180 offset:24576
    ds_read_b128 a[148:151], v181 offset:24576
    v_exp_f32 v88, v88
    v_exp_f32 v89, v89
    v_mfma_f32_32x32x16_bf16 v[56:71], a[100:103], v[12:15], v[56:71]
    s_waitcnt lgkmcnt(14)
    ds_read_b128 a[152:155], v182 offset:24576
    v_exp_f32 v90, v90
    v_add_f32 v166, v166, v88
    v_exp_f32 v91, v91
    v_mfma_f32_32x32x16_bf16 v[56:71], a[104:107], v[16:19], v[56:71]
    ds_read_b128 a[156:159], v183 offset:24576
    ds_read_b64_tr_b16 a[176:177], v188 offset:0
    buffer_load_dwordx4 v205, s[32:35], s66 offen offset:1024 nt lds
    v_add_f32 v167, v167, v89
    v_cvt_pk_bf16_f32 v148, v88, v89
    v_add_f32 v166, v166, v90
    v_mfma_f32_32x32x16_bf16 v[56:71], a[108:111], v[20:23], v[56:71]
    s_waitcnt lgkmcnt(14)
    ds_read_b64_tr_b16 a[178:179], v188 offset:2048
    v_exp_f32 v92, v92
    v_exp_f32 v93, v93
    v_add_f32 v167, v167, v91
    v_mfma_f32_32x32x16_bf16 v[56:71], a[112:115], v[24:27], v[56:71]
    ds_read_b64_tr_b16 a[180:181], v189 offset:0
    ds_read_b64_tr_b16 a[182:183], v189 offset:2048
    v_cvt_pk_bf16_f32 v149, v90, v91
    v_exp_f32 v94, v94
    v_add_f32 v166, v166, v92
    v_mfma_f32_32x32x16_bf16 v[56:71], a[116:119], v[28:31], v[56:71]
    ds_read_b64_tr_b16 a[184:185], v190 offset:0
    v_exp_f32 v95, v95
    v_add_f32 v167, v167, v93
    v_cvt_pk_bf16_f32 v150, v92, v93
    v_add_f32 v166, v166, v94
    v_mfma_f32_32x32x16_bf16 v[56:71], a[120:123], v[32:35], v[56:71]
    s_waitcnt lgkmcnt(14)
    ds_read_b64_tr_b16 a[186:187], v190 offset:2048
    ds_read_b64_tr_b16 a[188:189], v191 offset:0
    buffer_load_dwordx4 v204, s[32:35], s66 offen offset:2048 nt lds
    v_add_f32 v167, v167, v95
    v_cvt_pk_bf16_f32 v151, v94, v95
    v_mfma_f32_32x32x16_bf16 v[56:71], a[124:127], v[36:39], v[56:71]
    ds_read_b64_tr_b16 a[190:191], v191 offset:2048
    v_exp_f32 v96, v96
    v_exp_f32 v97, v97
    v_add_f32 v166, v166, v96
    v_mfma_f32_16x16x32_bf16 v[120:123], a[160:163], v[40:43], v[144:147]
    ds_read_b64_tr_b16 a[192:193], v188 offset:4096
    v_add_f32 v167, v167, v97
    v_mfma_f32_16x16x32_bf16 v[120:123], a[164:167], v[44:47], v[120:123]
    ds_read_b64_tr_b16 a[194:195], v188 offset:6144
    v_cvt_pk_bf16_f32 v152, v96, v97
    v_mfma_f32_16x16x32_bf16 v[120:123], a[168:171], v[48:51], v[120:123]
    s_waitcnt lgkmcnt(14)
    ds_read_b64_tr_b16 a[196:197], v189 offset:4096
    buffer_load_dwordx4 v205, s[32:35], s66 offen offset:3072 nt lds
    v_mfma_f32_16x16x32_bf16 v[120:123], a[172:175], v[52:55], v[120:123]
    ds_read_b64_tr_b16 a[198:199], v189 offset:6144
    v_mfma_f32_32x32x16_bf16 v[72:87], a[128:131], v[8:11], v[128:143]
    ds_read_b64_tr_b16 a[200:201], v190 offset:4096
    ds_read_b64_tr_b16 a[202:203], v190 offset:6144
    v_exp_f32 v98, v98
    v_exp_f32 v99, v99
    v_mfma_f32_32x32x16_bf16 v[72:87], a[132:135], v[12:15], v[72:87]
    ds_read_b64_tr_b16 a[204:205], v191 offset:4096
    v_exp_f32 v100, v100
    v_add_f32 v166, v166, v98
    v_exp_f32 v101, v101
    v_mfma_f32_32x32x16_bf16 v[72:87], a[136:139], v[16:19], v[72:87]
    s_mov_b32 s66, 196608
    s_add_u32 m0, s71, 114688
    ds_read_b64_tr_b16 a[206:207], v191 offset:6144
    ds_read_b64_tr_b16 a[208:209], v188 offset:8192
    buffer_load_dwordx4 v200, s[28:31], s66 offen offset:0 nt lds
    v_add_f32 v167, v167, v99
    v_cvt_pk_bf16_f32 v153, v98, v99
    v_mfma_f32_32x32x16_bf16 v[72:87], a[140:143], v[20:23], v[72:87]
    s_waitcnt lgkmcnt(14)
    ds_read_b64_tr_b16 a[210:211], v188 offset:10240
    v_exp_f32 v102, v102
    v_add_f32 v166, v166, v100
    v_exp_f32 v103, v103
    v_mfma_f32_32x32x16_bf16 v[72:87], a[144:147], v[24:27], v[72:87]
    ds_read_b64_tr_b16 a[212:213], v189 offset:8192
    ds_read_b64_tr_b16 a[214:215], v189 offset:10240
    v_add_f32 v167, v167, v101
    v_cvt_pk_bf16_f32 v154, v100, v101
    v_add_f32 v166, v166, v102
    v_add_f32 v167, v167, v103
    v_mfma_f32_32x32x16_bf16 v[72:87], a[148:151], v[28:31], v[72:87]
    ds_read_b64_tr_b16 a[216:217], v190 offset:8192
    v_cvt_pk_bf16_f32 v155, v102, v103
    v_exp_f32 v104, v104
    v_exp_f32 v105, v105
    v_mfma_f32_32x32x16_bf16 v[72:87], a[152:155], v[32:35], v[72:87]
    ds_read_b64_tr_b16 a[218:219], v190 offset:10240
    ds_read_b64_tr_b16 a[220:221], v191 offset:8192
    buffer_load_dwordx4 v201, s[28:31], s66 offen offset:1024 nt lds
    v_exp_f32 v106, v106
    v_add_f32 v166, v166, v104
    v_mfma_f32_32x32x16_bf16 v[72:87], a[156:159], v[36:39], v[72:87]
    ds_read_b64_tr_b16 a[222:223], v191 offset:10240
    v_exp_f32 v107, v107
    v_add_f32 v167, v167, v105
    v_cvt_pk_bf16_f32 v156, v104, v105
    v_add_f32 v166, v166, v106
    v_mfma_f32_32x32x16_bf16 a[0:15], a[176:179], v[148:151], a[0:15]
    s_waitcnt lgkmcnt(14)
    ds_read_b64_tr_b16 a[224:225], v188 offset:12288
    ds_read_b64_tr_b16 a[226:227], v188 offset:14336
    v_exp_f32 v108, v108
    v_exp_f32 v109, v109
    v_mfma_f32_32x32x16_bf16 a[16:31], a[180:183], v[148:151], a[16:31]
    ds_read_b64_tr_b16 a[228:229], v189 offset:12288
    ds_read_b64_tr_b16 a[230:231], v189 offset:14336
    v_add_f32 v167, v167, v107
    v_cvt_pk_bf16_f32 v157, v106, v107
    v_exp_f32 v110, v110
    v_mfma_f32_32x32x16_bf16 a[32:47], a[184:187], v[148:151], a[32:47]
    ds_read_b64_tr_b16 a[232:233], v190 offset:12288
    ds_read_b64_tr_b16 a[234:235], v190 offset:14336
    buffer_load_dwordx4 v202, s[28:31], s66 offen offset:2048 nt lds
    v_add_f32 v166, v166, v108
    v_exp_f32 v111, v111
    v_mfma_f32_32x32x16_bf16 a[48:63], a[188:191], v[148:151], a[48:63]
    ds_read_b64_tr_b16 a[236:237], v191 offset:12288
    ds_read_b64_tr_b16 a[238:239], v191 offset:14336
    v_add_f32 v167, v167, v109
    v_cvt_pk_bf16_f32 v158, v108, v109
    v_add_f32 v166, v166, v110
    v_add_f32 v167, v167, v111
    v_mfma_f32_32x32x16_bf16 a[0:15], a[192:195], v[152:155], a[0:15]
    s_waitcnt lgkmcnt(14)
    ds_read_b64_tr_b16 a[240:241], v192 offset:0
    ds_read_b64_tr_b16 a[242:243], v193 offset:0
    v_cvt_pk_bf16_f32 v159, v110, v111
    v_exp_f32 v112, v112
    v_mfma_f32_32x32x16_bf16 a[16:31], a[196:199], v[152:155], a[16:31]
    ds_read_b64_tr_b16 a[244:245], v194 offset:0
    ds_read_b64_tr_b16 a[246:247], v195 offset:0
    v_exp_f32 v113, v113
    v_exp_f32 v114, v114
    v_mfma_f32_32x32x16_bf16 a[32:47], a[200:203], v[152:155], a[32:47]
    ds_read_b64_tr_b16 a[248:249], v196 offset:0
    ds_read_b64_tr_b16 a[250:251], v197 offset:0
    buffer_load_dwordx4 v203, s[28:31], s66 offen offset:3072 nt lds
    v_add_f32 v166, v166, v112
    v_exp_f32 v115, v115
    v_mfma_f32_32x32x16_bf16 a[48:63], a[204:207], v[152:155], a[48:63]
    ds_read_b64_tr_b16 a[252:253], v198 offset:0
    ds_read_b64_tr_b16 a[254:255], v199 offset:0
    v_add_f32 v167, v167, v113
    v_cvt_pk_bf16_f32 v160, v112, v113
    v_exp_f32 v116, v116
    v_mfma_f32_32x32x16_bf16 a[0:15], a[208:211], v[156:159], a[0:15]
    s_waitcnt lgkmcnt(14)
    v_add_f32 v166, v166, v114
    v_exp_f32 v117, v117
    v_add_f32 v167, v167, v115
    v_cvt_pk_bf16_f32 v161, v114, v115
    v_add_f32 v166, v166, v116
    v_mfma_f32_32x32x16_bf16 a[16:31], a[212:215], v[156:159], a[16:31]
    v_exp_f32 v118, v118
    v_exp_f32 v119, v119
    v_add_f32 v167, v167, v117
    v_cvt_pk_bf16_f32 v162, v116, v117
    v_mfma_f32_32x32x16_bf16 a[32:47], a[216:219], v[156:159], a[32:47]
    v_add_f32 v166, v166, v118
    v_add_f32 v167, v167, v119
    v_cvt_pk_bf16_f32 v163, v118, v119
    v_exp_f32 v124, v124
    v_mfma_f32_32x32x16_bf16 a[48:63], a[220:223], v[156:159], a[48:63]
    v_exp_f32 v125, v125
    v_exp_f32 v126, v126
    v_exp_f32 v127, v127
    v_add_f32 v244, v124, v125
    v_cvt_pk_bf16_f32 v164, v124, v125
    v_add_f32 v245, v126, v127
    v_cvt_pk_bf16_f32 v165, v126, v127
    v_add_f32 v244, v244, v245
    v_add_f32 v170, v170, v244
    s_waitcnt vmcnt(4)
    s_waitcnt lgkmcnt(0)
    s_barrier
    v_mfma_f32_32x32x16_bf16 a[0:15], a[224:227], v[160:163], a[0:15]
    ds_read_b128 a[96:99], v176 offset:32768
    ds_read_b128 a[100:103], v177 offset:32768
    v_max3_f32 v171, v56, v57, v58
    v_max3_f32 v173, v59, v60, v61
    v_max3_f32 v172, v120, v121, v122
    v_max3_f32 v171, v171, v62, v63
    v_mfma_f32_32x32x16_bf16 a[16:31], a[228:231], v[160:163], a[16:31]
    ds_read_b128 a[104:107], v178 offset:32768
    ds_read_b128 a[108:111], v179 offset:32768
    v_max3_f32 v173, v173, v64, v65
    v_max3_f32 v171, v171, v66, v67
    v_max3_f32 v173, v173, v68, v69
    v_max3_f32 v171, v171, v70, v71
    v_mfma_f32_32x32x16_bf16 a[32:47], a[232:235], v[160:163], a[32:47]
    ds_read_b128 a[112:115], v180 offset:32768
    ds_read_b128 a[116:119], v181 offset:32768
    v_max3_f32 v173, v173, v72, v73
    v_max3_f32 v171, v171, v74, v75
    v_max3_f32 v173, v173, v76, v77
    v_max3_f32 v171, v171, v78, v79
    v_mfma_f32_32x32x16_bf16 a[48:63], a[236:239], v[160:163], a[48:63]
    ds_read_b128 a[120:123], v182 offset:32768
    ds_read_b128 a[124:127], v183 offset:32768
    v_max3_f32 v173, v173, v80, v81
    v_max3_f32 v171, v171, v82, v83
    v_max3_f32 v173, v173, v84, v85
    v_max_f32 v172, v172, v123
    v_mfma_f32_16x16x16_bf16 a[64:67], a[240:241], v[164:165], a[64:67]
    ds_read_b128 a[160:163], v184 offset:32768
    v_max3_f32 v171, v171, v86, v87
    v_mfma_f32_16x16x16_bf16 a[68:71], a[242:243], v[164:165], a[68:71]
    ds_read_b128 a[164:167], v185 offset:32768
    v_max_f32 v171, v171, v173
    v_mfma_f32_16x16x16_bf16 a[72:75], a[244:245], v[164:165], a[72:75]
    ds_read_b128 a[168:171], v186 offset:32768
    v_max_f32 v173, v171, v172
    v_mfma_f32_16x16x16_bf16 a[76:79], a[246:247], v[164:165], a[76:79]
    ds_read_b128 a[172:175], v187 offset:32768
    v_cmp_lt_f32 vcc, s73, v173
    v_mfma_f32_16x16x16_bf16 a[80:83], a[248:249], v[164:165], a[80:83]
    ds_read_b128 a[128:131], v176 offset:40960
    v_mfma_f32_16x16x16_bf16 a[84:87], a[250:251], v[164:165], a[84:87]
    ds_read_b128 a[132:135], v177 offset:40960
    v_mfma_f32_16x16x16_bf16 a[88:91], a[252:253], v[164:165], a[88:91]
    ds_read_b128 a[136:139], v178 offset:40960
    v_mfma_f32_16x16x16_bf16 a[92:95], a[254:255], v[164:165], a[92:95]
    s_mov_b32 s66, 180224
    s_add_u32 m0, s71, 98304
    ds_read_b128 a[140:143], v179 offset:40960
    buffer_load_dwordx4 v204, s[32:35], s66 offen offset:0 nt lds
    s_cbranch_vccz L_ok_10
    s_call_b64 s[80:81], L_slow0
L_ok_10:
    s_waitcnt lgkmcnt(14)
    v_mfma_f32_32x32x16_bf16 v[88:103], a[96:99], v[8:11], v[128:143]
    ds_read_b128 a[144:147], v180 offset:40960
    ds_read_b128 a[148:151], v181 offset:40960
    v_exp_f32 v56, v56
    v_exp_f32 v57, v57
    v_mfma_f32_32x32x16_bf16 v[88:103], a[100:103], v[12:15], v[88:103]
    s_waitcnt lgkmcnt(14)
    ds_read_b128 a[152:155], v182 offset:40960
    v_exp_f32 v58, v58
    v_add_f32 v166, v166, v56
    v_exp_f32 v59, v59
    v_mfma_f32_32x32x16_bf16 v[88:103], a[104:107], v[16:19], v[88:103]
    ds_read_b128 a[156:159], v183 offset:40960
    ds_read_b64_tr_b16 a[176:177], v188 offset:16384
    buffer_load_dwordx4 v205, s[32:35], s66 offen offset:1024 nt lds
    v_add_f32 v167, v167, v57
    v_cvt_pk_bf16_f32 v148, v56, v57
    v_add_f32 v166, v166, v58
    v_mfma_f32_32x32x16_bf16 v[88:103], a[108:111], v[20:23], v[88:103]
    s_waitcnt lgkmcnt(14)
    ds_read_b64_tr_b16 a[178:179], v188 offset:18432
    v_exp_f32 v60, v60
    v_exp_f32 v61, v61
    v_add_f32 v167, v167, v59
    v_mfma_f32_32x32x16_bf16 v[88:103], a[112:115], v[24:27], v[88:103]
    ds_read_b64_tr_b16 a[180:181], v189 offset:16384
    ds_read_b64_tr_b16 a[182:183], v189 offset:18432
    v_cvt_pk_bf16_f32 v149, v58, v59
    v_exp_f32 v62, v62
    v_add_f32 v166, v166, v60
    v_mfma_f32_32x32x16_bf16 v[88:103], a[116:119], v[28:31], v[88:103]
    ds_read_b64_tr_b16 a[184:185], v190 offset:16384
    v_exp_f32 v63, v63
    v_add_f32 v167, v167, v61
    v_cvt_pk_bf16_f32 v150, v60, v61
    v_add_f32 v166, v166, v62
    v_mfma_f32_32x32x16_bf16 v[88:103], a[120:123], v[32:35], v[88:103]
    s_waitcnt lgkmcnt(14)
    ds_read_b64_tr_b16 a[186:187], v190 offset:18432
    ds_read_b64_tr_b16 a[188:189], v191 offset:16384
    buffer_load_dwordx4 v204, s[32:35], s66 offen offset:2048 nt lds
    v_add_f32 v167, v167, v63
    v_cvt_pk_bf16_f32 v151, v62, v63
    v_mfma_f32_32x32x16_bf16 v[88:103], a[124:127], v[36:39], v[88:103]
    ds_read_b64_tr_b16 a[190:191], v191 offset:18432
    v_exp_f32 v64, v64
    v_exp_f32 v65, v65
    v_add_f32 v166, v166, v64
    v_mfma_f32_16x16x32_bf16 v[124:127], a[160:163], v[40:43], v[144:147]
    ds_read_b64_tr_b16 a[192:193], v188 offset:20480
    v_add_f32 v167, v167, v65
    v_mfma_f32_16x16x32_bf16 v[124:127], a[164:167], v[44:47], v[124:127]
    ds_read_b64_tr_b16 a[194:195], v188 offset:22528
    v_cvt_pk_bf16_f32 v152, v64, v65
    v_mfma_f32_16x16x32_bf16 v[124:127], a[168:171], v[48:51], v[124:127]
    s_waitcnt lgkmcnt(14)
    ds_read_b64_tr_b16 a[196:197], v189 offset:20480
    buffer_load_dwordx4 v205, s[32:35], s66 offen offset:3072 nt lds
    v_mfma_f32_16x16x32_bf16 v[124:127], a[172:175], v[52:55], v[124:127]
    ds_read_b64_tr_b16 a[198:199], v189 offset:22528
    v_mfma_f32_32x32x16_bf16 v[104:119], a[128:131], v[8:11], v[128:143]
    ds_read_b64_tr_b16 a[200:201], v190 offset:20480
    ds_read_b64_tr_b16 a[202:203], v190 offset:22528
    v_exp_f32 v66, v66
    v_exp_f32 v67, v67
    v_mfma_f32_32x32x16_bf16 v[104:119], a[132:135], v[12:15], v[104:119]
    ds_read_b64_tr_b16 a[204:205], v191 offset:20480
    v_exp_f32 v68, v68
    v_add_f32 v166, v166, v66
    v_exp_f32 v69, v69
    v_mfma_f32_32x32x16_bf16 v[104:119], a[136:139], v[16:19], v[104:119]
    s_mov_b32 s66, 212992
    s_add_u32 m0, s71, 131072
    ds_read_b64_tr_b16 a[206:207], v191 offset:22528
    ds_read_b64_tr_b16 a[208:209], v188 offset:24576
    buffer_load_dwordx4 v200, s[28:31], s66 offen offset:0 nt lds
    v_add_f32 v167, v167, v67
    v_cvt_pk_bf16_f32 v153, v66, v67
    v_mfma_f32_32x32x16_bf16 v[104:119], a[140:143], v[20:23], v[104:119]
    s_waitcnt lgkmcnt(14)
    ds_read_b64_tr_b16 a[210:211], v188 offset:26624
    v_exp_f32 v70, v70
    v_add_f32 v166, v166, v68
    v_exp_f32 v71, v71
    v_mfma_f32_32x32x16_bf16 v[104:119], a[144:147], v[24:27], v[104:119]
    ds_read_b64_tr_b16 a[212:213], v189 offset:24576
    ds_read_b64_tr_b16 a[214:215], v189 offset:26624
    v_add_f32 v167, v167, v69
    v_cvt_pk_bf16_f32 v154, v68, v69
    v_add_f32 v166, v166, v70
    v_add_f32 v167, v167, v71
    v_mfma_f32_32x32x16_bf16 v[104:119], a[148:151], v[28:31], v[104:119]
    ds_read_b64_tr_b16 a[216:217], v190 offset:24576
    v_cvt_pk_bf16_f32 v155, v70, v71
    v_exp_f32 v72, v72
    v_exp_f32 v73, v73
    v_mfma_f32_32x32x16_bf16 v[104:119], a[152:155], v[32:35], v[104:119]
    ds_read_b64_tr_b16 a[218:219], v190 offset:26624
    ds_read_b64_tr_b16 a[220:221], v191 offset:24576
    buffer_load_dwordx4 v201, s[28:31], s66 offen offset:1024 nt lds
    v_exp_f32 v74, v74
    v_add_f32 v166, v166, v72
    v_mfma_f32_32x32x16_bf16 v[104:119], a[156:159], v[36:39], v[104:119]
    ds_read_b64_tr_b16 a[222:223], v191 offset:26624
    v_exp_f32 v75, v75
    v_add_f32 v167, v167, v73
    v_cvt_pk_bf16_f32 v156, v72, v73
    v_add_f32 v166, v166, v74
    v_mfma_f32_32x32x16_bf16 a[0:15], a[176:179], v[148:151], a[0:15]
    s_waitcnt lgkmcnt(14)
    ds_read_b64_tr_b16 a[224:225], v188 offset:28672
    ds_read_b64_tr_b16 a[226:227], v188 offset:30720
    v_exp_f32 v76, v76
    v_exp_f32 v77, v77
    v_mfma_f32_32x32x16_bf16 a[16:31], a[180:183], v[148:151], a[16:31]
    ds_read_b64_tr_b16 a[228:229], v189 offset:28672
    ds_read_b64_tr_b16 a[230:231], v189 offset:30720
    v_add_f32 v167, v167, v75
    v_cvt_pk_bf16_f32 v157, v74, v75
    v_exp_f32 v78, v78
    v_mfma_f32_32x32x16_bf16 a[32:47], a[184:187], v[148:151], a[32:47]
    ds_read_b64_tr_b16 a[232:233], v190 offset:28672
    ds_read_b64_tr_b16 a[234:235], v190 offset:30720
    buffer_load_dwordx4 v202, s[28:31], s66 offen offset:2048 nt lds
    v_add_f32 v166, v166, v76
    v_exp_f32 v79, v79
    v_mfma_f32_32x32x16_bf16 a[48:63], a[188:191], v[148:151], a[48:63]
    ds_read_b64_tr_b16 a[236:237], v191 offset:28672
    ds_read_b64_tr_b16 a[238:239], v191 offset:30720
    v_add_f32 v167, v167, v77
    v_cvt_pk_bf16_f32 v158, v76, v77
    v_add_f32 v166, v166, v78
    v_add_f32 v167, v167, v79
    v_mfma_f32_32x32x16_bf16 a[0:15], a[192:195], v[152:155], a[0:15]
    s_waitcnt lgkmcnt(14)
    ds_read_b64_tr_b16 a[240:241], v192 offset:16384
    ds_read_b64_tr_b16 a[242:243], v193 offset:16384
    v_cvt_pk_bf16_f32 v159, v78, v79
    v_exp_f32 v80, v80
    v_mfma_f32_32x32x16_bf16 a[16:31], a[196:199], v[152:155], a[16:31]
    ds_read_b64_tr_b16 a[244:245], v194 offset:16384
    ds_read_b64_tr_b16 a[246:247], v195 offset:16384
    v_exp_f32 v81, v81
    v_exp_f32 v82, v82
    v_mfma_f32_32x32x16_bf16 a[32:47], a[200:203], v[152:155], a[32:47]
    ds_read_b64_tr_b16 a[248:249], v196 offset:16384
    ds_read_b64_tr_b16 a[250:251], v197 offset:16384
    buffer_load_dwordx4 v203, s[28:31], s66 offen offset:3072 nt lds
    v_add_f32 v166, v166, v80
    v_exp_f32 v83, v83
    v_mfma_f32_32x32x16_bf16 a[48:63], a[204:207], v[152:155], a[48:63]
    ds_read_b64_tr_b16 a[252:253], v198 offset:16384
    ds_read_b64_tr_b16 a[254:255], v199 offset:16384
    v_add_f32 v167, v167, v81
    v_cvt_pk_bf16_f32 v160, v80, v81
    v_exp_f32 v84, v84
    v_mfma_f32_32x32x16_bf16 a[0:15], a[208:211], v[156:159], a[0:15]
    s_waitcnt lgkmcnt(14)
    v_add_f32 v166, v166, v82
    v_exp_f32 v85, v85
    v_add_f32 v167, v167, v83
    v_cvt_pk_bf16_f32 v161, v82, v83
    v_add_f32 v166, v166, v84
    v_mfma_f32_32x32x16_bf16 a[16:31], a[212:215], v[156:159], a[16:31]
    v_exp_f32 v86, v86
    v_exp_f32 v87, v87
    v_add_f32 v167, v167, v85
    v_cvt_pk_bf16_f32 v162, v84, v85
    v_mfma_f32_32x32x16_bf16 a[32:47], a[216:219], v[156:159], a[32:47]
    v_add_f32 v166, v166, v86
    v_add_f32 v167, v167, v87
    v_cvt_pk_bf16_f32 v163, v86, v87
    v_exp_f32 v120, v120
    v_mfma_f32_32x32x16_bf16 a[48:63], a[220:223], v[156:159], a[48:63]
    v_exp_f32 v121, v121
    v_exp_f32 v122, v122
    v_exp_f32 v123, v123
    v_add_f32 v244, v120, v121
    v_cvt_pk_bf16_f32 v164, v120, v121
    v_add_f32 v245, v122, v123
    v_cvt_pk_bf16_f32 v165, v122, v123
    v_add_f32 v244, v244, v245
    v_add_f32 v170, v170, v244
    s_waitcnt vmcnt(4)
    s_waitcnt lgkmcnt(0)
    s_barrier
    v_mfma_f32_32x32x16_bf16 a[0:15], a[224:227], v[160:163], a[0:15]
    ds_read_b128 a[96:99], v176 offset:0
    ds_read_b128 a[100:103], v177 offset:0
    v_max3_f32 v171, v88, v89, v90
    v_max3_f32 v173, v91, v92, v93
    v_max3_f32 v172, v124, v125, v126
    v_max3_f32 v171, v171, v94, v95
    v_mfma_f32_32x32x16_bf16 a[16:31], a[228:231], v[160:163], a[16:31]
    ds_read_b128 a[104:107], v178 offset:0
    ds_read_b128 a[108:111], v179 offset:0
    v_max3_f32 v173, v173, v96, v97
    v_max3_f32 v171, v171, v98, v99
    v_max3_f32 v173, v173, v100, v101
    v_max3_f32 v171, v171, v102, v103
    v_mfma_f32_32x32x16_bf16 a[32:47], a[232:235], v[160:163], a[32:47]
    ds_read_b128 a[112:115], v180 offset:0
    ds_read_b128 a[116:119], v181 offset:0
    v_max3_f32 v173, v173, v104, v105
    v_max3_f32 v171, v171, v106, v107
    v_max3_f32 v173, v173, v108, v109
    v_max3_f32 v171, v171, v110, v111
    v_mfma_f32_32x32x16_bf16 a[48:63], a[236:239], v[160:163], a[48:63]
    ds_read_b128 a[120:123], v182 offset:0
    ds_read_b128 a[124:127], v183 offset:0
    v_max3_f32 v173, v173, v112, v113
    v_max3_f32 v171, v171, v114, v115
    v_max3_f32 v173, v173, v116, v117
    v_max_f32 v172, v172, v127
    v_mfma_f32_16x16x16_bf16 a[64:67], a[240:241], v[164:165], a[64:67]
    ds_read_b128 a[160:163], v184 offset:0
    v_max3_f32 v171, v171, v118, v119
    v_mfma_f32_16x16x16_bf16 a[68:71], a[242:243], v[164:165], a[68:71]
    ds_read_b128 a[164:167], v185 offset:0
    v_max_f32 v171, v171, v173
    v_mfma_f32_16x16x16_bf16 a[72:75], a[244:245], v[164:165], a[72:75]
    ds_read_b128 a[168:171], v186 offset:0
    v_max_f32 v173, v171, v172
    v_mfma_f32_16x16x16_bf16 a[76:79], a[246:247], v[164:165], a[76:79]
    ds_read_b128 a[172:175], v187 offset:0
    v_cmp_lt_f32 vcc, s73, v173
    v_mfma_f32_16x16x16_bf16 a[80:83], a[248:249], v[164:165], a[80:83]
    ds_read_b128 a[128:131], v176 offset:8192
    v_mfma_f32_16x16x16_bf16 a[84:87], a[250:251], v[164:165], a[84:87]
    ds_read_b128 a[132:135], v177 offset:8192
    v_mfma_f32_16x16x16_bf16 a[88:91], a[252:253], v[164:165], a[88:91]
    ds_read_b128 a[136:139], v178 offset:8192
    v_mfma_f32_16x16x16_bf16 a[92:95], a[254:255], v[164:165], a[92:95]
    s_mov_b32 s66, 196608
    s_add_u32 m0, s71, 65536
    ds_read_b128 a[140:143], v179 offset:8192
    buffer_load_dwordx4 v204, s[32:35], s66 offen offset:0 nt lds
    s_cbranch_vccz L_ok_11
    s_call_b64 s[80:81], L_slow1
L_ok_11:
    s_waitcnt lgkmcnt(14)
    v_mfma_f32_32x32x16_bf16 v[56:71], a[96:99], v[8:11], v[128:143]
    ds_read_b128 a[144:147], v180 offset:8192
    ds_read_b128 a[148:151], v181 offset:8192
    v_exp_f32 v88, v88
    v_exp_f32 v89, v89
    v_mfma_f32_32x32x16_bf16 v[56:71], a[100:103], v[12:15], v[56:71]
    s_waitcnt lgkmcnt(14)
    ds_read_b128 a[152:155], v182 offset:8192
    v_exp_f32 v90, v90
    v_add_f32 v166, v166, v88
    v_exp_f32 v91, v91
    v_mfma_f32_32x32x16_bf16 v[56:71], a[104:107], v[16:19], v[56:71]
    ds_read_b128 a[156:159], v183 offset:8192
    ds_read_b64_tr_b16 a[176:177], v188 offset:32768
    buffer_load_dwordx4 v205, s[32:35], s66 offen offset:1024 nt lds
    v_add_f32 v167, v167, v89
    v_cvt_pk_bf16_f32 v148, v88, v89
    v_add_f32 v166, v166, v90
    v_mfma_f32_32x32x16_bf16 v[56:71], a[108:111], v[20:23], v[56:71]
    s_waitcnt lgkmcnt(14)
    ds_read_b64_tr_b16 a[178:179], v188 offset:34816
    v_exp_f32 v92, v92
    v_exp_f32 v93, v93
    v_add_f32 v167, v167, v91
    v_mfma_f32_32x32x16_bf16 v[56:71], a[112:115], v[24:27], v[56:71]
    ds_read_b64_tr_b16 a[180:181], v189 offset:32768
    ds_read_b64_tr_b16 a[182:183], v189 offset:34816
    v_cvt_pk_bf16_f32 v149, v90, v91
    v_exp_f32 v94, v94
    v_add_f32 v166, v166, v92
    v_mfma_f32_32x32x16_bf16 v[56:71], a[116:119], v[28:31], v[56:71]
    ds_read_b64_tr_b16 a[184:185], v190 offset:32768
    v_exp_f32 v95, v95
    v_add_f32 v167, v167, v93
    v_cvt_pk_bf16_f32 v150, v92, v93
    v_add_f32 v166, v166, v94
    v_mfma_f32_32x32x16_bf16 v[56:71], a[120:123], v[32:35], v[56:71]
    s_waitcnt lgkmcnt(14)
    ds_read_b64_tr_b16 a[186:187], v190 offset:34816
    ds_read_b64_tr_b16 a[188:189], v191 offset:32768
    buffer_load_dwordx4 v204, s[32:35], s66 offen offset:2048 nt lds
    v_add_f32 v167, v167, v95
    v_cvt_pk_bf16_f32 v151, v94, v95
    v_mfma_f32_32x32x16_bf16 v[56:71], a[124:127], v[36:39], v[56:71]
    ds_read_b64_tr_b16 a[190:191], v191 offset:34816
    v_exp_f32 v96, v96
    v_exp_f32 v97, v97
    v_add_f32 v166, v166, v96
    v_mfma_f32_16x16x32_bf16 v[120:123], a[160:163], v[40:43], v[144:147]
    ds_read_b64_tr_b16 a[192:193], v188 offset:36864
    v_add_f32 v167, v167, v97
    v_mfma_f32_16x16x32_bf16 v[120:123], a[164:167], v[44:47], v[120:123]
    ds_read_b64_tr_b16 a[194:195], v188 offset:38912
    v_cvt_pk_bf16_f32 v152, v96, v97
    v_mfma_f32_16x16x32_bf16 v[120:123], a[168:171], v[48:51], v[120:123]
    s_waitcnt lgkmcnt(14)
    ds_read_b64_tr_b16 a[196:197], v189 offset:36864
    buffer_load_dwordx4 v205, s[32:35], s66 offen offset:3072 nt lds
    v_mfma_f32_16x16x32_bf16 v[120:123], a[172:175], v[52:55], v[120:123]
    ds_read_b64_tr_b16 a[198:199], v189 offset:38912
    v_mfma_f32_32x32x16_bf16 v[72:87], a[128:131], v[8:11], v[128:143]
    ds_read_b64_tr_b16 a[200:201], v190 offset:36864
    ds_read_b64_tr_b16 a[202:203], v190 offset:38912
    v_exp_f32 v98, v98
    v_exp_f32 v99, v99
    v_mfma_f32_32x32x16_bf16 v[72:87], a[132:135], v[12:15], v[72:87]
    ds_read_b64_tr_b16 a[204:205], v191 offset:36864
    v_exp_f32 v100, v100
    v_add_f32 v166, v166, v98
    v_exp_f32 v101, v101
    v_mfma_f32_32x32x16_bf16 v[72:87], a[136:139], v[16:19], v[72:87]
    s_mov_b32 s66, 229376
    s_add_u32 m0, s71, 147456
    ds_read_b64_tr_b16 a[206:207], v191 offset:38912
    ds_read_b64_tr_b16 a[208:209], v188 offset:40960
    buffer_load_dwordx4 v200, s[28:31], s66 offen offset:0 nt lds
    v_add_f32 v167, v167, v99
    v_cvt_pk_bf16_f32 v153, v98, v99
    v_mfma_f32_32x32x16_bf16 v[72:87], a[140:143], v[20:23], v[72:87]
    s_waitcnt lgkmcnt(14)
    ds_read_b64_tr_b16 a[210:211], v188 offset:43008
    v_exp_f32 v102, v102
    v_add_f32 v166, v166, v100
    v_exp_f32 v103, v103
    v_mfma_f32_32x32x16_bf16 v[72:87], a[144:147], v[24:27], v[72:87]
    ds_read_b64_tr_b16 a[212:213], v189 offset:40960
    ds_read_b64_tr_b16 a[214:215], v189 offset:43008
    v_add_f32 v167, v167, v101
    v_cvt_pk_bf16_f32 v154, v100, v101
    v_add_f32 v166, v166, v102
    v_add_f32 v167, v167, v103
    v_mfma_f32_32x32x16_bf16 v[72:87], a[148:151], v[28:31], v[72:87]
    ds_read_b64_tr_b16 a[216:217], v190 offset:40960
    v_cvt_pk_bf16_f32 v155, v102, v103
    v_exp_f32 v104, v104
    v_exp_f32 v105, v105
    v_mfma_f32_32x32x16_bf16 v[72:87], a[152:155], v[32:35], v[72:87]
    ds_read_b64_tr_b16 a[218:219], v190 offset:43008
    ds_read_b64_tr_b16 a[220:221], v191 offset:40960
    buffer_load_dwordx4 v201, s[28:31], s66 offen offset:1024 nt lds
    v_exp_f32 v106, v106
    v_add_f32 v166, v166, v104
    v_mfma_f32_32x32x16_bf16 v[72:87], a[156:159], v[36:39], v[72:87]
    ds_read_b64_tr_b16 a[222:223], v191 offset:43008
    v_exp_f32 v107, v107
    v_add_f32 v167, v167, v105
    v_cvt_pk_bf16_f32 v156, v104, v105
    v_add_f32 v166, v166, v106
    v_mfma_f32_32x32x16_bf16 a[0:15], a[176:179], v[148:151], a[0:15]
    s_waitcnt lgkmcnt(14)
    ds_read_b64_tr_b16 a[224:225], v188 offset:45056
    ds_read_b64_tr_b16 a[226:227], v188 offset:47104
    v_exp_f32 v108, v108
    v_exp_f32 v109, v109
    v_mfma_f32_32x32x16_bf16 a[16:31], a[180:183], v[148:151], a[16:31]
    ds_read_b64_tr_b16 a[228:229], v189 offset:45056
    ds_read_b64_tr_b16 a[230:231], v189 offset:47104
    v_add_f32 v167, v167, v107
    v_cvt_pk_bf16_f32 v157, v106, v107
    v_exp_f32 v110, v110
    v_mfma_f32_32x32x16_bf16 a[32:47], a[184:187], v[148:151], a[32:47]
    ds_read_b64_tr_b16 a[232:233], v190 offset:45056
    ds_read_b64_tr_b16 a[234:235], v190 offset:47104
    buffer_load_dwordx4 v202, s[28:31], s66 offen offset:2048 nt lds
    v_add_f32 v166, v166, v108
    v_exp_f32 v111, v111
    v_mfma_f32_32x32x16_bf16 a[48:63], a[188:191], v[148:151], a[48:63]
    ds_read_b64_tr_b16 a[236:237], v191 offset:45056
    ds_read_b64_tr_b16 a[238:239], v191 offset:47104
    v_add_f32 v167, v167, v109
    v_cvt_pk_bf16_f32 v158, v108, v109
    v_add_f32 v166, v166, v110
    v_add_f32 v167, v167, v111
    v_mfma_f32_32x32x16_bf16 a[0:15], a[192:195], v[152:155], a[0:15]
    s_waitcnt lgkmcnt(14)
    ds_read_b64_tr_b16 a[240:241], v192 offset:32768
    ds_read_b64_tr_b16 a[242:243], v193 offset:32768
    v_cvt_pk_bf16_f32 v159, v110, v111
    v_exp_f32 v112, v112
    v_mfma_f32_32x32x16_bf16 a[16:31], a[196:199], v[152:155], a[16:31]
    ds_read_b64_tr_b16 a[244:245], v194 offset:32768
    ds_read_b64_tr_b16 a[246:247], v195 offset:32768
    v_exp_f32 v113, v113
    v_exp_f32 v114, v114
    v_mfma_f32_32x32x16_bf16 a[32:47], a[200:203], v[152:155], a[32:47]
    ds_read_b64_tr_b16 a[248:249], v196 offset:32768
    ds_read_b64_tr_b16 a[250:251], v197 offset:32768
    buffer_load_dwordx4 v203, s[28:31], s66 offen offset:3072 nt lds
    v_add_f32 v166, v166, v112
    v_exp_f32 v115, v115
    v_mfma_f32_32x32x16_bf16 a[48:63], a[204:207], v[152:155], a[48:63]
    ds_read_b64_tr_b16 a[252:253], v198 offset:32768
    ds_read_b64_tr_b16 a[254:255], v199 offset:32768
    v_add_f32 v167, v167, v113
    v_cvt_pk_bf16_f32 v160, v112, v113
    v_exp_f32 v116, v116
    v_mfma_f32_32x32x16_bf16 a[0:15], a[208:211], v[156:159], a[0:15]
    s_waitcnt lgkmcnt(14)
    v_add_f32 v166, v166, v114
    v_exp_f32 v117, v117
    v_add_f32 v167, v167, v115
    v_cvt_pk_bf16_f32 v161, v114, v115
    v_add_f32 v166, v166, v116
    v_mfma_f32_32x32x16_bf16 a[16:31], a[212:215], v[156:159], a[16:31]
    v_exp_f32 v118, v118
    v_exp_f32 v119, v119
    v_add_f32 v167, v167, v117
    v_cvt_pk_bf16_f32 v162, v116, v117
    v_mfma_f32_32x32x16_bf16 a[32:47], a[216:219], v[156:159], a[32:47]
    v_add_f32 v166, v166, v118
    v_add_f32 v167, v167, v119
    v_cvt_pk_bf16_f32 v163, v118, v119
    v_exp_f32 v124, v124
    v_mfma_f32_32x32x16_bf16 a[48:63], a[220:223], v[156:159], a[48:63]
    v_exp_f32 v125, v125
    v_exp_f32 v126, v126
    v_exp_f32 v127, v127
    v_add_f32 v244, v124, v125
    v_cvt_pk_bf16_f32 v164, v124, v125
    v_add_f32 v245, v126, v127
    v_cvt_pk_bf16_f32 v165, v126, v127
    v_add_f32 v244, v244, v245
    v_add_f32 v170, v170, v244
    s_waitcnt vmcnt(4)
    s_waitcnt lgkmcnt(0)
    s_barrier
    v_mfma_f32_32x32x16_bf16 a[0:15], a[224:227], v[160:163], a[0:15]
    ds_read_b128 a[96:99], v176 offset:16384
    ds_read_b128 a[100:103], v177 offset:16384
    v_max3_f32 v171, v56, v57, v58
    v_max3_f32 v173, v59, v60, v61
    v_max3_f32 v172, v120, v121, v122
    v_max3_f32 v171, v171, v62, v63
    v_mfma_f32_32x32x16_bf16 a[16:31], a[228:231], v[160:163], a[16:31]
    ds_read_b128 a[104:107], v178 offset:16384
    ds_read_b128 a[108:111], v179 offset:16384
    v_max3_f32 v173, v173, v64, v65
    v_max3_f32 v171, v171, v66, v67
    v_max3_f32 v173, v173, v68, v69
    v_max3_f32 v171, v171, v70, v71
    v_mfma_f32_32x32x16_bf16 a[32:47], a[232:235], v[160:163], a[32:47]
    ds_read_b128 a[112:115], v180 offset:16384
    ds_read_b128 a[116:119], v181 offset:16384
    v_max3_f32 v173, v173, v72, v73
    v_max3_f32 v171, v171, v74, v75
    v_max3_f32 v173, v173, v76, v77
    v_max3_f32 v171, v171, v78, v79
    v_mfma_f32_32x32x16_bf16 a[48:63], a[236:239], v[160:163], a[48:63]
    ds_read_b128 a[120:123], v182 offset:16384
    ds_read_b128 a[124:127], v183 offset:16384
    v_max3_f32 v173, v173, v80, v81
    v_max3_f32 v171, v171, v82, v83
    v_max3_f32 v173, v173, v84, v85
    v_max_f32 v172, v172, v123
    v_mfma_f32_16x16x16_bf16 a[64:67], a[240:241], v[164:165], a[64:67]
    ds_read_b128 a[160:163], v184 offset:16384
    v_max3_f32 v171, v171, v86, v87
    v_mfma_f32_16x16x16_bf16 a[68:71], a[242:243], v[164:165], a[68:71]
    ds_read_b128 a[164:167], v185 offset:16384
    v_max_f32 v171, v171, v173
    v_mfma_f32_16x16x16_bf16 a[72:75], a[244:245], v[164:165], a[72:75]
    ds_read_b128 a[168:171], v186 offset:16384
    v_max_f32 v173, v171, v172
    v_mfma_f32_16x16x16_bf16 a[76:79], a[246:247], v[164:165], a[76:79]
    ds_read_b128 a[172:175], v187 offset:16384
    v_cmp_lt_f32 vcc, s73, v173
    v_mfma_f32_16x16x16_bf16 a[80:83], a[248:249], v[164:165], a[80:83]
    ds_read_b128 a[128:131], v176 offset:24576
    v_mfma_f32_16x16x16_bf16 a[84:87], a[250:251], v[164:165], a[84:87]
    ds_read_b128 a[132:135], v177 offset:24576
    v_mfma_f32_16x16x16_bf16 a[88:91], a[252:253], v[164:165], a[88:91]
    ds_read_b128 a[136:139], v178 offset:24576
    v_mfma_f32_16x16x16_bf16 a[92:95], a[254:255], v[164:165], a[92:95]
    s_mov_b32 s66, 212992
    s_add_u32 m0, s71, 81920
    ds_read_b128 a[140:143], v179 offset:24576
    buffer_load_dwordx4 v204, s[32:35], s66 offen offset:0 nt lds
    s_cbranch_vccz L_ok_12
    s_call_b64 s[80:81], L_slow0
L_ok_12:
    s_waitcnt lgkmcnt(14)
    v_mfma_f32_32x32x16_bf16 v[88:103], a[96:99], v[8:11], v[128:143]
    ds_read_b128 a[144:147], v180 offset:24576
    ds_read_b128 a[148:151], v181 offset:24576
    v_exp_f32 v56, v56
    v_exp_f32 v57, v57
    v_mfma_f32_32x32x16_bf16 v[88:103], a[100:103], v[12:15], v[88:103]
    s_waitcnt lgkmcnt(14)
    ds_read_b128 a[152:155], v182 offset:24576
    v_exp_f32 v58, v58
    v_add_f32 v166, v166, v56
    v_exp_f32 v59, v59
    v_mfma_f32_32x32x16_bf16 v[88:103], a[104:107], v[16:19], v[88:103]
    ds_read_b128 a[156:159], v183 offset:24576
    ds_read_b64_tr_b16 a[176:177], v188 offset:0
    buffer_load_dwordx4 v205, s[32:35], s66 offen offset:1024 nt lds
    v_add_f32 v167, v167, v57
    v_cvt_pk_bf16_f32 v148, v56, v57
    v_add_f32 v166, v166, v58
    v_mfma_f32_32x32x16_bf16 v[88:103], a[108:111], v[20:23], v[88:103]
    s_waitcnt lgkmcnt(14)
    ds_read_b64_tr_b16 a[178:179], v188 offset:2048
    v_exp_f32 v60, v60
    v_exp_f32 v61, v61
    v_add_f32 v167, v167, v59
    v_mfma_f32_32x32x16_bf16 v[88:103], a[112:115], v[24:27], v[88:103]
    ds_read_b64_tr_b16 a[180:181], v189 offset:0
    ds_read_b64_tr_b16 a[182:183], v189 offset:2048
    v_cvt_pk_bf16_f32 v149, v58, v59
    v_exp_f32 v62, v62
    v_add_f32 v166, v166, v60
    v_mfma_f32_32x32x16_bf16 v[88:103], a[116:119], v[28:31], v[88:103]
    ds_read_b64_tr_b16 a[184:185], v190 offset:0
    buffer_load_dwordx4 v204, s[32:35], s66 offen offset:2048 nt lds
    v_exp_f32 v63, v63
    v_add_f32 v167, v167, v61
    v_cvt_pk_bf16_f32 v150, v60, v61
    v_mfma_f32_32x32x16_bf16 v[88:103], a[120:123], v[32:35], v[88:103]
    s_waitcnt lgkmcnt(14)
    ds_read_b64_tr_b16 a[186:187], v190 offset:2048
    ds_read_b64_tr_b16 a[188:189], v191 offset:0
    v_add_f32 v166, v166, v62
    v_add_f32 v167, v167, v63
    v_cvt_pk_bf16_f32 v151, v62, v63
    v_mfma_f32_32x32x16_bf16 v[88:103], a[124:127], v[36:39], v[88:103]
    ds_read_b64_tr_b16 a[190:191], v191 offset:2048
    v_exp_f32 v64, v64
    v_exp_f32 v65, v65
    v_add_f32 v166, v166, v64
    v_mfma_f32_16x16x32_bf16 v[124:127], a[160:163], v[40:43], v[144:147]
    ds_read_b64_tr_b16 a[192:193], v188 offset:4096
    buffer_load_dwordx4 v205, s[32:35], s66 offen offset:3072 nt lds
    v_mfma_f32_16x16x32_bf16 v[124:127], a[164:167], v[44:47], v[124:127]
    ds_read_b64_tr_b16 a[194:195], v188 offset:6144
    v_add_f32 v167, v167, v65
    v_mfma_f32_16x16x32_bf16 v[124:127], a[168:171], v[48:51], v[124:127]
    s_waitcnt lgkmcnt(14)
    ds_read_b64_tr_b16 a[196:197], v189 offset:4096
    v_cvt_pk_bf16_f32 v152, v64, v65
    v_mfma_f32_16x16x32_bf16 v[124:127], a[172:175], v[52:55], v[124:127]
    s_mov_b32 s66, 245760
    s_add_u32 m0, s71, 114688
    ds_read_b64_tr_b16 a[198:199], v189 offset:6144
    buffer_load_dwordx4 v200, s[28:31], s66 offen offset:0 nt lds
    v_mfma_f32_32x32x16_bf16 v[104:119], a[128:131], v[8:11], v[128:143]
    ds_read_b64_tr_b16 a[200:201], v190 offset:4096
    ds_read_b64_tr_b16 a[202:203], v190 offset:6144
    v_exp_f32 v66, v66
    v_exp_f32 v67, v67
    v_mfma_f32_32x32x16_bf16 v[104:119], a[132:135], v[12:15], v[104:119]
    ds_read_b64_tr_b16 a[204:205], v191 offset:4096
    v_exp_f32 v68, v68
    v_add_f32 v166, v166, v66
    v_exp_f32 v69, v69
    v_mfma_f32_32x32x16_bf16 v[104:119], a[136:139], v[16:19], v[104:119]
    ds_read_b64_tr_b16 a[206:207], v191 offset:6144
    ds_read_b64_tr_b16 a[208:209], v188 offset:8192
    buffer_load_dwordx4 v201, s[28:31], s66 offen offset:1024 nt lds
    v_add_f32 v167, v167, v67
    v_cvt_pk_bf16_f32 v153, v66, v67
    v_add_f32 v166, v166, v68
    v_mfma_f32_32x32x16_bf16 v[104:119], a[140:143], v[20:23], v[104:119]
    s_waitcnt lgkmcnt(14)
    ds_read_b64_tr_b16 a[210:211], v188 offset:10240
    v_exp_f32 v70, v70
    v_exp_f32 v71, v71
    v_add_f32 v167, v167, v69
    v_mfma_f32_32x32x16_bf16 v[104:119], a[144:147], v[24:27], v[104:119]
    ds_read_b64_tr_b16 a[212:213], v189 offset:8192
    ds_read_b64_tr_b16 a[214:215], v189 offset:10240
    v_cvt_pk_bf16_f32 v154, v68, v69
    v_add_f32 v166, v166, v70
    v_add_f32 v167, v167, v71
    v_cvt_pk_bf16_f32 v155, v70, v71
    v_mfma_f32_32x32x16_bf16 v[104:119], a[148:151], v[28:31], v[104:119]
    ds_read_b64_tr_b16 a[216:217], v190 offset:8192
    buffer_load_dwordx4 v202, s[28:31], s66 offen offset:2048 nt lds
    v_exp_f32 v72, v72
    v_exp_f32 v73, v73
    v_mfma_f32_32x32x16_bf16 v[104:119], a[152:155], v[32:35], v[104:119]
    ds_read_b64_tr_b16 a[218:219], v190 offset:10240
    ds_read_b64_tr_b16 a[220:221], v191 offset:8192
    v_exp_f32 v74, v74
    v_add_f32 v166, v166, v72
    v_add_f32 v167, v167, v73
    v_mfma_f32_32x32x16_bf16 v[104:119], a[156:159], v[36:39], v[104:119]
    ds_read_b64_tr_b16 a[222:223], v191 offset:10240
    v_exp_f32 v75, v75
    v_cvt_pk_bf16_f32 v156, v72, v73
    v_exp_f32 v76, v76
    v_mfma_f32_32x32x16_bf16 a[0:15], a[176:179], v[148:151], a[0:15]
    s_waitcnt lgkmcnt(14)
    ds_read_b64_tr_b16 a[224:225], v188 offset:12288
    ds_read_b64_tr_b16 a[226:227], v188 offset:14336
    buffer_load_dwordx4 v203, s[28:31], s66 offen offset:3072 nt lds
    v_add_f32 v166, v166, v74
    v_exp_f32 v77, v77
    v_mfma_f32_32x32x16_bf16 a[16:31], a[180:183], v[148:151], a[16:31]
    ds_read_b64_tr_b16 a[228:229], v189 offset:12288
    ds_read_b64_tr_b16 a[230:231], v189 offset:14336
    v_add_f32 v167, v167, v75
    v_cvt_pk_bf16_f32 v157, v74, v75
    v_exp_f32 v78, v78
    v_mfma_f32_32x32x16_bf16 a[32:47], a[184:187], v[148:151], a[32:47]
    ds_read_b64_tr_b16 a[232:233], v190 offset:12288
    ds_read_b64_tr_b16 a[234:235], v190 offset:14336
    v_add_f32 v166, v166, v76
    v_exp_f32 v79, v79
    v_add_f32 v167, v167, v77
    v_mfma_f32_32x32x16_bf16 a[48:63], a[188:191], v[148:151], a[48:63]
    ds_read_b64_tr_b16 a[236:237], v191 offset:12288
    ds_read_b64_tr_b16 a[238:239], v191 offset:14336
    v_and_b32 v253, 12, v249
    buffer_load_dword v253, v253, s[48:51], s19 offen sc1
    v_cvt_pk_bf16_f32 v158, v76, v77
    v_add_f32 v166, v166, v78
    v_add_f32 v167, v167, v79
    v_mfma_f32_32x32x16_bf16 a[0:15], a[192:195], v[152:155], a[0:15]
    s_waitcnt lgkmcnt(14)
    ds_read_b64_tr_b16 a[240:241], v192 offset:0
    ds_read_b64_tr_b16 a[242:243], v193 offset:0
    v_cvt_pk_bf16_f32 v159, v78, v79
    v_exp_f32 v80, v80
    v_mfma_f32_32x32x16_bf16 a[16:31], a[196:199], v[152:155], a[16:31]
    ds_read_b64_tr_b16 a[244:245], v194 offset:0
    ds_read_b64_tr_b16 a[246:247], v195 offset:0
    v_exp_f32 v81, v81
    v_exp_f32 v82, v82
    v_mfma_f32_32x32x16_bf16 a[32:47], a[200:203], v[152:155], a[32:47]
    ds_read_b64_tr_b16 a[248:249], v196 offset:0
    ds_read_b64_tr_b16 a[250:251], v197 offset:0
    buffer_load_dword v250, v249, s[48:51], s3 offen sc1
    v_add_f32 v166, v166, v80
    v_exp_f32 v83, v83
    v_mfma_f32_32x32x16_bf16 a[48:63], a[204:207], v[152:155], a[48:63]
    ds_read_b64_tr_b16 a[252:253], v198 offset:0
    ds_read_b64_tr_b16 a[254:255], v199 offset:0
    v_add_f32 v167, v167, v81
    v_cvt_pk_bf16_f32 v160, v80, v81
    v_exp_f32 v84, v84
    v_mfma_f32_32x32x16_bf16 a[0:15], a[208:211], v[156:159], a[0:15]
    s_waitcnt lgkmcnt(14)
    v_add_f32 v166, v166, v82
    v_exp_f32 v85, v85
    v_add_f32 v167, v167, v83
    v_cvt_pk_bf16_f32 v161, v82, v83
    v_add_f32 v166, v166, v84
    v_mfma_f32_32x32x16_bf16 a[16:31], a[212:215], v[156:159], a[16:31]
    v_exp_f32 v86, v86
    v_exp_f32 v87, v87
    v_add_f32 v167, v167, v85
    v_cvt_pk_bf16_f32 v162, v84, v85
    v_mfma_f32_32x32x16_bf16 a[32:47], a[216:219], v[156:159], a[32:47]
    v_add_f32 v166, v166, v86
    v_add_f32 v167, v167, v87
    v_cvt_pk_bf16_f32 v163, v86, v87
    v_exp_f32 v120, v120
    v_mfma_f32_32x32x16_bf16 a[48:63], a[220:223], v[156:159], a[48:63]
    v_exp_f32 v121, v121
    v_exp_f32 v122, v122
    v_exp_f32 v123, v123
    v_add_f32 v244, v120, v121
    v_cvt_pk_bf16_f32 v164, v120, v121
    v_add_f32 v245, v122, v123
    v_cvt_pk_bf16_f32 v165, v122, v123
    v_add_f32 v244, v244, v245
    v_add_f32 v170, v170, v244
    s_waitcnt vmcnt(6)
    s_waitcnt lgkmcnt(0)
    s_barrier
    v_mfma_f32_32x32x16_bf16 a[0:15], a[224:227], v[160:163], a[0:15]
    ds_read_b128 a[96:99], v176 offset:32768
    ds_read_b128 a[100:103], v177 offset:32768
    v_max3_f32 v171, v88, v89, v90
    v_max3_f32 v173, v91, v92, v93
    v_max3_f32 v172, v124, v125, v126
    v_max3_f32 v171, v171, v94, v95
    v_mfma_f32_32x32x16_bf16 a[16:31], a[228:231], v[160:163], a[16:31]
    ds_read_b128 a[104:107], v178 offset:32768
    ds_read_b128 a[108:111], v179 offset:32768
    v_max3_f32 v173, v173, v96, v97
    v_max3_f32 v171, v171, v98, v99
    v_max3_f32 v173, v173, v100, v101
    v_max3_f32 v171, v171, v102, v103
    v_mfma_f32_32x32x16_bf16 a[32:47], a[232:235], v[160:163], a[32:47]
    ds_read_b128 a[112:115], v180 offset:32768
    ds_read_b128 a[116:119], v181 offset:32768
    v_max3_f32 v173, v173, v104, v105
    v_max3_f32 v171, v171, v106, v107
    v_max3_f32 v173, v173, v108, v109
    v_max3_f32 v171, v171, v110, v111
    v_mfma_f32_32x32x16_bf16 a[48:63], a[236:239], v[160:163], a[48:63]
    ds_read_b128 a[120:123], v182 offset:32768
    ds_read_b128 a[124:127], v183 offset:32768
    v_max3_f32 v173, v173, v112, v113
    v_max3_f32 v171, v171, v114, v115
    v_max3_f32 v173, v173, v116, v117
    v_max_f32 v172, v172, v127
    v_mfma_f32_16x16x16_bf16 a[64:67], a[240:241], v[164:165], a[64:67]
    ds_read_b128 a[160:163], v184 offset:32768
    v_max3_f32 v171, v171, v118, v119
    v_mfma_f32_16x16x16_bf16 a[68:71], a[242:243], v[164:165], a[68:71]
    ds_read_b128 a[164:167], v185 offset:32768
    v_max_f32 v171, v171, v173
    v_mfma_f32_16x16x16_bf16 a[72:75], a[244:245], v[164:165], a[72:75]
    ds_read_b128 a[168:171], v186 offset:32768
    v_max_f32 v173, v171, v172
    v_mfma_f32_16x16x16_bf16 a[76:79], a[246:247], v[164:165], a[76:79]
    ds_read_b128 a[172:175], v187 offset:32768
    v_cmp_lt_f32 vcc, s73, v173
    v_mfma_f32_16x16x16_bf16 a[80:83], a[248:249], v[164:165], a[80:83]
    ds_read_b128 a[128:131], v176 offset:40960
    v_mfma_f32_16x16x16_bf16 a[84:87], a[250:251], v[164:165], a[84:87]
    ds_read_b128 a[132:135], v177 offset:40960
    v_mfma_f32_16x16x16_bf16 a[88:91], a[252:253], v[164:165], a[88:91]
    ds_read_b128 a[136:139], v178 offset:40960
    v_mfma_f32_16x16x16_bf16 a[92:95], a[254:255], v[164:165], a[92:95]
    s_mov_b32 s66, 229376
    s_add_u32 m0, s71, 98304
    ds_read_b128 a[140:143], v179 offset:40960
    buffer_load_dwordx4 v204, s[32:35], s66 offen offset:0 nt lds
    s_cbranch_vccz L_ok_13
    s_call_b64 s[80:81], L_slow1
L_ok_13:
    s_waitcnt lgkmcnt(14)
    v_mfma_f32_32x32x16_bf16 v[56:71], a[96:99], v[8:11], v[128:143]
    ds_read_b128 a[144:147], v180 offset:40960
    ds_read_b128 a[148:151], v181 offset:40960
    v_exp_f32 v88, v88
    v_exp_f32 v89, v89
    v_mfma_f32_32x32x16_bf16 v[56:71], a[100:103], v[12:15], v[56:71]
    s_waitcnt lgkmcnt(14)
    ds_read_b128 a[152:155], v182 offset:40960
    v_exp_f32 v90, v90
    v_add_f32 v166, v166, v88
    v_exp_f32 v91, v91
    v_mfma_f32_32x32x16_bf16 v[56:71], a[104:107], v[16:19], v[56:71]
    ds_read_b128 a[156:159], v183 offset:40960
    ds_read_b64_tr_b16 a[176:177], v188 offset:16384
    buffer_load_dwordx4 v205, s[32:35], s66 offen offset:1024 nt lds
    v_add_f32 v167, v167, v89
    v_cvt_pk_bf16_f32 v148, v88, v89
    v_add_f32 v166, v166, v90
    v_mfma_f32_32x32x16_bf16 v[56:71], a[108:111], v[20:23], v[56:71]
    s_waitcnt lgkmcnt(14)
    ds_read_b64_tr_b16 a[178:179], v188 offset:18432
    v_exp_f32 v92, v92
    v_exp_f32 v93, v93
    v_add_f32 v167, v167, v91
    v_mfma_f32_32x32x16_bf16 v[56:71], a[112:115], v[24:27], v[56:71]
    ds_read_b64_tr_b16 a[180:181], v189 offset:16384
    ds_read_b64_tr_b16 a[182:183], v189 offset:18432
    v_cvt_pk_bf16_f32 v149, v90, v91
    v_exp_f32 v94, v94
    v_add_f32 v166, v166, v92
    v_mfma_f32_32x32x16_bf16 v[56:71], a[116:119], v[28:31], v[56:71]
    ds_read_b64_tr_b16 a[184:185], v190 offset:16384
    v_exp_f32 v95, v95
    v_add_f32 v167, v167, v93
    v_cvt_pk_bf16_f32 v150, v92, v93
    v_add_f32 v166, v166, v94
    v_mfma_f32_32x32x16_bf16 v[56:71], a[120:123], v[32:35], v[56:71]
    s_waitcnt lgkmcnt(14)
    ds_read_b64_tr_b16 a[186:187], v190 offset:18432
    ds_read_b64_tr_b16 a[188:189], v191 offset:16384
    buffer_load_dwordx4 v204, s[32:35], s66 offen offset:2048 nt lds
    v_add_f32 v167, v167, v95
    v_cvt_pk_bf16_f32 v151, v94, v95
    v_mfma_f32_32x32x16_bf16 v[56:71], a[124:127], v[36:39], v[56:71]
    ds_read_b64_tr_b16 a[190:191], v191 offset:18432
    v_exp_f32 v96, v96
    v_exp_f32 v97, v97
    v_add_f32 v166, v166, v96
    v_mfma_f32_16x16x32_bf16 v[120:123], a[160:163], v[40:43], v[144:147]
    ds_read_b64_tr_b16 a[192:193], v188 offset:20480
    v_add_f32 v167, v167, v97
    v_mfma_f32_16x16x32_bf16 v[120:123], a[164:167], v[44:47], v[120:123]
    ds_read_b64_tr_b16 a[194:195], v188 offset:22528
    v_cvt_pk_bf16_f32 v152, v96, v97
    v_mfma_f32_16x16x32_bf16 v[120:123], a[168:171], v[48:51], v[120:123]
    s_waitcnt lgkmcnt(14)
    ds_read_b64_tr_b16 a[196:197], v189 offset:20480
    buffer_load_dwordx4 v205, s[32:35], s66 offen offset:3072 nt lds
    v_mfma_f32_16x16x32_bf16 v[120:123], a[172:175], v[52:55], v[120:123]
    ds_read_b64_tr_b16 a[198:199], v189 offset:22528
    v_mfma_f32_32x32x16_bf16 v[72:87], a[128:131], v[8:11], v[128:143]
    ds_read_b64_tr_b16 a[200:201], v190 offset:20480
    ds_read_b64_tr_b16 a[202:203], v190 offset:22528
    v_exp_f32 v98, v98
    v_exp_f32 v99, v99
    v_mfma_f32_32x32x16_bf16 v[72:87], a[132:135], v[12:15], v[72:87]
    ds_read_b64_tr_b16 a[204:205], v191 offset:20480
    v_exp_f32 v100, v100
    v_add_f32 v166, v166, v98
    v_exp_f32 v101, v101
    v_mfma_f32_32x32x16_bf16 v[72:87], a[136:139], v[16:19], v[72:87]
    s_mov_b32 s66, 245760
    s_add_u32 m0, s71, 65536
    ds_read_b64_tr_b16 a[206:207], v191 offset:22528
    ds_read_b64_tr_b16 a[208:209], v188 offset:24576
    buffer_load_dwordx4 v204, s[32:35], s66 offen offset:0 nt lds
    v_add_f32 v167, v167, v99
    v_cvt_pk_bf16_f32 v153, v98, v99
    v_mfma_f32_32x32x16_bf16 v[72:87], a[140:143], v[20:23], v[72:87]
    s_waitcnt lgkmcnt(14)
    ds_read_b64_tr_b16 a[210:211], v188 offset:26624
    v_exp_f32 v102, v102
    v_add_f32 v166, v166, v100
    v_exp_f32 v103, v103
    v_mfma_f32_32x32x16_bf16 v[72:87], a[144:147], v[24:27], v[72:87]
    ds_read_b64_tr_b16 a[212:213], v189 offset:24576
    ds_read_b64_tr_b16 a[214:215], v189 offset:26624
    v_add_f32 v167, v167, v101
    v_cvt_pk_bf16_f32 v154, v100, v101
    v_add_f32 v166, v166, v102
    v_add_f32 v167, v167, v103
    v_mfma_f32_32x32x16_bf16 v[72:87], a[148:151], v[28:31], v[72:87]
    ds_read_b64_tr_b16 a[216:217], v190 offset:24576
    v_cvt_pk_bf16_f32 v155, v102, v103
    v_exp_f32 v104, v104
    v_exp_f32 v105, v105
    v_mfma_f32_32x32x16_bf16 v[72:87], a[152:155], v[32:35], v[72:87]
    ds_read_b64_tr_b16 a[218:219], v190 offset:26624
    ds_read_b64_tr_b16 a[220:221], v191 offset:24576
    buffer_load_dwordx4 v205, s[32:35], s66 offen offset:1024 nt lds
    v_exp_f32 v106, v106
    v_add_f32 v166, v166, v104
    v_mfma_f32_32x32x16_bf16 v[72:87], a[156:159], v[36:39], v[72:87]
    ds_read_b64_tr_b16 a[222:223], v191 offset:26624
    v_exp_f32 v107, v107
    v_add_f32 v167, v167, v105
    v_cvt_pk_bf16_f32 v156, v104, v105
    v_add_f32 v166, v166, v106
    v_mfma_f32_32x32x16_bf16 a[0:15], a[176:179], v[148:151], a[0:15]
    s_waitcnt lgkmcnt(14)
    ds_read_b64_tr_b16 a[224:225], v188 offset:28672
    ds_read_b64_tr_b16 a[226:227], v188 offset:30720
    v_exp_f32 v108, v108
    v_exp_f32 v109, v109
    v_mfma_f32_32x32x16_bf16 a[16:31], a[180:183], v[148:151], a[16:31]
    ds_read_b64_tr_b16 a[228:229], v189 offset:28672
    ds_read_b64_tr_b16 a[230:231], v189 offset:30720
    v_add_f32 v167, v167, v107
    v_cvt_pk_bf16_f32 v157, v106, v107
    v_exp_f32 v110, v110
    v_mfma_f32_32x32x16_bf16 a[32:47], a[184:187], v[148:151], a[32:47]
    ds_read_b64_tr_b16 a[232:233], v190 offset:28672
    ds_read_b64_tr_b16 a[234:235], v190 offset:30720
    buffer_load_dwordx4 v204, s[32:35], s66 offen offset:2048 nt lds
    v_add_f32 v166, v166, v108
    v_exp_f32 v111, v111
    v_mfma_f32_32x32x16_bf16 a[48:63], a[188:191], v[148:151], a[48:63]
    ds_read_b64_tr_b16 a[236:237], v191 offset:28672
    ds_read_b64_tr_b16 a[238:239], v191 offset:30720
    v_add_f32 v167, v167, v109
    v_cvt_pk_bf16_f32 v158, v108, v109
    v_add_f32 v166, v166, v110
    v_add_f32 v167, v167, v111
    v_mfma_f32_32x32x16_bf16 a[0:15], a[192:195], v[152:155], a[0:15]
    s_waitcnt lgkmcnt(14)
    ds_read_b64_tr_b16 a[240:241], v192 offset:16384
    ds_read_b64_tr_b16 a[242:243], v193 offset:16384
    v_cvt_pk_bf16_f32 v159, v110, v111
    v_exp_f32 v112, v112
    v_mfma_f32_32x32x16_bf16 a[16:31], a[196:199], v[152:155], a[16:31]
    ds_read_b64_tr_b16 a[244:245], v194 offset:16384
    ds_read_b64_tr_b16 a[246:247], v195 offset:16384
    v_exp_f32 v113, v113
    v_exp_f32 v114, v114
    v_mfma_f32_32x32x16_bf16 a[32:47], a[200:203], v[152:155], a[32:47]
    ds_read_b64_tr_b16 a[248:249], v196 offset:16384
    ds_read_b64_tr_b16 a[250:251], v197 offset:16384
    buffer_load_dwordx4 v205, s[32:35], s66 offen offset:3072 nt lds
    v_add_f32 v166, v166, v112
    v_exp_f32 v115, v115
    v_mfma_f32_32x32x16_bf16 a[48:63], a[204:207], v[152:155], a[48:63]
    ds_read_b64_tr_b16 a[252:253], v198 offset:16384
    ds_read_b64_tr_b16 a[254:255], v199 offset:16384
    v_add_f32 v167, v167, v113
    v_cvt_pk_bf16_f32 v160, v112, v113
    v_exp_f32 v116, v116
    v_mfma_f32_32x32x16_bf16 a[0:15], a[208:211], v[156:159], a[0:15]
    s_waitcnt lgkmcnt(14)
    v_add_f32 v166, v166, v114
    v_exp_f32 v117, v117
    v_add_f32 v167, v167, v115
    v_cvt_pk_bf16_f32 v161, v114, v115
    v_add_f32 v166, v166, v116
    v_mfma_f32_32x32x16_bf16 a[16:31], a[212:215], v[156:159], a[16:31]
    v_exp_f32 v118, v118
    v_exp_f32 v119, v119
    v_add_f32 v167, v167, v117
    v_cvt_pk_bf16_f32 v162, v116, v117
    v_mfma_f32_32x32x16_bf16 a[32:47], a[216:219], v[156:159], a[32:47]
    v_add_f32 v166, v166, v118
    v_add_f32 v167, v167, v119
    v_cvt_pk_bf16_f32 v163, v118, v119
    v_exp_f32 v124, v124
    v_mfma_f32_32x32x16_bf16 a[48:63], a[220:223], v[156:159], a[48:63]
    v_exp_f32 v125, v125
    v_exp_f32 v126, v126
    v_exp_f32 v127, v127
    v_add_f32 v244, v124, v125
    v_cvt_pk_bf16_f32 v164, v124, v125
    v_add_f32 v245, v126, v127
    v_cvt_pk_bf16_f32 v165, v126, v127
    v_add_f32 v244, v244, v245
    v_add_f32 v170, v170, v244
    s_waitcnt vmcnt(4)
    s_waitcnt lgkmcnt(0)
    s_barrier
    v_mfma_f32_32x32x16_bf16 a[0:15], a[224:227], v[160:163], a[0:15]
    ds_read_b128 a[96:99], v176 offset:0
    ds_read_b128 a[100:103], v177 offset:0
    v_max3_f32 v171, v56, v57, v58
    v_max3_f32 v173, v59, v60, v61
    v_max3_f32 v172, v120, v121, v122
    v_max3_f32 v171, v171, v62, v63
    v_mfma_f32_32x32x16_bf16 a[16:31], a[228:231], v[160:163], a[16:31]
    ds_read_b128 a[104:107], v178 offset:0
    ds_read_b128 a[108:111], v179 offset:0
    v_max3_f32 v173, v173, v64, v65
    v_max3_f32 v171, v171, v66, v67
    v_max3_f32 v173, v173, v68, v69
    v_max3_f32 v171, v171, v70, v71
    v_mfma_f32_32x32x16_bf16 a[32:47], a[232:235], v[160:163], a[32:47]
    ds_read_b128 a[112:115], v180 offset:0
    ds_read_b128 a[116:119], v181 offset:0
    v_max3_f32 v173, v173, v72, v73
    v_max3_f32 v171, v171, v74, v75
    v_max3_f32 v173, v173, v76, v77
    v_max3_f32 v171, v171, v78, v79
    v_mfma_f32_32x32x16_bf16 a[48:63], a[236:239], v[160:163], a[48:63]
    ds_read_b128 a[120:123], v182 offset:0
    ds_read_b128 a[124:127], v183 offset:0
    v_max3_f32 v173, v173, v80, v81
    v_max3_f32 v171, v171, v82, v83
    v_max3_f32 v173, v173, v84, v85
    v_max_f32 v172, v172, v123
    v_mfma_f32_16x16x16_bf16 a[64:67], a[240:241], v[164:165], a[64:67]
    ds_read_b128 a[160:163], v184 offset:0
    v_max3_f32 v171, v171, v86, v87
    v_mfma_f32_16x16x16_bf16 a[68:71], a[242:243], v[164:165], a[68:71]
    ds_read_b128 a[164:167], v185 offset:0
    v_max_f32 v171, v171, v173
    v_mfma_f32_16x16x16_bf16 a[72:75], a[244:245], v[164:165], a[72:75]
    ds_read_b128 a[168:171], v186 offset:0
    v_max_f32 v173, v171, v172
    v_mfma_f32_16x16x16_bf16 a[76:79], a[246:247], v[164:165], a[76:79]
    ds_read_b128 a[172:175], v187 offset:0
    v_cmp_lt_f32 vcc, s73, v173
    v_mfma_f32_16x16x16_bf16 a[80:83], a[248:249], v[164:165], a[80:83]
    ds_read_b128 a[128:131], v176 offset:8192
    v_mfma_f32_16x16x16_bf16 a[84:87], a[250:251], v[164:165], a[84:87]
    ds_read_b128 a[132:135], v177 offset:8192
    v_mfma_f32_16x16x16_bf16 a[88:91], a[252:253], v[164:165], a[88:91]
    ds_read_b128 a[136:139], v178 offset:8192
    v_mfma_f32_16x16x16_bf16 a[92:95], a[254:255], v[164:165], a[92:95]
    s_add_u32 s65, s23, 3
    s_and_b32 s65, s65, 7
    s_mul_i32 s65, s65, 163840
    s_add_u32 m0, s72, 143360
    ds_read_b128 a[140:143], v179 offset:8192
    buffer_load_dwordx4 v227, s[44:47], s65 offen offset:0 lds
    s_cbranch_vccz L_ok_14
    s_call_b64 s[80:81], L_slow0
L_ok_14:
    s_waitcnt lgkmcnt(14)
    v_mfma_f32_32x32x16_bf16 v[88:103], a[96:99], v[8:11], v[128:143]
    ds_read_b128 a[144:147], v180 offset:8192
    ds_read_b128 a[148:151], v181 offset:8192
    v_exp_f32 v56, v56
    v_exp_f32 v57, v57
    v_mfma_f32_32x32x16_bf16 v[88:103], a[100:103], v[12:15], v[88:103]
    s_waitcnt lgkmcnt(14)
    ds_read_b128 a[152:155], v182 offset:8192
    v_exp_f32 v58, v58
    v_add_f32 v166, v166, v56
    v_exp_f32 v59, v59
    v_mfma_f32_32x32x16_bf16 v[88:103], a[104:107], v[16:19], v[88:103]
    ds_read_b128 a[156:159], v183 offset:8192
    ds_read_b64_tr_b16 a[176:177], v188 offset:32768
    v_add_f32 v167, v167, v57
    v_cvt_pk_bf16_f32 v148, v56, v57
    v_exp_f32 v60, v60
    v_mfma_f32_32x32x16_bf16 v[88:103], a[108:111], v[20:23], v[88:103]
    s_waitcnt lgkmcnt(14)
    ds_read_b64_tr_b16 a[178:179], v188 offset:34816
    v_add_f32 v166, v166, v58
    v_exp_f32 v61, v61
    v_add_f32 v167, v167, v59
    v_cvt_pk_bf16_f32 v149, v58, v59
    v_mfma_f32_32x32x16_bf16 v[88:103], a[112:115], v[24:27], v[88:103]
    ds_read_b64_tr_b16 a[180:181], v189 offset:32768
    ds_read_b64_tr_b16 a[182:183], v189 offset:34816
    v_exp_f32 v62, v62
    v_add_f32 v166, v166, v60
    v_add_f32 v167, v167, v61
    v_mfma_f32_32x32x16_bf16 v[88:103], a[116:119], v[28:31], v[88:103]
    ds_read_b64_tr_b16 a[184:185], v190 offset:32768
    buffer_load_dwordx4 v228, s[44:47], s65 offen offset:1024 lds
    v_exp_f32 v63, v63
    v_cvt_pk_bf16_f32 v150, v60, v61
    v_add_f32 v166, v166, v62
    v_mfma_f32_32x32x16_bf16 v[88:103], a[120:123], v[32:35], v[88:103]
    s_waitcnt lgkmcnt(14)
    ds_read_b64_tr_b16 a[186:187], v190 offset:34816
    ds_read_b64_tr_b16 a[188:189], v191 offset:32768
    v_add_f32 v167, v167, v63
    v_cvt_pk_bf16_f32 v151, v62, v63
    v_exp_f32 v64, v64
    v_mfma_f32_32x32x16_bf16 v[88:103], a[124:127], v[36:39], v[88:103]
    ds_read_b64_tr_b16 a[190:191], v191 offset:34816
    v_exp_f32 v65, v65
    v_exp_f32 v66, v66
    v_add_f32 v166, v166, v64
    v_mfma_f32_16x16x32_bf16 v[124:127], a[160:163], v[40:43], v[144:147]
    ds_read_b64_tr_b16 a[192:193], v188 offset:36864
    v_add_f32 v167, v167, v65
    v_mfma_f32_16x16x32_bf16 v[124:127], a[164:167], v[44:47], v[124:127]
    ds_read_b64_tr_b16 a[194:195], v188 offset:38912
    v_cvt_pk_bf16_f32 v152, v64, v65
    v_mfma_f32_16x16x32_bf16 v[124:127], a[168:171], v[48:51], v[124:127]
    s_waitcnt lgkmcnt(14)
    ds_read_b64_tr_b16 a[196:197], v189 offset:36864
    v_add_f32 v166, v166, v66
    v_mfma_f32_16x16x32_bf16 v[124:127], a[172:175], v[52:55], v[124:127]
    ds_read_b64_tr_b16 a[198:199], v189 offset:38912
    buffer_load_dwordx4 v229, s[44:47], s65 offen offset:2048 lds
    v_mfma_f32_32x32x16_bf16 v[104:119], a[128:131], v[8:11], v[128:143]
    ds_read_b64_tr_b16 a[200:201], v190 offset:36864
    ds_read_b64_tr_b16 a[202:203], v190 offset:38912
    v_exp_f32 v67, v67
    v_exp_f32 v68, v68
    v_mfma_f32_32x32x16_bf16 v[104:119], a[132:135], v[12:15], v[104:119]
    ds_read_b64_tr_b16 a[204:205], v191 offset:36864
    v_exp_f32 v69, v69
    v_add_f32 v167, v167, v67
    v_cvt_pk_bf16_f32 v153, v66, v67
    v_add_f32 v166, v166, v68
    v_mfma_f32_32x32x16_bf16 v[104:119], a[136:139], v[16:19], v[104:119]
    ds_read_b64_tr_b16 a[206:207], v191 offset:38912
    ds_read_b64_tr_b16 a[208:209], v188 offset:40960
    v_exp_f32 v70, v70
    v_exp_f32 v71, v71
    v_mfma_f32_32x32x16_bf16 v[104:119], a[140:143], v[20:23], v[104:119]
    s_waitcnt lgkmcnt(14)
    ds_read_b64_tr_b16 a[210:211], v188 offset:43008
    v_add_f32 v167, v167, v69
    v_cvt_pk_bf16_f32 v154, v68, v69
    v_add_f32 v166, v166, v70
    v_add_f32 v167, v167, v71
    v_cvt_pk_bf16_f32 v155, v70, v71
    v_mfma_f32_32x32x16_bf16 v[104:119], a[144:147], v[24:27], v[104:119]
    ds_read_b64_tr_b16 a[212:213], v189 offset:40960
    ds_read_b64_tr_b16 a[214:215], v189 offset:43008
    v_exp_f32 v72, v72
    v_exp_f32 v73, v73
    v_mfma_f32_32x32x16_bf16 v[104:119], a[148:151], v[28:31], v[104:119]
    ds_read_b64_tr_b16 a[216:217], v190 offset:40960
    buffer_load_dwordx4 v230, s[44:47], s65 offen offset:3072 lds
    v_exp_f32 v74, v74
    v_add_f32 v166, v166, v72
    v_add_f32 v167, v167, v73
    v_mfma_f32_32x32x16_bf16 v[104:119], a[152:155], v[32:35], v[104:119]
    ds_read_b64_tr_b16 a[218:219], v190 offset:43008
    ds_read_b64_tr_b16 a[220:221], v191 offset:40960
    v_exp_f32 v75, v75
    v_cvt_pk_bf16_f32 v156, v72, v73
    v_add_f32 v166, v166, v74
    v_mfma_f32_32x32x16_bf16 v[104:119], a[156:159], v[36:39], v[104:119]
    ds_read_b64_tr_b16 a[222:223], v191 offset:43008
    v_exp_f32 v76, v76
    v_exp_f32 v77, v77
    v_add_f32 v167, v167, v75
    v_mfma_f32_32x32x16_bf16 a[0:15], a[176:179], v[148:151], a[0:15]
    s_waitcnt lgkmcnt(14)
    ds_read_b64_tr_b16 a[224:225], v188 offset:45056
    ds_read_b64_tr_b16 a[226:227], v188 offset:47104
    v_cvt_pk_bf16_f32 v157, v74, v75
    v_exp_f32 v78, v78
    v_add_f32 v166, v166, v76
    v_mfma_f32_32x32x16_bf16 a[16:31], a[180:183], v[148:151], a[16:31]
    ds_read_b64_tr_b16 a[228:229], v189 offset:45056
    ds_read_b64_tr_b16 a[230:231], v189 offset:47104
    v_exp_f32 v79, v79
    v_add_f32 v167, v167, v77
    v_cvt_pk_bf16_f32 v158, v76, v77
    v_mfma_f32_32x32x16_bf16 a[32:47], a[184:187], v[148:151], a[32:47]
    ds_read_b64_tr_b16 a[232:233], v190 offset:45056
    ds_read_b64_tr_b16 a[234:235], v190 offset:47104
    v_add_f32 v166, v166, v78
    v_add_f32 v167, v167, v79
    v_cvt_pk_bf16_f32 v159, v78, v79
    v_mfma_f32_32x32x16_bf16 a[48:63], a[188:191], v[148:151], a[48:63]
    ds_read_b64_tr_b16 a[236:237], v191 offset:45056
    ds_read_b64_tr_b16 a[238:239], v191 offset:47104
    s_add_u32 m0, s72, 147456
    s_nop 0
    buffer_load_dwordx4 v231, s[44:47], s65 offen lds
    v_exp_f32 v80, v80
    v_mfma_f32_32x32x16_bf16 a[0:15], a[192:195], v[152:155], a[0:15]
    s_waitcnt lgkmcnt(14)
    ds_read_b64_tr_b16 a[240:241], v192 offset:32768
    ds_read_b64_tr_b16 a[242:243], v193 offset:32768
    v_exp_f32 v81, v81
    v_exp_f32 v82, v82
    v_mfma_f32_32x32x16_bf16 a[16:31], a[196:199], v[152:155], a[16:31]
    ds_read_b64_tr_b16 a[244:245], v194 offset:32768
    ds_read_b64_tr_b16 a[246:247], v195 offset:32768
    v_add_f32 v166, v166, v80
    v_exp_f32 v83, v83
    v_add_f32 v167, v167, v81
    v_mfma_f32_32x32x16_bf16 a[32:47], a[200:203], v[152:155], a[32:47]
    ds_read_b64_tr_b16 a[248:249], v196 offset:32768
    ds_read_b64_tr_b16 a[250:251], v197 offset:32768
    v_cvt_pk_bf16_f32 v160, v80, v81
    v_exp_f32 v84, v84
    v_add_f32 v166, v166, v82
    v_mfma_f32_32x32x16_bf16 a[48:63], a[204:207], v[152:155], a[48:63]
    ds_read_b64_tr_b16 a[252:253], v198 offset:32768
    ds_read_b64_tr_b16 a[254:255], v199 offset:32768
    v_exp_f32 v85, v85
    v_add_f32 v167, v167, v83
    v_cvt_pk_bf16_f32 v161, v82, v83
    v_mfma_f32_32x32x16_bf16 a[0:15], a[208:211], v[156:159], a[0:15]
    s_waitcnt lgkmcnt(14)
    v_exp_f32 v86, v86
    v_add_f32 v166, v166, v84
    v_exp_f32 v87, v87
    v_add_f32 v167, v167, v85
    v_mfma_f32_32x32x16_bf16 a[16:31], a[212:215], v[156:159], a[16:31]
    v_cvt_pk_bf16_f32 v162, v84, v85
    v_add_f32 v166, v166, v86
    v_add_f32 v167, v167, v87
    v_cvt_pk_bf16_f32 v163, v86, v87
    v_exp_f32 v120, v120
    v_mfma_f32_32x32x16_bf16 a[32:47], a[216:219], v[156:159], a[32:47]
    v_exp_f32 v121, v121
    v_exp_f32 v122, v122
    v_exp_f32 v123, v123
    v_mfma_f32_32x32x16_bf16 a[48:63], a[220:223], v[156:159], a[48:63]
    v_add_f32 v244, v120, v121
    v_cvt_pk_bf16_f32 v164, v120, v121
    v_add_f32 v245, v122, v123
    v_cvt_pk_bf16_f32 v165, v122, v123
    v_add_f32 v244, v244, v245
    v_add_f32 v170, v170, v244
    s_lshl_b32 s60, s20, 9
    s_add_u32 s60, s60, 81920
    v_lshlrev_b32 v4, 3, v0
    v_add_u32 v7, s60, v4
    v_add_u32 v4, 81920, v4
    s_lshl_b32 s60, s20, 13
    s_add_u32 s60, s60, 83968
    v_add_u32 v5, s60, v236
    s_lshl_b32 s60, s20, 11
    s_add_u32 s60, s60, 83968
    v_add_u32 v6, s60, v236
    s_mul_i32 s62, s27, 36864
    s_lshl_b32 s60, s20, 10
    s_add_u32 s61, s60, s62
    s_add_u32 s61, s61, 32768
    v_lshrrev_b32 v250, 1, v250
    v_cmp_eq_u32 vcc, s75, v250
    s_cmp_eq_u64 vcc, exec
    s_cselect_b32 s77, 1, 0
    v_lshrrev_b32 v1, 4, v0
    v_add_u32 v1, s23, v1
    v_add_u32 v1, 5, v1
    v_and_b32 v1, 7, v1
    v_lshlrev_b32 v1, 7, v1
    v_bfe_u32 v2, v0, 1, 3
    v_add_u32 v1, v1, v2
    s_lshl_b32 s63, s22, 2
    s_add_u32 s63, s63, s20
    s_lshl_b32 s63, s63, 3
    v_add_u32 v1, s63, v1
    v_mul_u32_u24 v1, 1280, v1
    v_and_b32 v2, 1, v0
    v_mul_u32_u24 v2, 156, v2
    v_add_u32 v1, v1, v2
    s_mov_b32 exec_lo, 4294967295
    s_mov_b32 exec_hi, 65535
    buffer_load_dword v254, v1, s[44:47], 0 offen
    s_mov_b64 exec, -1
    s_waitcnt vmcnt(6)
    s_waitcnt lgkmcnt(0)
    s_barrier
    v_mfma_f32_32x32x16_bf16 a[0:15], a[224:227], v[160:163], a[0:15]
    ds_read_b64_tr_b16 a[176:177], v188 offset:0
    ds_read_b64_tr_b16 a[178:179], v188 offset:2048
    v_max3_f32 v171, v88, v89, v90
    v_max3_f32 v173, v91, v92, v93
    v_max3_f32 v172, v124, v125, v126
    v_max3_f32 v171, v171, v94, v95
    v_mfma_f32_32x32x16_bf16 a[16:31], a[228:231], v[160:163], a[16:31]
    ds_read_b64_tr_b16 a[180:181], v189 offset:0
    ds_read_b64_tr_b16 a[182:183], v189 offset:2048
    v_max3_f32 v173, v173, v96, v97
    v_max3_f32 v171, v171, v98, v99
    v_max3_f32 v173, v173, v100, v101
    v_max3_f32 v171, v171, v102, v103
    v_mfma_f32_32x32x16_bf16 a[32:47], a[232:235], v[160:163], a[32:47]
    ds_read_b64_tr_b16 a[184:185], v190 offset:0
    ds_read_b64_tr_b16 a[186:187], v190 offset:2048
    v_max3_f32 v173, v173, v104, v105
    v_max3_f32 v171, v171, v106, v107
    v_max3_f32 v173, v173, v108, v109
    v_max3_f32 v171, v171, v110, v111
    v_mfma_f32_32x32x16_bf16 a[48:63], a[236:239], v[160:163], a[48:63]
    ds_read_b64_tr_b16 a[188:189], v191 offset:0
    ds_read_b64_tr_b16 a[190:191], v191 offset:2048
    v_max3_f32 v173, v173, v112, v113
    v_max3_f32 v171, v171, v114, v115
    v_max3_f32 v173, v173, v116, v117
    v_max_f32 v172, v172, v127
    v_mfma_f32_16x16x16_bf16 a[64:67], a[240:241], v[164:165], a[64:67]
    ds_read_b64_tr_b16 a[192:193], v188 offset:4096
    v_max3_f32 v171, v171, v118, v119
    v_mfma_f32_16x16x16_bf16 a[68:71], a[242:243], v[164:165], a[68:71]
    ds_read_b64_tr_b16 a[194:195], v188 offset:6144
    v_max_f32 v171, v171, v173
    v_mfma_f32_16x16x16_bf16 a[72:75], a[244:245], v[164:165], a[72:75]
    ds_read_b64_tr_b16 a[196:197], v189 offset:4096
    v_max_f32 v173, v171, v172
    v_mfma_f32_16x16x16_bf16 a[76:79], a[246:247], v[164:165], a[76:79]
    ds_read_b64_tr_b16 a[198:199], v189 offset:6144
    v_cmp_lt_f32 vcc, s73, v173
    v_mfma_f32_16x16x16_bf16 a[80:83], a[248:249], v[164:165], a[80:83]
    ds_read_b64_tr_b16 a[200:201], v190 offset:4096
    v_mfma_f32_16x16x16_bf16 a[84:87], a[250:251], v[164:165], a[84:87]
    ds_read_b64_tr_b16 a[202:203], v190 offset:6144
    v_mfma_f32_16x16x16_bf16 a[88:91], a[252:253], v[164:165], a[88:91]
    ds_read_b64_tr_b16 a[204:205], v191 offset:4096
    v_mfma_f32_16x16x16_bf16 a[92:95], a[254:255], v[164:165], a[92:95]
    ds_read_b64_tr_b16 a[206:207], v191 offset:6144
    ds_read_b64_tr_b16 a[240:241], v192 offset:0
    ds_read_b64_tr_b16 a[242:243], v193 offset:0
    ds_read_b64_tr_b16 a[244:245], v194 offset:0
    ds_read_b64_tr_b16 a[246:247], v195 offset:0
    ds_read_b64_tr_b16 a[248:249], v196 offset:0
    ds_read_b64_tr_b16 a[250:251], v197 offset:0
    ds_read_b64_tr_b16 a[252:253], v198 offset:0
    ds_read_b64_tr_b16 a[254:255], v199 offset:0
    s_cbranch_vccz L_ok_15
    s_call_b64 s[80:81], L_slow1
L_ok_15:
    v_exp_f32 v124, v124
    v_exp_f32 v125, v125
    v_exp_f32 v126, v126
    v_exp_f32 v127, v127
    v_add_f32 v244, v124, v125
    v_cvt_pk_bf16_f32 v164, v124, v125
    v_add_f32 v245, v126, v127
    v_cvt_pk_bf16_f32 v165, v126, v127
    v_add_f32 v244, v244, v245
    v_add_f32 v170, v170, v244
    s_waitcnt lgkmcnt(7)
    v_mfma_f32_16x16x16_bf16 a[64:67], a[240:241], v[164:165], a[64:67]
    s_waitcnt lgkmcnt(6)
    ds_read_b64_tr_b16 a[208:209], v188 offset:8192
    v_mov_b32 v240, v170
    v_mfma_f32_16x16x16_bf16 a[68:71], a[242:243], v[164:165], a[68:71]
    s_waitcnt lgkmcnt(6)
    s_add_u32 s65, s23, 4
    s_and_b32 s65, s65, 7
    s_mul_i32 s65, s65, 163840
    s_add_u32 m0, s72, 122880
    ds_read_b64_tr_b16 a[210:211], v188 offset:10240
    buffer_load_dwordx4 v227, s[44:47], s65 offen offset:0 lds
    v_mfma_f32_16x16x16_bf16 a[72:75], a[244:245], v[164:165], a[72:75]
    s_waitcnt lgkmcnt(6)
    ds_read_b64_tr_b16 a[212:213], v189 offset:8192
    v_permlane32_swap_b32 v170, v240
    v_mfma_f32_16x16x16_bf16 a[76:79], a[246:247], v[164:165], a[76:79]
    s_waitcnt lgkmcnt(6)
    ds_read_b64_tr_b16 a[214:215], v189 offset:10240
    v_add_f32 v170, v170, v240
    v_mfma_f32_16x16x16_bf16 a[80:83], a[248:249], v[164:165], a[80:83]
    s_waitcnt lgkmcnt(6)
    ds_read_b64_tr_b16 a[216:217], v190 offset:8192
    buffer_load_dwordx4 v228, s[44:47], s65 offen offset:1024 lds
    v_mfma_f32_16x16x16_bf16 a[84:87], a[250:251], v[164:165], a[84:87]
    s_waitcnt lgkmcnt(6)
    ds_read_b64_tr_b16 a[218:219], v190 offset:10240
    v_mov_b32 v240, v170
    v_mfma_f32_16x16x16_bf16 a[88:91], a[252:253], v[164:165], a[88:91]
    s_waitcnt lgkmcnt(6)
    ds_read_b64_tr_b16 a[220:221], v191 offset:8192
    v_exp_f32 v88, v88
    v_exp_f32 v89, v89
    v_exp_f32 v90, v90
    v_add_f32 v166, v166, v88
    v_exp_f32 v91, v91
    v_add_f32 v167, v167, v89
    v_cvt_pk_bf16_f32 v148, v88, v89
    v_exp_f32 v92, v92
    v_add_f32 v166, v166, v90
    v_exp_f32 v93, v93
    v_add_f32 v167, v167, v91
    v_cvt_pk_bf16_f32 v149, v90, v91
    v_exp_f32 v94, v94
    v_add_f32 v166, v166, v92
    v_exp_f32 v95, v95
    v_add_f32 v167, v167, v93
    v_cvt_pk_bf16_f32 v150, v92, v93
    v_add_f32 v166, v166, v94
    v_add_f32 v167, v167, v95
    v_cvt_pk_bf16_f32 v151, v94, v95
    v_mfma_f32_16x16x16_bf16 a[92:95], a[254:255], v[164:165], a[92:95]
    ds_read_b64_tr_b16 a[222:223], v191 offset:10240
    buffer_load_dwordx4 v229, s[44:47], s65 offen offset:2048 lds
    v_permlane16_swap_b32 v170, v240
    v_add_f32 v145, v170, v240
    v_mfma_f32_32x32x16_bf16 a[0:15], a[176:179], v[148:151], a[0:15]
    ds_read_b64_tr_b16 a[224:225], v188 offset:12288
    ds_read_b64_tr_b16 a[226:227], v188 offset:14336
    v_exp_f32 v96, v96
    v_exp_f32 v97, v97
    v_mfma_f32_32x32x16_bf16 a[16:31], a[180:183], v[148:151], a[16:31]
    ds_read_b64_tr_b16 a[228:229], v189 offset:12288
    ds_read_b64_tr_b16 a[230:231], v189 offset:14336
    v_exp_f32 v98, v98
    v_add_f32 v166, v166, v96
    v_add_f32 v167, v167, v97
    v_mfma_f32_32x32x16_bf16 a[32:47], a[184:187], v[148:151], a[32:47]
    ds_read_b64_tr_b16 a[232:233], v190 offset:12288
    ds_read_b64_tr_b16 a[234:235], v190 offset:14336
    buffer_load_dwordx4 v230, s[44:47], s65 offen offset:3072 lds
    v_exp_f32 v99, v99
    v_cvt_pk_bf16_f32 v152, v96, v97
    v_exp_f32 v100, v100
    v_add_f32 v166, v166, v98
    v_exp_f32 v101, v101
    v_add_f32 v167, v167, v99
    v_cvt_pk_bf16_f32 v153, v98, v99
    v_exp_f32 v102, v102
    v_add_f32 v166, v166, v100
    v_exp_f32 v103, v103
    v_add_f32 v167, v167, v101
    v_cvt_pk_bf16_f32 v154, v100, v101
    v_add_f32 v166, v166, v102
    v_add_f32 v167, v167, v103
    v_cvt_pk_bf16_f32 v155, v102, v103
    v_mfma_f32_32x32x16_bf16 a[48:63], a[188:191], v[148:151], a[48:63]
    ds_read_b64_tr_b16 a[236:237], v191 offset:12288
    ds_read_b64_tr_b16 a[238:239], v191 offset:14336
    ds_write_b64 v7, v[144:145]
    v_exp_f32 v104, v104
    v_mfma_f32_32x32x16_bf16 a[0:15], a[192:195], v[152:155], a[0:15]
    ds_write_b128 v5, a[64:67] offset:0
    ds_write_b128 v5, a[68:71] offset:1024
    v_exp_f32 v105, v105
    v_mfma_f32_32x32x16_bf16 a[16:31], a[196:199], v[152:155], a[16:31]
    ds_write_b128 v5, a[72:75] offset:2048
    ds_write_b128 v5, a[76:79] offset:3072
    s_add_u32 m0, s72, 126976
    s_nop 0
    buffer_load_dwordx4 v231, s[44:47], s65 offen lds
    v_add_f32 v166, v166, v104
    v_mfma_f32_32x32x16_bf16 a[32:47], a[200:203], v[152:155], a[32:47]
    ds_write_b128 v5, a[80:83] offset:4096
    ds_write_b128 v5, a[84:87] offset:5120
    v_exp_f32 v106, v106
    v_exp_f32 v107, v107
    v_add_f32 v167, v167, v105
    v_cvt_pk_bf16_f32 v156, v104, v105
    v_exp_f32 v108, v108
    v_add_f32 v166, v166, v106
    v_exp_f32 v109, v109
    v_add_f32 v167, v167, v107
    v_cvt_pk_bf16_f32 v157, v106, v107
    v_exp_f32 v110, v110
    v_add_f32 v166, v166, v108
    v_exp_f32 v111, v111
    v_add_f32 v167, v167, v109
    v_cvt_pk_bf16_f32 v158, v108, v109
    v_add_f32 v166, v166, v110
    v_add_f32 v167, v167, v111
    v_cvt_pk_bf16_f32 v159, v110, v111
    v_mfma_f32_32x32x16_bf16 a[48:63], a[204:207], v[152:155], a[48:63]
    s_waitcnt lgkmcnt(14)
    ds_write_b128 v5, a[88:91] offset:6144
    ds_write_b128 v5, a[92:95] offset:7168
    v_exp_f32 v112, v112
    v_mfma_f32_32x32x16_bf16 a[0:15], a[208:211], v[156:159], a[0:15]
    v_exp_f32 v113, v113
    v_exp_f32 v114, v114
    v_add_f32 v166, v166, v112
    v_add_f32 v167, v167, v113
    v_mfma_f32_32x32x16_bf16 a[16:31], a[212:215], v[156:159], a[16:31]
    v_exp_f32 v115, v115
    v_cvt_pk_bf16_f32 v160, v112, v113
    v_exp_f32 v116, v116
    v_add_f32 v166, v166, v114
    v_mfma_f32_32x32x16_bf16 a[32:47], a[216:219], v[156:159], a[32:47]
    s_waitcnt lgkmcnt(0)
    s_barrier
    v_exp_f32 v117, v117
    v_add_f32 v167, v167, v115
    v_cvt_pk_bf16_f32 v161, v114, v115
    v_exp_f32 v118, v118
    v_add_f32 v166, v166, v116
    v_exp_f32 v119, v119
    v_add_f32 v167, v167, v117
    v_cvt_pk_bf16_f32 v162, v116, v117
    v_add_f32 v166, v166, v118
    v_add_f32 v167, v167, v119
    v_cvt_pk_bf16_f32 v163, v118, v119
    v_mfma_f32_32x32x16_bf16 a[48:63], a[220:223], v[156:159], a[48:63]
    s_add_u32 s65, s23, 5
    s_and_b32 s65, s65, 7
    s_mul_i32 s65, s65, 163840
    s_add_u32 m0, s72, 61440
    ds_read_b64 v[240:241], v4 offset:0
    ds_read_b64 v[242:243], v4 offset:512
    ds_read_b64 v[244:245], v4 offset:1024
    ds_read_b64 v[246:247], v4 offset:1536
    buffer_load_dwordx4 v227, s[44:47], s65 offen offset:0 lds
    v_mfma_f32_32x32x16_bf16 a[0:15], a[224:227], v[160:163], a[0:15]
    buffer_load_dwordx4 v228, s[44:47], s65 offen offset:1024 lds
    buffer_load_dwordx4 v229, s[44:47], s65 offen offset:2048 lds
    v_add_f32 v166, v166, v167
    v_mov_b32 v167, v166
    s_nop 1
    v_permlane32_swap_b32 v166, v167
    v_add_f32 v166, v166, v167
    v_rcp_f32 v166, v166
    v_mfma_f32_32x32x16_bf16 a[16:31], a[228:231], v[160:163], a[16:31]
    ds_read_b128 v[176:179], v6 offset:0
    ds_read_b128 v[180:183], v6 offset:1024
    ds_read_b128 v[184:187], v6 offset:8192
    ds_read_b128 v[188:191], v6 offset:9216
    ds_read_b128 v[192:195], v6 offset:16384
    ds_read_b128 v[196:199], v6 offset:17408
    ds_read_b128 v[200:203], v6 offset:24576
    ds_read_b128 v[204:207], v6 offset:25600
    buffer_load_dwordx4 v230, s[44:47], s65 offen offset:3072 lds
    s_add_u32 m0, s72, 65536
    s_nop 0
    buffer_load_dwordx4 v231, s[44:47], s65 offen lds
    v_mfma_f32_32x32x16_bf16 a[32:47], a[232:235], v[160:163], a[32:47]
    v_mfma_f32_32x32x16_bf16 a[48:63], a[236:239], v[160:163], a[48:63]
    s_waitcnt lgkmcnt(10)
    v_min_f32 v1, v240, v242
    s_waitcnt lgkmcnt(8)
    v_min3_f32 v1, v1, v244, v246
    v_sub_f32 v240, v1, v240
    v_sub_f32 v242, v1, v242
    v_sub_f32 v244, v1, v244
    v_sub_f32 v246, v1, v246
    v_exp_f32 v240, v240
    v_exp_f32 v242, v242
    v_exp_f32 v244, v244
    v_exp_f32 v246, v246
    s_waitcnt lgkmcnt(0)
    s_nop 7
    s_cmp_eq_u32 s77, 0
    s_cbranch_scc1 L_slowst
    v_accvgpr_read_b32 v56, a0
    v_accvgpr_read_b32 v57, a1
    v_accvgpr_read_b32 v58, a2
    v_accvgpr_read_b32 v59, a3
    v_accvgpr_read_b32 v60, a4
    v_accvgpr_read_b32 v61, a5
    v_accvgpr_read_b32 v62, a6
    v_accvgpr_read_b32 v63, a7
    v_accvgpr_read_b32 v64, a8
    v_accvgpr_read_b32 v65, a9
    v_accvgpr_read_b32 v66, a10
    v_accvgpr_read_b32 v67, a11
    v_accvgpr_read_b32 v68, a12
    v_accvgpr_read_b32 v69, a13
    v_accvgpr_read_b32 v70, a14
    v_accvgpr_read_b32 v71, a15
    v_pk_mul_f32 v[56:57], v[56:57], v[166:167] op_sel_hi:[1,0]
    v_pk_mul_f32 v[58:59], v[58:59], v[166:167] op_sel_hi:[1,0]
    v_pk_mul_f32 v[60:61], v[60:61], v[166:167] op_sel_hi:[1,0]
    v_pk_mul_f32 v[62:63], v[62:63], v[166:167] op_sel_hi:[1,0]
    v_pk_mul_f32 v[64:65], v[64:65], v[166:167] op_sel_hi:[1,0]
    v_pk_mul_f32 v[66:67], v[66:67], v[166:167] op_sel_hi:[1,0]
    v_pk_mul_f32 v[68:69], v[68:69], v[166:167] op_sel_hi:[1,0]
    v_pk_mul_f32 v[70:71], v[70:71], v[166:167] op_sel_hi:[1,0]
    v_cvt_pk_bf16_f32 v8, v56, v57
    v_cvt_pk_bf16_f32 v9, v58, v59
    v_cvt_pk_bf16_f32 v10, v60, v61
    v_cvt_pk_bf16_f32 v11, v62, v63
    v_cvt_pk_bf16_f32 v12, v64, v65
    v_cvt_pk_bf16_f32 v13, v66, v67
    v_cvt_pk_bf16_f32 v14, v68, v69
    v_cvt_pk_bf16_f32 v15, v70, v71
    buffer_store_dwordx4 v[8:11], v235, s[48:51], s62 offen offset:0
    buffer_store_dwordx4 v[12:15], v235, s[48:51], s62 offen offset:512
    v_mul_f32 v2, v240, v241
    v_fmac_f32 v2, v242, v243
    v_fmac_f32 v2, v244, v245
    v_fmac_f32 v2, v246, v247
    v_rcp_f32 v2, v2
    v_pk_mul_f32 v[120:121], v[176:177], v[240:241] op_sel_hi:[1,0]
    v_pk_mul_f32 v[122:123], v[178:179], v[240:241] op_sel_hi:[1,0]
    v_pk_mul_f32 v[124:125], v[180:181], v[240:241] op_sel_hi:[1,0]
    v_pk_mul_f32 v[126:127], v[182:183], v[240:241] op_sel_hi:[1,0]
    v_pk_fma_f32 v[120:121], v[184:185], v[242:243], v[120:121] op_sel_hi:[1,0,1]
    v_pk_fma_f32 v[122:123], v[186:187], v[242:243], v[122:123] op_sel_hi:[1,0,1]
    v_pk_fma_f32 v[124:125], v[188:189], v[242:243], v[124:125] op_sel_hi:[1,0,1]
    v_pk_fma_f32 v[126:127], v[190:191], v[242:243], v[126:127] op_sel_hi:[1,0,1]
    v_pk_fma_f32 v[120:121], v[192:193], v[244:245], v[120:121] op_sel_hi:[1,0,1]
    v_pk_fma_f32 v[122:123], v[194:195], v[244:245], v[122:123] op_sel_hi:[1,0,1]
    v_pk_fma_f32 v[124:125], v[196:197], v[244:245], v[124:125] op_sel_hi:[1,0,1]
    v_pk_fma_f32 v[126:127], v[198:199], v[244:245], v[126:127] op_sel_hi:[1,0,1]
    v_pk_fma_f32 v[120:121], v[200:201], v[246:247], v[120:121] op_sel_hi:[1,0,1]
    v_pk_fma_f32 v[122:123], v[202:203], v[246:247], v[122:123] op_sel_hi:[1,0,1]
    v_pk_fma_f32 v[124:125], v[204:205], v[246:247], v[124:125] op_sel_hi:[1,0,1]
    v_pk_fma_f32 v[126:127], v[206:207], v[246:247], v[126:127] op_sel_hi:[1,0,1]
    v_pk_mul_f32 v[120:121], v[120:121], v[2:3] op_sel_hi:[1,0]
    v_pk_mul_f32 v[122:123], v[122:123], v[2:3] op_sel_hi:[1,0]
    v_pk_mul_f32 v[124:125], v[124:125], v[2:3] op_sel_hi:[1,0]
    v_pk_mul_f32 v[126:127], v[126:127], v[2:3] op_sel_hi:[1,0]
    v_cvt_pk_bf16_f32 v40, v120, v121
    v_cvt_pk_bf16_f32 v41, v122, v123
    v_cvt_pk_bf16_f32 v42, v124, v125
    v_cvt_pk_bf16_f32 v43, v126, v127
    buffer_store_dwordx4 v[40:43], v236, s[48:51], s61 offen
    v_accvgpr_read_b32 v72, a16
    v_accvgpr_read_b32 v73, a17
    v_accvgpr_read_b32 v74, a18
    v_accvgpr_read_b32 v75, a19
    v_accvgpr_read_b32 v76, a20
    v_accvgpr_read_b32 v77, a21
    v_accvgpr_read_b32 v78, a22
    v_accvgpr_read_b32 v79, a23
    v_accvgpr_read_b32 v80, a24
    v_accvgpr_read_b32 v81, a25
    v_accvgpr_read_b32 v82, a26
    v_accvgpr_read_b32 v83, a27
    v_accvgpr_read_b32 v84, a28
    v_accvgpr_read_b32 v85, a29
    v_accvgpr_read_b32 v86, a30
    v_accvgpr_read_b32 v87, a31
    v_pk_mul_f32 v[72:73], v[72:73], v[166:167] op_sel_hi:[1,0]
    v_pk_mul_f32 v[74:75], v[74:75], v[166:167] op_sel_hi:[1,0]
    v_pk_mul_f32 v[76:77], v[76:77], v[166:167] op_sel_hi:[1,0]
    v_pk_mul_f32 v[78:79], v[78:79], v[166:167] op_sel_hi:[1,0]
    v_pk_mul_f32 v[80:81], v[80:81], v[166:167] op_sel_hi:[1,0]
    v_pk_mul_f32 v[82:83], v[82:83], v[166:167] op_sel_hi:[1,0]
    v_pk_mul_f32 v[84:85], v[84:85], v[166:167] op_sel_hi:[1,0]
    v_pk_mul_f32 v[86:87], v[86:87], v[166:167] op_sel_hi:[1,0]
    v_cvt_pk_bf16_f32 v16, v72, v73
    v_cvt_pk_bf16_f32 v17, v74, v75
    v_cvt_pk_bf16_f32 v18, v76, v77
    v_cvt_pk_bf16_f32 v19, v78, v79
    v_cvt_pk_bf16_f32 v20, v80, v81
    v_cvt_pk_bf16_f32 v21, v82, v83
    v_cvt_pk_bf16_f32 v22, v84, v85
    v_cvt_pk_bf16_f32 v23, v86, v87
    buffer_store_dwordx4 v[16:19], v235, s[48:51], s62 offen offset:1024
    buffer_store_dwordx4 v[20:23], v235, s[48:51], s62 offen offset:1536
    v_accvgpr_read_b32 v88, a32
    v_accvgpr_read_b32 v89, a33
    v_accvgpr_read_b32 v90, a34
    v_accvgpr_read_b32 v91, a35
    v_accvgpr_read_b32 v92, a36
    v_accvgpr_read_b32 v93, a37
    v_accvgpr_read_b32 v94, a38
    v_accvgpr_read_b32 v95, a39
    v_accvgpr_read_b32 v96, a40
    v_accvgpr_read_b32 v97, a41
    v_accvgpr_read_b32 v98, a42
    v_accvgpr_read_b32 v99, a43
    v_accvgpr_read_b32 v100, a44
    v_accvgpr_read_b32 v101, a45
    v_accvgpr_read_b32 v102, a46
    v_accvgpr_read_b32 v103, a47
    v_pk_mul_f32 v[88:89], v[88:89], v[166:167] op_sel_hi:[1,0]
    v_pk_mul_f32 v[90:91], v[90:91], v[166:167] op_sel_hi:[1,0]
    v_pk_mul_f32 v[92:93], v[92:93], v[166:167] op_sel_hi:[1,0]
    v_pk_mul_f32 v[94:95], v[94:95], v[166:167] op_sel_hi:[1,0]
    v_pk_mul_f32 v[96:97], v[96:97], v[166:167] op_sel_hi:[1,0]
    v_pk_mul_f32 v[98:99], v[98:99], v[166:167] op_sel_hi:[1,0]
    v_pk_mul_f32 v[100:101], v[100:101], v[166:167] op_sel_hi:[1,0]
    v_pk_mul_f32 v[102:103], v[102:103], v[166:167] op_sel_hi:[1,0]
    v_cvt_pk_bf16_f32 v24, v88, v89
    v_cvt_pk_bf16_f32 v25, v90, v91
    v_cvt_pk_bf16_f32 v26, v92, v93
    v_cvt_pk_bf16_f32 v27, v94, v95
    v_cvt_pk_bf16_f32 v28, v96, v97
    v_cvt_pk_bf16_f32 v29, v98, v99
    v_cvt_pk_bf16_f32 v30, v100, v101
    v_cvt_pk_bf16_f32 v31, v102, v103
    buffer_store_dwordx4 v[24:27], v235, s[48:51], s62 offen offset:2048
    buffer_store_dwordx4 v[28:31], v235, s[48:51], s62 offen offset:2560
    v_accvgpr_read_b32 v104, a48
    v_accvgpr_read_b32 v105, a49
    v_accvgpr_read_b32 v106, a50
    v_accvgpr_read_b32 v107, a51
    v_accvgpr_read_b32 v108, a52
    v_accvgpr_read_b32 v109, a53
    v_accvgpr_read_b32 v110, a54
    v_accvgpr_read_b32 v111, a55
    v_accvgpr_read_b32 v112, a56
    v_accvgpr_read_b32 v113, a57
    v_accvgpr_read_b32 v114, a58
    v_accvgpr_read_b32 v115, a59
    v_accvgpr_read_b32 v116, a60
    v_accvgpr_read_b32 v117, a61
    v_accvgpr_read_b32 v118, a62
    v_accvgpr_read_b32 v119, a63
    v_pk_mul_f32 v[104:105], v[104:105], v[166:167] op_sel_hi:[1,0]
    v_pk_mul_f32 v[106:107], v[106:107], v[166:167] op_sel_hi:[1,0]
    v_pk_mul_f32 v[108:109], v[108:109], v[166:167] op_sel_hi:[1,0]
    v_pk_mul_f32 v[110:111], v[110:111], v[166:167] op_sel_hi:[1,0]
    v_pk_mul_f32 v[112:113], v[112:113], v[166:167] op_sel_hi:[1,0]
    v_pk_mul_f32 v[114:115], v[114:115], v[166:167] op_sel_hi:[1,0]
    v_pk_mul_f32 v[116:117], v[116:117], v[166:167] op_sel_hi:[1,0]
    v_pk_mul_f32 v[118:119], v[118:119], v[166:167] op_sel_hi:[1,0]
    v_cvt_pk_bf16_f32 v32, v104, v105
    v_cvt_pk_bf16_f32 v33, v106, v107
    v_cvt_pk_bf16_f32 v34, v108, v109
    v_cvt_pk_bf16_f32 v35, v110, v111
    v_cvt_pk_bf16_f32 v36, v112, v113
    v_cvt_pk_bf16_f32 v37, v114, v115
    v_cvt_pk_bf16_f32 v38, v116, v117
    v_cvt_pk_bf16_f32 v39, v118, v119
    buffer_store_dwordx4 v[32:35], v235, s[48:51], s62 offen offset:3072
    buffer_store_dwordx4 v[36:39], v235, s[48:51], s62 offen offset:3584
    s_branch L_stdone
L_slowst:
    v_accvgpr_read_b32 v56, a0
    v_accvgpr_read_b32 v57, a1
    v_accvgpr_read_b32 v58, a2
    v_accvgpr_read_b32 v59, a3
    v_accvgpr_read_b32 v60, a4
    v_accvgpr_read_b32 v61, a5
    v_accvgpr_read_b32 v62, a6
    v_accvgpr_read_b32 v63, a7
    v_accvgpr_read_b32 v64, a8
    v_accvgpr_read_b32 v65, a9
    v_accvgpr_read_b32 v66, a10
    v_accvgpr_read_b32 v67, a11
    v_accvgpr_read_b32 v68, a12
    v_accvgpr_read_b32 v69, a13
    v_accvgpr_read_b32 v70, a14
    v_accvgpr_read_b32 v71, a15
    v_pk_mul_f32 v[56:57], v[56:57], v[166:167] op_sel_hi:[1,0]
    v_pk_mul_f32 v[58:59], v[58:59], v[166:167] op_sel_hi:[1,0]
    v_pk_mul_f32 v[60:61], v[60:61], v[166:167] op_sel_hi:[1,0]
    v_pk_mul_f32 v[62:63], v[62:63], v[166:167] op_sel_hi:[1,0]
    v_pk_mul_f32 v[64:65], v[64:65], v[166:167] op_sel_hi:[1,0]
    v_pk_mul_f32 v[66:67], v[66:67], v[166:167] op_sel_hi:[1,0]
    v_pk_mul_f32 v[68:69], v[68:69], v[166:167] op_sel_hi:[1,0]
    v_pk_mul_f32 v[70:71], v[70:71], v[166:167] op_sel_hi:[1,0]
    v_cvt_pk_bf16_f32 v8, v56, v57
    v_cvt_pk_bf16_f32 v9, v58, v59
    v_cvt_pk_bf16_f32 v10, v60, v61
    v_cvt_pk_bf16_f32 v11, v62, v63
    v_cvt_pk_bf16_f32 v12, v64, v65
    v_cvt_pk_bf16_f32 v13, v66, v67
    v_cvt_pk_bf16_f32 v14, v68, v69
    v_cvt_pk_bf16_f32 v15, v70, v71
    buffer_store_dwordx4 v[8:11], v235, s[48:51], s62 offen offset:0 sc1
    buffer_store_dwordx4 v[12:15], v235, s[48:51], s62 offen offset:512 sc1
    v_mul_f32 v2, v240, v241
    v_fmac_f32 v2, v242, v243
    v_fmac_f32 v2, v244, v245
    v_fmac_f32 v2, v246, v247
    v_rcp_f32 v2, v2
    v_pk_mul_f32 v[120:121], v[176:177], v[240:241] op_sel_hi:[1,0]
    v_pk_mul_f32 v[122:123], v[178:179], v[240:241] op_sel_hi:[1,0]
    v_pk_mul_f32 v[124:125], v[180:181], v[240:241] op_sel_hi:[1,0]
    v_pk_mul_f32 v[126:127], v[182:183], v[240:241] op_sel_hi:[1,0]
    v_pk_fma_f32 v[120:121], v[184:185], v[242:243], v[120:121] op_sel_hi:[1,0,1]
    v_pk_fma_f32 v[122:123], v[186:187], v[242:243], v[122:123] op_sel_hi:[1,0,1]
    v_pk_fma_f32 v[124:125], v[188:189], v[242:243], v[124:125] op_sel_hi:[1,0,1]
    v_pk_fma_f32 v[126:127], v[190:191], v[242:243], v[126:127] op_sel_hi:[1,0,1]
    v_pk_fma_f32 v[120:121], v[192:193], v[244:245], v[120:121] op_sel_hi:[1,0,1]
    v_pk_fma_f32 v[122:123], v[194:195], v[244:245], v[122:123] op_sel_hi:[1,0,1]
    v_pk_fma_f32 v[124:125], v[196:197], v[244:245], v[124:125] op_sel_hi:[1,0,1]
    v_pk_fma_f32 v[126:127], v[198:199], v[244:245], v[126:127] op_sel_hi:[1,0,1]
    v_pk_fma_f32 v[120:121], v[200:201], v[246:247], v[120:121] op_sel_hi:[1,0,1]
    v_pk_fma_f32 v[122:123], v[202:203], v[246:247], v[122:123] op_sel_hi:[1,0,1]
    v_pk_fma_f32 v[124:125], v[204:205], v[246:247], v[124:125] op_sel_hi:[1,0,1]
    v_pk_fma_f32 v[126:127], v[206:207], v[246:247], v[126:127] op_sel_hi:[1,0,1]
    v_pk_mul_f32 v[120:121], v[120:121], v[2:3] op_sel_hi:[1,0]
    v_pk_mul_f32 v[122:123], v[122:123], v[2:3] op_sel_hi:[1,0]
    v_pk_mul_f32 v[124:125], v[124:125], v[2:3] op_sel_hi:[1,0]
    v_pk_mul_f32 v[126:127], v[126:127], v[2:3] op_sel_hi:[1,0]
    v_cvt_pk_bf16_f32 v40, v120, v121
    v_cvt_pk_bf16_f32 v41, v122, v123
    v_cvt_pk_bf16_f32 v42, v124, v125
    v_cvt_pk_bf16_f32 v43, v126, v127
    buffer_store_dwordx4 v[40:43], v236, s[48:51], s61 offen sc1
    v_accvgpr_read_b32 v72, a16
    v_accvgpr_read_b32 v73, a17
    v_accvgpr_read_b32 v74, a18
    v_accvgpr_read_b32 v75, a19
    v_accvgpr_read_b32 v76, a20
    v_accvgpr_read_b32 v77, a21
    v_accvgpr_read_b32 v78, a22
    v_accvgpr_read_b32 v79, a23
    v_accvgpr_read_b32 v80, a24
    v_accvgpr_read_b32 v81, a25
    v_accvgpr_read_b32 v82, a26
    v_accvgpr_read_b32 v83, a27
    v_accvgpr_read_b32 v84, a28
    v_accvgpr_read_b32 v85, a29
    v_accvgpr_read_b32 v86, a30
    v_accvgpr_read_b32 v87, a31
    v_pk_mul_f32 v[72:73], v[72:73], v[166:167] op_sel_hi:[1,0]
    v_pk_mul_f32 v[74:75], v[74:75], v[166:167] op_sel_hi:[1,0]
    v_pk_mul_f32 v[76:77], v[76:77], v[166:167] op_sel_hi:[1,0]
    v_pk_mul_f32 v[78:79], v[78:79], v[166:167] op_sel_hi:[1,0]
    v_pk_mul_f32 v[80:81], v[80:81], v[166:167] op_sel_hi:[1,0]
    v_pk_mul_f32 v[82:83], v[82:83], v[166:167] op_sel_hi:[1,0]
    v_pk_mul_f32 v[84:85], v[84:85], v[166:167] op_sel_hi:[1,0]
    v_pk_mul_f32 v[86:87], v[86:87], v[166:167] op_sel_hi:[1,0]
    v_cvt_pk_bf16_f32 v16, v72, v73
    v_cvt_pk_bf16_f32 v17, v74, v75
    v_cvt_pk_bf16_f32 v18, v76, v77
    v_cvt_pk_bf16_f32 v19, v78, v79
    v_cvt_pk_bf16_f32 v20, v80, v81
    v_cvt_pk_bf16_f32 v21, v82, v83
    v_cvt_pk_bf16_f32 v22, v84, v85
    v_cvt_pk_bf16_f32 v23, v86, v87
    buffer_store_dwordx4 v[16:19], v235, s[48:51], s62 offen offset:1024 sc1
    buffer_store_dwordx4 v[20:23], v235, s[48:51], s62 offen offset:1536 sc1
    v_accvgpr_read_b32 v88, a32
    v_accvgpr_read_b32 v89, a33
    v_accvgpr_read_b32 v90, a34
    v_accvgpr_read_b32 v91, a35
    v_accvgpr_read_b32 v92, a36
    v_accvgpr_read_b32 v93, a37
    v_accvgpr_read_b32 v94, a38
    v_accvgpr_read_b32 v95, a39
    v_accvgpr_read_b32 v96, a40
    v_accvgpr_read_b32 v97, a41
    v_accvgpr_read_b32 v98, a42
    v_accvgpr_read_b32 v99, a43
    v_accvgpr_read_b32 v100, a44
    v_accvgpr_read_b32 v101, a45
    v_accvgpr_read_b32 v102, a46
    v_accvgpr_read_b32 v103, a47
    v_pk_mul_f32 v[88:89], v[88:89], v[166:167] op_sel_hi:[1,0]
    v_pk_mul_f32 v[90:91], v[90:91], v[166:167] op_sel_hi:[1,0]
    v_pk_mul_f32 v[92:93], v[92:93], v[166:167] op_sel_hi:[1,0]
    v_pk_mul_f32 v[94:95], v[94:95], v[166:167] op_sel_hi:[1,0]
    v_pk_mul_f32 v[96:97], v[96:97], v[166:167] op_sel_hi:[1,0]
    v_pk_mul_f32 v[98:99], v[98:99], v[166:167] op_sel_hi:[1,0]
    v_pk_mul_f32 v[100:101], v[100:101], v[166:167] op_sel_hi:[1,0]
    v_pk_mul_f32 v[102:103], v[102:103], v[166:167] op_sel_hi:[1,0]
    v_cvt_pk_bf16_f32 v24, v88, v89
    v_cvt_pk_bf16_f32 v25, v90, v91
    v_cvt_pk_bf16_f32 v26, v92, v93
    v_cvt_pk_bf16_f32 v27, v94, v95
    v_cvt_pk_bf16_f32 v28, v96, v97
    v_cvt_pk_bf16_f32 v29, v98, v99
    v_cvt_pk_bf16_f32 v30, v100, v101
    v_cvt_pk_bf16_f32 v31, v102, v103
    buffer_store_dwordx4 v[24:27], v235, s[48:51], s62 offen offset:2048 sc1
    buffer_store_dwordx4 v[28:31], v235, s[48:51], s62 offen offset:2560 sc1
    v_accvgpr_read_b32 v104, a48
    v_accvgpr_read_b32 v105, a49
    v_accvgpr_read_b32 v106, a50
    v_accvgpr_read_b32 v107, a51
    v_accvgpr_read_b32 v108, a52
    v_accvgpr_read_b32 v109, a53
    v_accvgpr_read_b32 v110, a54
    v_accvgpr_read_b32 v111, a55
    v_accvgpr_read_b32 v112, a56
    v_accvgpr_read_b32 v113, a57
    v_accvgpr_read_b32 v114, a58
    v_accvgpr_read_b32 v115, a59
    v_accvgpr_read_b32 v116, a60
    v_accvgpr_read_b32 v117, a61
    v_accvgpr_read_b32 v118, a62
    v_accvgpr_read_b32 v119, a63
    v_pk_mul_f32 v[104:105], v[104:105], v[166:167] op_sel_hi:[1,0]
    v_pk_mul_f32 v[106:107], v[106:107], v[166:167] op_sel_hi:[1,0]
    v_pk_mul_f32 v[108:109], v[108:109], v[166:167] op_sel_hi:[1,0]
    v_pk_mul_f32 v[110:111], v[110:111], v[166:167] op_sel_hi:[1,0]
    v_pk_mul_f32 v[112:113], v[112:113], v[166:167] op_sel_hi:[1,0]
    v_pk_mul_f32 v[114:115], v[114:115], v[166:167] op_sel_hi:[1,0]
    v_pk_mul_f32 v[116:117], v[116:117], v[166:167] op_sel_hi:[1,0]
    v_pk_mul_f32 v[118:119], v[118:119], v[166:167] op_sel_hi:[1,0]
    v_cvt_pk_bf16_f32 v32, v104, v105
    v_cvt_pk_bf16_f32 v33, v106, v107
    v_cvt_pk_bf16_f32 v34, v108, v109
    v_cvt_pk_bf16_f32 v35, v110, v111
    v_cvt_pk_bf16_f32 v36, v112, v113
    v_cvt_pk_bf16_f32 v37, v114, v115
    v_cvt_pk_bf16_f32 v38, v116, v117
    v_cvt_pk_bf16_f32 v39, v118, v119
    buffer_store_dwordx4 v[32:35], v235, s[48:51], s62 offen offset:3072 sc1
    buffer_store_dwordx4 v[36:39], v235, s[48:51], s62 offen offset:3584 sc1
L_stdone:
    s_add_u32 s60, s20, 0
    s_and_b32 s60, s60, 3
    s_mul_i32 s61, s60, 5120
    s_lshl_b32 s60, s60, 10
    v_add_u32 v208, s61, v232
    v_add_u32 v220, s60, v236
    v_add_u32 v209, 61440, v208
    v_add_u32 v210, 122880, v208
    s_add_u32 s60, s20, 1
    s_and_b32 s60, s60, 3
    s_mul_i32 s61, s60, 5120
    s_lshl_b32 s60, s60, 10
    v_add_u32 v211, s61, v232
    v_add_u32 v221, s60, v236
    v_add_u32 v212, 61440, v211
    v_add_u32 v213, 122880, v211
    s_add_u32 s60, s20, 2
    s_and_b32 s60, s60, 3
    s_mul_i32 s61, s60, 5120
    s_lshl_b32 s60, s60, 10
    v_add_u32 v214, s61, v232
    v_add_u32 v222, s60, v236
    v_add_u32 v215, 61440, v214
    v_add_u32 v216, 122880, v214
    s_add_u32 s60, s20, 3
    s_and_b32 s60, s60, 3
    s_mul_i32 s61, s60, 5120
    s_lshl_b32 s60, s60, 10
    v_add_u32 v217, s61, v232
    v_add_u32 v223, s60, v236
    v_add_u32 v218, 61440, v217
    v_add_u32 v219, 122880, v217
    s_and_b32 s74, s27, 0xf8
    s_mul_i32 s74, s74, 36864
    s_add_u32 s68, s74, 32768
    s_lshl_b32 s60, s20, 13
    s_add_u32 s74, s74, s60
    s_lshl_b32 s60, s75, 1
    s_or_b32 s60, s60, 1
    v_mov_b32 v5, s60
    s_waitcnt vmcnt(0)
    s_cmp_eq_u32 s77, 0
    s_cbranch_scc1 L_slowfl
    buffer_store_dword v5, v251, s[48:51], s3 offen
    s_branch L_fldone
L_slowfl:
    buffer_store_dword v5, v251, s[48:51], s3 offen sc1
L_fldone:
    s_add_u32 s64, s23, 0
    s_and_b32 s64, s64, 7
    s_mul_i32 s64, s64, 36864
    s_add_u32 s62, s64, s68
    s_add_u32 s64, s64, s74
    s_add_u32 s63, s64, 4096
    buffer_load_dwordx4 a[0:3], v220, s[48:51], s64 offen sc1
    buffer_load_dwordx4 a[4:7], v220, s[48:51], s63 offen sc1
    buffer_load_dwordx4 a[32:35], v220, s[48:51], s62 offen sc1
    buffer_load_dwordx4 a[8:11], v221, s[48:51], s64 offen sc1
    buffer_load_dwordx4 a[12:15], v221, s[48:51], s63 offen sc1
    buffer_load_dwordx4 a[16:19], v222, s[48:51], s64 offen sc1
    buffer_load_dwordx4 a[20:23], v222, s[48:51], s63 offen sc1
    buffer_load_dwordx4 a[24:27], v223, s[48:51], s64 offen sc1
    buffer_load_dwordx4 a[28:31], v223, s[48:51], s63 offen sc1
    s_barrier
    buffer_load_dword v7, v249, s[48:51], s3 offen sc1
    s_add_u32 s65, s23, 6
    s_and_b32 s65, s65, 7
    s_mul_i32 s65, s65, 163840
    s_add_u32 m0, s72, 81920
    s_nop 0
    buffer_load_dwordx4 v227, s[44:47], s65 offen offset:0 lds
    buffer_load_dwordx4 v228, s[44:47], s65 offen offset:1024 lds
    buffer_load_dwordx4 v229, s[44:47], s65 offen offset:2048 lds
    buffer_load_dwordx4 v230, s[44:47], s65 offen offset:3072 lds
    s_add_u32 m0, s72, 86016
    s_nop 0
    buffer_load_dwordx4 v231, s[44:47], s65 offen lds
    s_add_u32 s65, s23, 7
    s_and_b32 s65, s65, 7
    s_mul_i32 s65, s65, 163840
    s_add_u32 m0, s72, 102400
    s_nop 0
    buffer_load_dwordx4 v227, s[44:47], s65 offen offset:0 lds
    buffer_load_dwordx4 v228, s[44:47], s65 offen offset:1024 lds
    buffer_load_dwordx4 v229, s[44:47], s65 offen offset:2048 lds
    buffer_load_dwordx4 v230, s[44:47], s65 offen offset:3072 lds
    s_add_u32 m0, s72, 106496
    s_nop 0
    buffer_load_dwordx4 v231, s[44:47], s65 offen lds
    ds_read_b64_tr_b16 v[128:129], v208 offset:0
    ds_read_b64_tr_b16 v[130:131], v208 offset:1280
    ds_read_b64_tr_b16 v[132:133], v208 offset:8
    ds_read_b64_tr_b16 v[134:135], v208 offset:1288
    ds_read_b64_tr_b16 v[136:137], v208 offset:16
    ds_read_b64_tr_b16 v[138:139], v208 offset:1296
    ds_read_b64_tr_b16 v[140:141], v208 offset:24
    ds_read_b64_tr_b16 v[142:143], v208 offset:1304
    ds_read_b64_tr_b16 v[144:145], v208 offset:32
    ds_read_b64_tr_b16 v[146:147], v208 offset:1312
    v_and_b32 v2, 15, v0
    v_lshrrev_b32 v1, 4, v0
    v_mul_u32_u24 v5, 336, v2
    v_mul_u32_u24 v3, 80, v1
    s_mul_i32 s60, s20, 5376
    v_add3_u32 v5, v5, v3, s60
    v_min_u32 v4, 39, v0
    v_mul_u32_u24 v3, 6554, v4
    v_lshrrev_b32 v3, 16, v3
    v_lshlrev_b32 v4, 5, v4
    v_lshl_add_u32 v4, v3, 4, v4
    s_mul_i32 s60, s20, 1344
    v_add_u32 v4, s60, v4
    s_waitcnt vmcnt(19) lgkmcnt(8)
    v_mfma_f32_16x16x32_bf16 v[56:59], v[128:131], a[0:3], 0
    ds_read_b64_tr_b16 v[148:149], v211 offset:0
    s_waitcnt vmcnt(18)
    v_mfma_f32_16x16x32_bf16 v[76:79], v[128:131], a[4:7], 0
    ds_read_b64_tr_b16 v[150:151], v211 offset:1280
    s_waitcnt vmcnt(17)
    v_mfma_f32_16x16x32_bf16 v[96:99], v[128:131], a[32:35], 0
    s_waitcnt lgkmcnt(8)
    ds_read_b64_tr_b16 v[152:153], v211 offset:8
    v_mfma_f32_16x16x32_bf16 v[60:63], v[132:135], a[0:3], 0
    ds_read_b64_tr_b16 v[154:155], v211 offset:1288
    v_mfma_f32_16x16x32_bf16 v[80:83], v[132:135], a[4:7], 0
    ds_read_b64_tr_b16 v[156:157], v211 offset:16
    v_mfma_f32_16x16x32_bf16 v[100:103], v[132:135], a[32:35], 0
    s_waitcnt lgkmcnt(9)
    ds_read_b64_tr_b16 v[158:159], v211 offset:1296
    v_mfma_f32_16x16x32_bf16 v[64:67], v[136:139], a[0:3], 0
    ds_read_b64_tr_b16 v[160:161], v211 offset:24
    v_mfma_f32_16x16x32_bf16 v[84:87], v[136:139], a[4:7], 0
    ds_read_b64_tr_b16 v[162:163], v211 offset:1304
    v_mfma_f32_16x16x32_bf16 v[104:107], v[136:139], a[32:35], 0
    s_waitcnt lgkmcnt(10)
    ds_read_b64_tr_b16 v[164:165], v211 offset:32
    v_mfma_f32_16x16x32_bf16 v[68:71], v[140:143], a[0:3], 0
    ds_read_b64_tr_b16 v[166:167], v211 offset:1312
    v_mfma_f32_16x16x32_bf16 v[88:91], v[140:143], a[4:7], 0
    v_mfma_f32_16x16x32_bf16 v[108:111], v[140:143], a[32:35], 0
    s_waitcnt lgkmcnt(10)
    v_mfma_f32_16x16x32_bf16 v[72:75], v[144:147], a[0:3], 0
    v_mfma_f32_16x16x32_bf16 v[92:95], v[144:147], a[4:7], 0
    v_mfma_f32_16x16x32_bf16 v[112:115], v[144:147], a[32:35], 0
    s_waitcnt vmcnt(10)
    v_and_b32 v7, 1, v7
    v_cmp_eq_u32 vcc, 1, v7
    s_cmp_eq_u64 vcc, exec
    s_cbranch_scc1 L_f1_x
    s_mov_b32 s69, 0
L_f1:
    buffer_load_dword v7, v249, s[48:51], s3 offen sc1
    s_waitcnt vmcnt(0)
    v_and_b32 v7, 1, v7
    v_cmp_eq_u32 vcc, 1, v7
    s_cmp_eq_u64 vcc, exec
    s_cbranch_scc1 L_f1_x
    s_add_u32 s69, s69, 1
    s_cmp_lt_u32 s69, 200000
    s_cbranch_scc1 L_f1
L_f1_x:
    s_add_u32 s64, s23, 1
    s_and_b32 s64, s64, 7
    s_mul_i32 s64, s64, 36864
    s_add_u32 s62, s64, s68
    s_add_u32 s64, s64, s74
    s_add_u32 s63, s64, 4096
    buffer_load_dwordx4 a[36:39], v220, s[48:51], s64 offen sc1
    s_waitcnt lgkmcnt(8)
    v_mfma_f32_16x16x32_bf16 v[56:59], v[148:151], a[8:11], v[56:59]
    ds_read_b64_tr_b16 v[128:129], v214 offset:0
    v_mfma_f32_16x16x32_bf16 v[76:79], v[148:151], a[12:15], v[76:79]
    s_waitcnt lgkmcnt(7)
    ds_read_b64_tr_b16 v[130:131], v214 offset:1280
    buffer_load_dwordx4 a[40:43], v220, s[48:51], s63 offen sc1
    v_mfma_f32_16x16x32_bf16 v[60:63], v[152:155], a[8:11], v[60:63]
    ds_read_b64_tr_b16 v[132:133], v214 offset:8
    v_mfma_f32_16x16x32_bf16 v[80:83], v[152:155], a[12:15], v[80:83]
    s_waitcnt lgkmcnt(7)
    ds_read_b64_tr_b16 v[134:135], v214 offset:1288
    v_mfma_f32_16x16x32_bf16 v[64:67], v[156:159], a[8:11], v[64:67]
    ds_read_b64_tr_b16 v[136:137], v214 offset:16
    buffer_load_dwordx4 a[68:71], v220, s[48:51], s62 offen sc1
    v_mfma_f32_16x16x32_bf16 v[84:87], v[156:159], a[12:15], v[84:87]
    s_waitcnt lgkmcnt(7)
    ds_read_b64_tr_b16 v[138:139], v214 offset:1296
    v_mfma_f32_16x16x32_bf16 v[68:71], v[160:163], a[8:11], v[68:71]
    ds_read_b64_tr_b16 v[140:141], v214 offset:24
    v_mfma_f32_16x16x32_bf16 v[88:91], v[160:163], a[12:15], v[88:91]
    s_waitcnt lgkmcnt(7)
    ds_read_b64_tr_b16 v[142:143], v214 offset:1304
    buffer_load_dwordx4 a[44:47], v221, s[48:51], s64 offen sc1
    v_mfma_f32_16x16x32_bf16 v[72:75], v[164:167], a[8:11], v[72:75]
    ds_read_b64_tr_b16 v[144:145], v214 offset:32
    v_mfma_f32_16x16x32_bf16 v[92:95], v[164:167], a[12:15], v[92:95]
    s_waitcnt lgkmcnt(7)
    ds_read_b64_tr_b16 v[146:147], v214 offset:1312
    v_mfma_f32_16x16x32_bf16 v[56:59], v[128:131], a[16:19], v[56:59]
    ds_read_b64_tr_b16 v[148:149], v217 offset:0
    buffer_load_dwordx4 a[48:51], v221, s[48:51], s63 offen sc1
    v_mfma_f32_16x16x32_bf16 v[76:79], v[128:131], a[20:23], v[76:79]
    s_waitcnt lgkmcnt(7)
    ds_read_b64_tr_b16 v[150:151], v217 offset:1280
    v_mfma_f32_16x16x32_bf16 v[60:63], v[132:135], a[16:19], v[60:63]
    ds_read_b64_tr_b16 v[152:153], v217 offset:8
    v_mfma_f32_16x16x32_bf16 v[80:83], v[132:135], a[20:23], v[80:83]
    s_waitcnt lgkmcnt(7)
    ds_read_b64_tr_b16 v[154:155], v217 offset:1288
    buffer_load_dwordx4 a[52:55], v222, s[48:51], s64 offen sc1
    v_mfma_f32_16x16x32_bf16 v[64:67], v[136:139], a[16:19], v[64:67]
    ds_read_b64_tr_b16 v[156:157], v217 offset:16
    v_mfma_f32_16x16x32_bf16 v[84:87], v[136:139], a[20:23], v[84:87]
    s_waitcnt lgkmcnt(7)
    ds_read_b64_tr_b16 v[158:159], v217 offset:1296
    v_mfma_f32_16x16x32_bf16 v[68:71], v[140:143], a[16:19], v[68:71]
    ds_read_b64_tr_b16 v[160:161], v217 offset:24
    buffer_load_dwordx4 a[56:59], v222, s[48:51], s63 offen sc1
    v_mfma_f32_16x16x32_bf16 v[88:91], v[140:143], a[20:23], v[88:91]
    s_waitcnt lgkmcnt(7)
    ds_read_b64_tr_b16 v[162:163], v217 offset:1304
    v_mfma_f32_16x16x32_bf16 v[72:75], v[144:147], a[16:19], v[72:75]
    ds_read_b64_tr_b16 v[164:165], v217 offset:32
    v_mfma_f32_16x16x32_bf16 v[92:95], v[144:147], a[20:23], v[92:95]
    s_waitcnt lgkmcnt(7)
    ds_read_b64_tr_b16 v[166:167], v217 offset:1312
    buffer_load_dwordx4 a[60:63], v223, s[48:51], s64 offen sc1
    v_mfma_f32_16x16x32_bf16 v[56:59], v[148:151], a[24:27], v[56:59]
    ds_read_b64_tr_b16 v[128:129], v208 offset:20480
    v_mfma_f32_16x16x32_bf16 v[76:79], v[148:151], a[28:31], v[76:79]
    s_waitcnt lgkmcnt(7)
    ds_read_b64_tr_b16 v[130:131], v208 offset:21760
    v_mfma_f32_16x16x32_bf16 v[60:63], v[152:155], a[24:27], v[60:63]
    ds_read_b64_tr_b16 v[132:133], v208 offset:20488
    buffer_load_dwordx4 a[64:67], v223, s[48:51], s63 offen sc1
    v_mfma_f32_16x16x32_bf16 v[80:83], v[152:155], a[28:31], v[80:83]
    s_waitcnt lgkmcnt(7)
    ds_read_b64_tr_b16 v[134:135], v208 offset:21768
    v_mfma_f32_16x16x32_bf16 v[64:67], v[156:159], a[24:27], v[64:67]
    ds_read_b64_tr_b16 v[136:137], v208 offset:20496
    v_mfma_f32_16x16x32_bf16 v[84:87], v[156:159], a[28:31], v[84:87]
    s_waitcnt lgkmcnt(7)
    ds_read_b64_tr_b16 v[138:139], v208 offset:21776
    v_mfma_f32_16x16x32_bf16 v[68:71], v[160:163], a[24:27], v[68:71]
    ds_read_b64_tr_b16 v[140:141], v208 offset:20504
    v_mfma_f32_16x16x32_bf16 v[88:91], v[160:163], a[28:31], v[88:91]
    s_waitcnt lgkmcnt(7)
    ds_read_b64_tr_b16 v[142:143], v208 offset:21784
    v_mfma_f32_16x16x32_bf16 v[72:75], v[164:167], a[24:27], v[72:75]
    ds_read_b64_tr_b16 v[144:145], v208 offset:20512
    v_mfma_f32_16x16x32_bf16 v[92:95], v[164:167], a[28:31], v[92:95]
    ds_read_b64_tr_b16 v[146:147], v208 offset:21792
    s_add_u32 s64, s23, 2
    s_and_b32 s64, s64, 7
    s_mul_i32 s64, s64, 36864
    s_add_u32 s62, s64, s68
    s_add_u32 s64, s64, s74
    s_add_u32 s63, s64, 4096
    buffer_load_dwordx4 a[72:75], v220, s[48:51], s64 offen sc1
    s_waitcnt vmcnt(9) lgkmcnt(8)
    v_mfma_f32_16x16x32_bf16 v[56:59], v[128:131], a[36:39], v[56:59]
    ds_read_b64_tr_b16 v[148:149], v211 offset:20480
    s_waitcnt vmcnt(8)
    v_mfma_f32_16x16x32_bf16 v[76:79], v[128:131], a[40:43], v[76:79]
    ds_read_b64_tr_b16 v[150:151], v211 offset:21760
    s_waitcnt vmcnt(7)
    v_mfma_f32_16x16x32_bf16 v[96:99], v[128:131], a[68:71], v[96:99]
    s_waitcnt lgkmcnt(8)
    ds_read_b64_tr_b16 v[152:153], v211 offset:20488
    v_mfma_f32_16x16x32_bf16 v[60:63], v[132:135], a[36:39], v[60:63]
    ds_read_b64_tr_b16 v[154:155], v211 offset:21768
    buffer_load_dwordx4 a[76:79], v220, s[48:51], s63 offen sc1
    v_mfma_f32_16x16x32_bf16 v[80:83], v[132:135], a[40:43], v[80:83]
    ds_read_b64_tr_b16 v[156:157], v211 offset:20496
    v_mfma_f32_16x16x32_bf16 v[100:103], v[132:135], a[68:71], v[100:103]
    s_waitcnt lgkmcnt(9)
    ds_read_b64_tr_b16 v[158:159], v211 offset:21776
    v_mfma_f32_16x16x32_bf16 v[64:67], v[136:139], a[36:39], v[64:67]
    ds_read_b64_tr_b16 v[160:161], v211 offset:20504
    v_mfma_f32_16x16x32_bf16 v[84:87], v[136:139], a[40:43], v[84:87]
    ds_read_b64_tr_b16 v[162:163], v211 offset:21784
    buffer_load_dwordx4 a[104:107], v220, s[48:51], s62 offen sc1
    v_mfma_f32_16x16x32_bf16 v[104:107], v[136:139], a[68:71], v[104:107]
    s_waitcnt lgkmcnt(10)
    ds_read_b64_tr_b16 v[164:165], v211 offset:20512
    v_mfma_f32_16x16x32_bf16 v[68:71], v[140:143], a[36:39], v[68:71]
    ds_read_b64_tr_b16 v[166:167], v211 offset:21792
    v_mfma_f32_16x16x32_bf16 v[88:91], v[140:143], a[40:43], v[88:91]
    v_mfma_f32_16x16x32_bf16 v[108:111], v[140:143], a[68:71], v[108:111]
    s_waitcnt lgkmcnt(10)
    buffer_load_dwordx4 a[80:83], v221, s[48:51], s64 offen sc1
    v_mfma_f32_16x16x32_bf16 v[72:75], v[144:147], a[36:39], v[72:75]
    v_mfma_f32_16x16x32_bf16 v[92:95], v[144:147], a[40:43], v[92:95]
    v_mfma_f32_16x16x32_bf16 v[112:115], v[144:147], a[68:71], v[112:115]
    s_waitcnt vmcnt(9) lgkmcnt(8)
    v_mfma_f32_16x16x32_bf16 v[56:59], v[148:151], a[44:47], v[56:59]
    ds_read_b64_tr_b16 v[128:129], v214 offset:20480
    buffer_load_dwordx4 a[84:87], v221, s[48:51], s63 offen sc1
    s_waitcnt vmcnt(9)
    v_mfma_f32_16x16x32_bf16 v[76:79], v[148:151], a[48:51], v[76:79]
    s_waitcnt lgkmcnt(7)
    ds_read_b64_tr_b16 v[130:131], v214 offset:21760
    v_mfma_f32_16x16x32_bf16 v[60:63], v[152:155], a[44:47], v[60:63]
    ds_read_b64_tr_b16 v[132:133], v214 offset:20488
    v_mfma_f32_16x16x32_bf16 v[80:83], v[152:155], a[48:51], v[80:83]
    s_waitcnt lgkmcnt(7)
    ds_read_b64_tr_b16 v[134:135], v214 offset:21768
    v_mfma_f32_16x16x32_bf16 v[64:67], v[156:159], a[44:47], v[64:67]
    ds_read_b64_tr_b16 v[136:137], v214 offset:20496
    buffer_load_dwordx4 a[88:91], v222, s[48:51], s64 offen sc1
    v_mfma_f32_16x16x32_bf16 v[84:87], v[156:159], a[48:51], v[84:87]
    s_waitcnt lgkmcnt(7)
    ds_read_b64_tr_b16 v[138:139], v214 offset:21776
    v_mfma_f32_16x16x32_bf16 v[68:71], v[160:163], a[44:47], v[68:71]
    ds_read_b64_tr_b16 v[140:141], v214 offset:20504
    v_mfma_f32_16x16x32_bf16 v[88:91], v[160:163], a[48:51], v[88:91]
    s_waitcnt lgkmcnt(7)
    ds_read_b64_tr_b16 v[142:143], v214 offset:21784
    v_mfma_f32_16x16x32_bf16 v[72:75], v[164:167], a[44:47], v[72:75]
    ds_read_b64_tr_b16 v[144:145], v214 offset:20512
    buffer_load_dwordx4 a[92:95], v222, s[48:51], s63 offen sc1
    v_mfma_f32_16x16x32_bf16 v[92:95], v[164:167], a[48:51], v[92:95]
    ds_read_b64_tr_b16 v[146:147], v214 offset:21792
    s_waitcnt vmcnt(10) lgkmcnt(8)
    v_mfma_f32_16x16x32_bf16 v[56:59], v[128:131], a[52:55], v[56:59]
    ds_read_b64_tr_b16 v[148:149], v217 offset:20480
    s_waitcnt vmcnt(9)
    v_mfma_f32_16x16x32_bf16 v[76:79], v[128:131], a[56:59], v[76:79]
    s_waitcnt lgkmcnt(7)
    ds_read_b64_tr_b16 v[150:151], v217 offset:21760
    v_mfma_f32_16x16x32_bf16 v[60:63], v[132:135], a[52:55], v[60:63]
    ds_read_b64_tr_b16 v[152:153], v217 offset:20488
    buffer_load_dwordx4 a[96:99], v223, s[48:51], s64 offen sc1
    v_mfma_f32_16x16x32_bf16 v[80:83], v[132:135], a[56:59], v[80:83]
    s_waitcnt lgkmcnt(7)
    ds_read_b64_tr_b16 v[154:155], v217 offset:21768
    v_mfma_f32_16x16x32_bf16 v[64:67], v[136:139], a[52:55], v[64:67]
    ds_read_b64_tr_b16 v[156:157], v217 offset:20496
    v_mfma_f32_16x16x32_bf16 v[84:87], v[136:139], a[56:59], v[84:87]
    s_waitcnt lgkmcnt(7)
    ds_read_b64_tr_b16 v[158:159], v217 offset:21776
    v_mfma_f32_16x16x32_bf16 v[68:71], v[140:143], a[52:55], v[68:71]
    ds_read_b64_tr_b16 v[160:161], v217 offset:20504
    buffer_load_dwordx4 a[100:103], v223, s[48:51], s63 offen sc1
    v_mfma_f32_16x16x32_bf16 v[88:91], v[140:143], a[56:59], v[88:91]
    s_waitcnt lgkmcnt(7)
    ds_read_b64_tr_b16 v[162:163], v217 offset:21784
    v_mfma_f32_16x16x32_bf16 v[72:75], v[144:147], a[52:55], v[72:75]
    ds_read_b64_tr_b16 v[164:165], v217 offset:20512
    v_mfma_f32_16x16x32_bf16 v[92:95], v[144:147], a[56:59], v[92:95]
    ds_read_b64_tr_b16 v[166:167], v217 offset:21792
    s_waitcnt vmcnt(10) lgkmcnt(8)
    v_mfma_f32_16x16x32_bf16 v[56:59], v[148:151], a[60:63], v[56:59]
    s_add_u32 s64, s23, 3
    s_and_b32 s64, s64, 7
    s_mul_i32 s64, s64, 36864
    s_add_u32 s62, s64, s68
    s_add_u32 s64, s64, s74
    s_add_u32 s63, s64, 4096
    ds_read_b64_tr_b16 v[128:129], v208 offset:40960
    buffer_load_dwordx4 a[108:111], v220, s[48:51], s64 offen sc1
    s_waitcnt vmcnt(10)
    v_mfma_f32_16x16x32_bf16 v[76:79], v[148:151], a[64:67], v[76:79]
    s_waitcnt lgkmcnt(7)
    ds_read_b64_tr_b16 v[130:131], v208 offset:42240
    v_mfma_f32_16x16x32_bf16 v[60:63], v[152:155], a[60:63], v[60:63]
    ds_read_b64_tr_b16 v[132:133], v208 offset:40968
    v_mfma_f32_16x16x32_bf16 v[80:83], v[152:155], a[64:67], v[80:83]
    s_waitcnt lgkmcnt(7)
    ds_read_b64_tr_b16 v[134:135], v208 offset:42248
    v_mfma_f32_16x16x32_bf16 v[64:67], v[156:159], a[60:63], v[64:67]
    ds_read_b64_tr_b16 v[136:137], v208 offset:40976
    buffer_load_dwordx4 a[112:115], v220, s[48:51], s63 offen sc1
    v_mfma_f32_16x16x32_bf16 v[84:87], v[156:159], a[64:67], v[84:87]
    s_waitcnt lgkmcnt(7)
    ds_read_b64_tr_b16 v[138:139], v208 offset:42256
    v_mfma_f32_16x16x32_bf16 v[68:71], v[160:163], a[60:63], v[68:71]
    ds_read_b64_tr_b16 v[140:141], v208 offset:40984
    v_mfma_f32_16x16x32_bf16 v[88:91], v[160:163], a[64:67], v[88:91]
    s_waitcnt lgkmcnt(7)
    ds_read_b64_tr_b16 v[142:143], v208 offset:42264
    v_mfma_f32_16x16x32_bf16 v[72:75], v[164:167], a[60:63], v[72:75]
    ds_read_b64_tr_b16 v[144:145], v208 offset:40992
    v_mfma_f32_16x16x32_bf16 v[92:95], v[164:167], a[64:67], v[92:95]
    ds_read_b64_tr_b16 v[146:147], v208 offset:42272
    buffer_load_dwordx4 a[140:143], v220, s[48:51], s62 offen sc1
    s_waitcnt vmcnt(11) lgkmcnt(8)
    v_mfma_f32_16x16x32_bf16 v[56:59], v[128:131], a[72:75], v[56:59]
    ds_read_b64_tr_b16 v[148:149], v211 offset:40960
    s_waitcnt vmcnt(10)
    v_mfma_f32_16x16x32_bf16 v[76:79], v[128:131], a[76:79], v[76:79]
    ds_read_b64_tr_b16 v[150:151], v211 offset:42240
    s_waitcnt vmcnt(9)
    v_mfma_f32_16x16x32_bf16 v[96:99], v[128:131], a[104:107], v[96:99]
    s_waitcnt lgkmcnt(8)
    ds_read_b64_tr_b16 v[152:153], v211 offset:40968
    v_mfma_f32_16x16x32_bf16 v[60:63], v[132:135], a[72:75], v[60:63]
    ds_read_b64_tr_b16 v[154:155], v211 offset:42248
    buffer_load_dwordx4 a[116:119], v221, s[48:51], s64 offen sc1
    v_mfma_f32_16x16x32_bf16 v[80:83], v[132:135], a[76:79], v[80:83]
    ds_read_b64_tr_b16 v[156:157], v211 offset:40976
    v_mfma_f32_16x16x32_bf16 v[100:103], v[132:135], a[104:107], v[100:103]
    s_waitcnt lgkmcnt(9)
    ds_read_b64_tr_b16 v[158:159], v211 offset:42256
    v_mfma_f32_16x16x32_bf16 v[64:67], v[136:139], a[72:75], v[64:67]
    ds_read_b64_tr_b16 v[160:161], v211 offset:40984
    v_mfma_f32_16x16x32_bf16 v[84:87], v[136:139], a[76:79], v[84:87]
    ds_read_b64_tr_b16 v[162:163], v211 offset:42264
    buffer_load_dwordx4 a[120:123], v221, s[48:51], s63 offen sc1
    v_mfma_f32_16x16x32_bf16 v[104:107], v[136:139], a[104:107], v[104:107]
    s_waitcnt lgkmcnt(10)
    ds_read_b64_tr_b16 v[164:165], v211 offset:40992
    v_mfma_f32_16x16x32_bf16 v[68:71], v[140:143], a[72:75], v[68:71]
    ds_read_b64_tr_b16 v[166:167], v211 offset:42272
    v_mfma_f32_16x16x32_bf16 v[88:91], v[140:143], a[76:79], v[88:91]
    v_mfma_f32_16x16x32_bf16 v[108:111], v[140:143], a[104:107], v[108:111]
    s_waitcnt lgkmcnt(10)
    buffer_load_dwordx4 a[124:127], v222, s[48:51], s64 offen sc1
    v_mfma_f32_16x16x32_bf16 v[72:75], v[144:147], a[72:75], v[72:75]
    v_mfma_f32_16x16x32_bf16 v[92:95], v[144:147], a[76:79], v[92:95]
    v_mfma_f32_16x16x32_bf16 v[112:115], v[144:147], a[104:107], v[112:115]
    s_waitcnt vmcnt(11) lgkmcnt(8)
    v_mfma_f32_16x16x32_bf16 v[56:59], v[148:151], a[80:83], v[56:59]
    ds_read_b64_tr_b16 v[128:129], v214 offset:40960
    buffer_load_dwordx4 a[128:131], v222, s[48:51], s63 offen sc1
    s_waitcnt vmcnt(11)
    v_mfma_f32_16x16x32_bf16 v[76:79], v[148:151], a[84:87], v[76:79]
    s_waitcnt lgkmcnt(7)
    ds_read_b64_tr_b16 v[130:131], v214 offset:42240
    v_mfma_f32_16x16x32_bf16 v[60:63], v[152:155], a[80:83], v[60:63]
    ds_read_b64_tr_b16 v[132:133], v214 offset:40968
    v_mfma_f32_16x16x32_bf16 v[80:83], v[152:155], a[84:87], v[80:83]
    s_waitcnt lgkmcnt(7)
    ds_read_b64_tr_b16 v[134:135], v214 offset:42248
    v_mfma_f32_16x16x32_bf16 v[64:67], v[156:159], a[80:83], v[64:67]
    ds_read_b64_tr_b16 v[136:137], v214 offset:40976
    buffer_load_dwordx4 a[132:135], v223, s[48:51], s64 offen sc1
    v_mfma_f32_16x16x32_bf16 v[84:87], v[156:159], a[84:87], v[84:87]
    s_waitcnt lgkmcnt(7)
    ds_read_b64_tr_b16 v[138:139], v214 offset:42256
    v_mfma_f32_16x16x32_bf16 v[68:71], v[160:163], a[80:83], v[68:71]
    ds_read_b64_tr_b16 v[140:141], v214 offset:40984
    v_mfma_f32_16x16x32_bf16 v[88:91], v[160:163], a[84:87], v[88:91]
    s_waitcnt lgkmcnt(7)
    ds_read_b64_tr_b16 v[142:143], v214 offset:42264
    v_mfma_f32_16x16x32_bf16 v[72:75], v[164:167], a[80:83], v[72:75]
    ds_read_b64_tr_b16 v[144:145], v214 offset:40992
    buffer_load_dwordx4 a[136:139], v223, s[48:51], s63 offen sc1
    v_mfma_f32_16x16x32_bf16 v[92:95], v[164:167], a[84:87], v[92:95]
    ds_read_b64_tr_b16 v[146:147], v214 offset:42272
    s_waitcnt vmcnt(12) lgkmcnt(8)
    v_mfma_f32_16x16x32_bf16 v[56:59], v[128:131], a[88:91], v[56:59]
    ds_read_b64_tr_b16 v[148:149], v217 offset:40960
    s_waitcnt vmcnt(11)
    v_mfma_f32_16x16x32_bf16 v[76:79], v[128:131], a[92:95], v[76:79]
    s_waitcnt lgkmcnt(7)
    ds_read_b64_tr_b16 v[150:151], v217 offset:42240
    v_mfma_f32_16x16x32_bf16 v[60:63], v[132:135], a[88:91], v[60:63]
    s_add_u32 s64, s23, 4
    s_and_b32 s64, s64, 7
    s_mul_i32 s64, s64, 36864
    s_add_u32 s62, s64, s68
    s_add_u32 s64, s64, s74
    s_add_u32 s63, s64, 4096
    ds_read_b64_tr_b16 v[152:153], v217 offset:40968
    buffer_load_dwordx4 a[144:147], v220, s[48:51], s64 offen sc1
    v_mfma_f32_16x16x32_bf16 v[80:83], v[132:135], a[92:95], v[80:83]
    s_waitcnt lgkmcnt(7)
    ds_read_b64_tr_b16 v[154:155], v217 offset:42248
    v_mfma_f32_16x16x32_bf16 v[64:67], v[136:139], a[88:91], v[64:67]
    ds_read_b64_tr_b16 v[156:157], v217 offset:40976
    v_mfma_f32_16x16x32_bf16 v[84:87], v[136:139], a[92:95], v[84:87]
    s_waitcnt lgkmcnt(7)
    ds_read_b64_tr_b16 v[158:159], v217 offset:42256
    v_mfma_f32_16x16x32_bf16 v[68:71], v[140:143], a[88:91], v[68:71]
    ds_read_b64_tr_b16 v[160:161], v217 offset:40984
    buffer_load_dwordx4 a[148:151], v220, s[48:51], s63 offen sc1
    v_mfma_f32_16x16x32_bf16 v[88:91], v[140:143], a[92:95], v[88:91]
    s_waitcnt lgkmcnt(7)
    ds_read_b64_tr_b16 v[162:163], v217 offset:42264
    v_mfma_f32_16x16x32_bf16 v[72:75], v[144:147], a[88:91], v[72:75]
    ds_read_b64_tr_b16 v[164:165], v217 offset:40992
    v_mfma_f32_16x16x32_bf16 v[92:95], v[144:147], a[92:95], v[92:95]
    ds_read_b64_tr_b16 v[166:167], v217 offset:42272
    s_waitcnt vmcnt(12) lgkmcnt(8)
    v_mfma_f32_16x16x32_bf16 v[56:59], v[148:151], a[96:99], v[56:59]
    ds_read_b64_tr_b16 v[128:129], v210 offset:20480
    buffer_load_dwordx4 a[176:179], v220, s[48:51], s62 offen sc1
    s_waitcnt vmcnt(12)
    v_mfma_f32_16x16x32_bf16 v[76:79], v[148:151], a[100:103], v[76:79]
    s_waitcnt lgkmcnt(7)
    ds_read_b64_tr_b16 v[130:131], v210 offset:21760
    v_mfma_f32_16x16x32_bf16 v[60:63], v[152:155], a[96:99], v[60:63]
    ds_read_b64_tr_b16 v[132:133], v210 offset:20488
    v_mfma_f32_16x16x32_bf16 v[80:83], v[152:155], a[100:103], v[80:83]
    s_waitcnt lgkmcnt(7)
    ds_read_b64_tr_b16 v[134:135], v210 offset:21768
    v_mfma_f32_16x16x32_bf16 v[64:67], v[156:159], a[96:99], v[64:67]
    ds_read_b64_tr_b16 v[136:137], v210 offset:20496
    buffer_load_dwordx4 a[152:155], v221, s[48:51], s64 offen sc1
    v_mfma_f32_16x16x32_bf16 v[84:87], v[156:159], a[100:103], v[84:87]
    s_waitcnt lgkmcnt(7)
    ds_read_b64_tr_b16 v[138:139], v210 offset:21776
    v_mfma_f32_16x16x32_bf16 v[68:71], v[160:163], a[96:99], v[68:71]
    ds_read_b64_tr_b16 v[140:141], v210 offset:20504
    v_mfma_f32_16x16x32_bf16 v[88:91], v[160:163], a[100:103], v[88:91]
    s_waitcnt lgkmcnt(7)
    ds_read_b64_tr_b16 v[142:143], v210 offset:21784
    v_mfma_f32_16x16x32_bf16 v[72:75], v[164:167], a[96:99], v[72:75]
    ds_read_b64_tr_b16 v[144:145], v210 offset:20512
    v_mfma_f32_16x16x32_bf16 v[92:95], v[164:167], a[100:103], v[92:95]
    ds_read_b64_tr_b16 v[146:147], v210 offset:21792
    buffer_load_dwordx4 a[156:159], v221, s[48:51], s63 offen sc1
    s_waitcnt vmcnt(13) lgkmcnt(8)
    v_mfma_f32_16x16x32_bf16 v[56:59], v[128:131], a[108:111], v[56:59]
    ds_read_b64_tr_b16 v[148:149], v213 offset:20480
    s_waitcnt vmcnt(12)
    v_mfma_f32_16x16x32_bf16 v[76:79], v[128:131], a[112:115], v[76:79]
    ds_read_b64_tr_b16 v[150:151], v213 offset:21760
    s_waitcnt vmcnt(11)
    v_mfma_f32_16x16x32_bf16 v[96:99], v[128:131], a[140:143], v[96:99]
    s_waitcnt lgkmcnt(8)
    ds_read_b64_tr_b16 v[152:153], v213 offset:20488
    v_mfma_f32_16x16x32_bf16 v[60:63], v[132:135], a[108:111], v[60:63]
    ds_read_b64_tr_b16 v[154:155], v213 offset:21768
    buffer_load_dwordx4 a[160:163], v222, s[48:51], s64 offen sc1
    v_mfma_f32_16x16x32_bf16 v[80:83], v[132:135], a[112:115], v[80:83]
    ds_read_b64_tr_b16 v[156:157], v213 offset:20496
    v_mfma_f32_16x16x32_bf16 v[100:103], v[132:135], a[140:143], v[100:103]
    s_waitcnt lgkmcnt(9)
    ds_read_b64_tr_b16 v[158:159], v213 offset:21776
    v_mfma_f32_16x16x32_bf16 v[64:67], v[136:139], a[108:111], v[64:67]
    ds_read_b64_tr_b16 v[160:161], v213 offset:20504
    v_mfma_f32_16x16x32_bf16 v[84:87], v[136:139], a[112:115], v[84:87]
    ds_read_b64_tr_b16 v[162:163], v213 offset:21784
    buffer_load_dwordx4 a[164:167], v222, s[48:51], s63 offen sc1
    v_mfma_f32_16x16x32_bf16 v[104:107], v[136:139], a[140:143], v[104:107]
    s_waitcnt lgkmcnt(10)
    ds_read_b64_tr_b16 v[164:165], v213 offset:20512
    v_mfma_f32_16x16x32_bf16 v[68:71], v[140:143], a[108:111], v[68:71]
    ds_read_b64_tr_b16 v[166:167], v213 offset:21792
    v_mfma_f32_16x16x32_bf16 v[88:91], v[140:143], a[112:115], v[88:91]
    v_mfma_f32_16x16x32_bf16 v[108:111], v[140:143], a[140:143], v[108:111]
    s_waitcnt lgkmcnt(10)
    buffer_load_dwordx4 a[168:171], v223, s[48:51], s64 offen sc1
    v_mfma_f32_16x16x32_bf16 v[72:75], v[144:147], a[108:111], v[72:75]
    v_mfma_f32_16x16x32_bf16 v[92:95], v[144:147], a[112:115], v[92:95]
    v_mfma_f32_16x16x32_bf16 v[112:115], v[144:147], a[140:143], v[112:115]
    s_waitcnt vmcnt(13) lgkmcnt(8)
    v_mfma_f32_16x16x32_bf16 v[56:59], v[148:151], a[116:119], v[56:59]
    ds_read_b64_tr_b16 v[128:129], v216 offset:20480
    buffer_load_dwordx4 a[172:175], v223, s[48:51], s63 offen sc1
    s_waitcnt vmcnt(13)
    v_mfma_f32_16x16x32_bf16 v[76:79], v[148:151], a[120:123], v[76:79]
    s_waitcnt lgkmcnt(7)
    ds_read_b64_tr_b16 v[130:131], v216 offset:21760
    v_mfma_f32_16x16x32_bf16 v[60:63], v[152:155], a[116:119], v[60:63]
    ds_read_b64_tr_b16 v[132:133], v216 offset:20488
    v_mfma_f32_16x16x32_bf16 v[80:83], v[152:155], a[120:123], v[80:83]
    s_waitcnt lgkmcnt(7)
    ds_read_b64_tr_b16 v[134:135], v216 offset:21768
    v_mfma_f32_16x16x32_bf16 v[64:67], v[156:159], a[116:119], v[64:67]
    s_add_u32 s64, s23, 5
    s_and_b32 s64, s64, 7
    s_mul_i32 s64, s64, 36864
    s_add_u32 s62, s64, s68
    s_add_u32 s64, s64, s74
    s_add_u32 s63, s64, 4096
    ds_read_b64_tr_b16 v[136:137], v216 offset:20496
    buffer_load_dwordx4 a[180:183], v220, s[48:51], s64 offen sc1
    v_mfma_f32_16x16x32_bf16 v[84:87], v[156:159], a[120:123], v[84:87]
    s_waitcnt lgkmcnt(7)
    ds_read_b64_tr_b16 v[138:139], v216 offset:21776
    v_mfma_f32_16x16x32_bf16 v[68:71], v[160:163], a[116:119], v[68:71]
    ds_read_b64_tr_b16 v[140:141], v216 offset:20504
    v_mfma_f32_16x16x32_bf16 v[88:91], v[160:163], a[120:123], v[88:91]
    s_waitcnt lgkmcnt(7)
    ds_read_b64_tr_b16 v[142:143], v216 offset:21784
    v_mfma_f32_16x16x32_bf16 v[72:75], v[164:167], a[116:119], v[72:75]
    ds_read_b64_tr_b16 v[144:145], v216 offset:20512
    buffer_load_dwordx4 a[184:187], v220, s[48:51], s63 offen sc1
    v_mfma_f32_16x16x32_bf16 v[92:95], v[164:167], a[120:123], v[92:95]
    ds_read_b64_tr_b16 v[146:147], v216 offset:21792
    s_waitcnt vmcnt(14) lgkmcnt(8)
    v_mfma_f32_16x16x32_bf16 v[56:59], v[128:131], a[124:127], v[56:59]
    ds_read_b64_tr_b16 v[148:149], v219 offset:20480
    s_waitcnt vmcnt(13)
    v_mfma_f32_16x16x32_bf16 v[76:79], v[128:131], a[128:131], v[76:79]
    s_waitcnt lgkmcnt(7)
    ds_read_b64_tr_b16 v[150:151], v219 offset:21760
    v_mfma_f32_16x16x32_bf16 v[60:63], v[132:135], a[124:127], v[60:63]
    ds_read_b64_tr_b16 v[152:153], v219 offset:20488
    buffer_load_dwordx4 a[212:215], v220, s[48:51], s62 offen sc1
    v_mfma_f32_16x16x32_bf16 v[80:83], v[132:135], a[128:131], v[80:83]
    s_waitcnt lgkmcnt(7)
    ds_read_b64_tr_b16 v[154:155], v219 offset:21768
    v_mfma_f32_16x16x32_bf16 v[64:67], v[136:139], a[124:127], v[64:67]
    ds_read_b64_tr_b16 v[156:157], v219 offset:20496
    v_mfma_f32_16x16x32_bf16 v[84:87], v[136:139], a[128:131], v[84:87]
    s_waitcnt lgkmcnt(7)
    ds_read_b64_tr_b16 v[158:159], v219 offset:21776
    v_mfma_f32_16x16x32_bf16 v[68:71], v[140:143], a[124:127], v[68:71]
    ds_read_b64_tr_b16 v[160:161], v219 offset:20504
    buffer_load_dwordx4 a[188:191], v221, s[48:51], s64 offen sc1
    v_mfma_f32_16x16x32_bf16 v[88:91], v[140:143], a[128:131], v[88:91]
    s_waitcnt lgkmcnt(7)
    ds_read_b64_tr_b16 v[162:163], v219 offset:21784
    v_mfma_f32_16x16x32_bf16 v[72:75], v[144:147], a[124:127], v[72:75]
    ds_read_b64_tr_b16 v[164:165], v219 offset:20512
    v_mfma_f32_16x16x32_bf16 v[92:95], v[144:147], a[128:131], v[92:95]
    ds_read_b64_tr_b16 v[166:167], v219 offset:21792
    s_waitcnt vmcnt(14) lgkmcnt(8)
    v_mfma_f32_16x16x32_bf16 v[56:59], v[148:151], a[132:135], v[56:59]
    ds_read_b64_tr_b16 v[128:129], v210 offset:0
    buffer_load_dwordx4 a[192:195], v221, s[48:51], s63 offen sc1
    s_waitcnt vmcnt(14)
    v_mfma_f32_16x16x32_bf16 v[76:79], v[148:151], a[136:139], v[76:79]
    s_waitcnt lgkmcnt(7)
    ds_read_b64_tr_b16 v[130:131], v210 offset:1280
    v_mfma_f32_16x16x32_bf16 v[60:63], v[152:155], a[132:135], v[60:63]
    ds_read_b64_tr_b16 v[132:133], v210 offset:8
    v_mfma_f32_16x16x32_bf16 v[80:83], v[152:155], a[136:139], v[80:83]
    s_waitcnt lgkmcnt(7)
    ds_read_b64_tr_b16 v[134:135], v210 offset:1288
    v_mfma_f32_16x16x32_bf16 v[64:67], v[156:159], a[132:135], v[64:67]
    ds_read_b64_tr_b16 v[136:137], v210 offset:16
    buffer_load_dwordx4 a[196:199], v222, s[48:51], s64 offen sc1
    v_mfma_f32_16x16x32_bf16 v[84:87], v[156:159], a[136:139], v[84:87]
    s_waitcnt lgkmcnt(7)
    ds_read_b64_tr_b16 v[138:139], v210 offset:1296
    v_mfma_f32_16x16x32_bf16 v[68:71], v[160:163], a[132:135], v[68:71]
    ds_read_b64_tr_b16 v[140:141], v210 offset:24
    v_mfma_f32_16x16x32_bf16 v[88:91], v[160:163], a[136:139], v[88:91]
    s_waitcnt lgkmcnt(7)
    ds_read_b64_tr_b16 v[142:143], v210 offset:1304
    v_mfma_f32_16x16x32_bf16 v[72:75], v[164:167], a[132:135], v[72:75]
    ds_read_b64_tr_b16 v[144:145], v210 offset:32
    v_mfma_f32_16x16x32_bf16 v[92:95], v[164:167], a[136:139], v[92:95]
    ds_read_b64_tr_b16 v[146:147], v210 offset:1312
    buffer_load_dwordx4 a[200:203], v222, s[48:51], s63 offen sc1
    s_waitcnt vmcnt(15) lgkmcnt(8)
    v_mfma_f32_16x16x32_bf16 v[56:59], v[128:131], a[144:147], v[56:59]
    ds_read_b64_tr_b16 v[148:149], v213 offset:0
    s_waitcnt vmcnt(14)
    v_mfma_f32_16x16x32_bf16 v[76:79], v[128:131], a[148:151], v[76:79]
    ds_read_b64_tr_b16 v[150:151], v213 offset:1280
    s_waitcnt vmcnt(13)
    v_mfma_f32_16x16x32_bf16 v[96:99], v[128:131], a[176:179], v[96:99]
    s_waitcnt lgkmcnt(8)
    ds_read_b64_tr_b16 v[152:153], v213 offset:8
    v_mfma_f32_16x16x32_bf16 v[60:63], v[132:135], a[144:147], v[60:63]
    ds_read_b64_tr_b16 v[154:155], v213 offset:1288
    buffer_load_dwordx4 a[204:207], v223, s[48:51], s64 offen sc1
    v_mfma_f32_16x16x32_bf16 v[80:83], v[132:135], a[148:151], v[80:83]
    ds_read_b64_tr_b16 v[156:157], v213 offset:16
    v_mfma_f32_16x16x32_bf16 v[100:103], v[132:135], a[176:179], v[100:103]
    s_waitcnt lgkmcnt(9)
    ds_read_b64_tr_b16 v[158:159], v213 offset:1296
    v_mfma_f32_16x16x32_bf16 v[64:67], v[136:139], a[144:147], v[64:67]
    ds_read_b64_tr_b16 v[160:161], v213 offset:24
    v_mfma_f32_16x16x32_bf16 v[84:87], v[136:139], a[148:151], v[84:87]
    ds_read_b64_tr_b16 v[162:163], v213 offset:1304
    buffer_load_dwordx4 a[208:211], v223, s[48:51], s63 offen sc1
    v_mfma_f32_16x16x32_bf16 v[104:107], v[136:139], a[176:179], v[104:107]
    s_waitcnt lgkmcnt(10)
    ds_read_b64_tr_b16 v[164:165], v213 offset:32
    v_mfma_f32_16x16x32_bf16 v[68:71], v[140:143], a[144:147], v[68:71]
    ds_read_b64_tr_b16 v[166:167], v213 offset:1312
    v_mfma_f32_16x16x32_bf16 v[88:91], v[140:143], a[148:151], v[88:91]
    v_mfma_f32_16x16x32_bf16 v[108:111], v[140:143], a[176:179], v[108:111]
    s_waitcnt lgkmcnt(10)
    s_add_u32 s64, s23, 6
    s_and_b32 s64, s64, 7
    s_mul_i32 s64, s64, 36864
    s_add_u32 s62, s64, s68
    s_add_u32 s64, s64, s74
    s_add_u32 s63, s64, 4096
    buffer_load_dwordx4 a[216:219], v220, s[48:51], s64 offen sc1
    v_mfma_f32_16x16x32_bf16 v[72:75], v[144:147], a[144:147], v[72:75]
    v_mfma_f32_16x16x32_bf16 v[92:95], v[144:147], a[148:151], v[92:95]
    v_mfma_f32_16x16x32_bf16 v[112:115], v[144:147], a[176:179], v[112:115]
    s_waitcnt vmcnt(15) lgkmcnt(8)
    v_mfma_f32_16x16x32_bf16 v[56:59], v[148:151], a[152:155], v[56:59]
    ds_read_b64_tr_b16 v[128:129], v216 offset:0
    buffer_load_dwordx4 a[220:223], v220, s[48:51], s63 offen sc1
    s_waitcnt vmcnt(15)
    v_mfma_f32_16x16x32_bf16 v[76:79], v[148:151], a[156:159], v[76:79]
    s_waitcnt lgkmcnt(7)
    ds_read_b64_tr_b16 v[130:131], v216 offset:1280
    v_mfma_f32_16x16x32_bf16 v[60:63], v[152:155], a[152:155], v[60:63]
    ds_read_b64_tr_b16 v[132:133], v216 offset:8
    v_mfma_f32_16x16x32_bf16 v[80:83], v[152:155], a[156:159], v[80:83]
    s_waitcnt lgkmcnt(7)
    ds_read_b64_tr_b16 v[134:135], v216 offset:1288
    v_mfma_f32_16x16x32_bf16 v[64:67], v[156:159], a[152:155], v[64:67]
    ds_read_b64_tr_b16 v[136:137], v216 offset:16
    buffer_load_dwordx4 a[248:251], v220, s[48:51], s62 offen sc1
    v_mfma_f32_16x16x32_bf16 v[84:87], v[156:159], a[156:159], v[84:87]
    s_waitcnt lgkmcnt(7)
    ds_read_b64_tr_b16 v[138:139], v216 offset:1296
    v_mfma_f32_16x16x32_bf16 v[68:71], v[160:163], a[152:155], v[68:71]
    ds_read_b64_tr_b16 v[140:141], v216 offset:24
    v_mfma_f32_16x16x32_bf16 v[88:91], v[160:163], a[156:159], v[88:91]
    s_waitcnt lgkmcnt(7)
    ds_read_b64_tr_b16 v[142:143], v216 offset:1304
    v_mfma_f32_16x16x32_bf16 v[72:75], v[164:167], a[152:155], v[72:75]
    ds_read_b64_tr_b16 v[144:145], v216 offset:32
    buffer_load_dwordx4 a[224:227], v221, s[48:51], s64 offen sc1
    v_mfma_f32_16x16x32_bf16 v[92:95], v[164:167], a[156:159], v[92:95]
    ds_read_b64_tr_b16 v[146:147], v216 offset:1312
    s_waitcnt vmcnt(16) lgkmcnt(8)
    v_mfma_f32_16x16x32_bf16 v[56:59], v[128:131], a[160:163], v[56:59]
    ds_read_b64_tr_b16 v[148:149], v219 offset:0
    s_waitcnt vmcnt(15)
    v_mfma_f32_16x16x32_bf16 v[76:79], v[128:131], a[164:167], v[76:79]
    s_waitcnt lgkmcnt(7)
    ds_read_b64_tr_b16 v[150:151], v219 offset:1280
    v_mfma_f32_16x16x32_bf16 v[60:63], v[132:135], a[160:163], v[60:63]
    ds_read_b64_tr_b16 v[152:153], v219 offset:8
    buffer_load_dwordx4 a[228:231], v221, s[48:51], s63 offen sc1
    v_mfma_f32_16x16x32_bf16 v[80:83], v[132:135], a[164:167], v[80:83]
    s_waitcnt lgkmcnt(7)
    ds_read_b64_tr_b16 v[154:155], v219 offset:1288
    v_mfma_f32_16x16x32_bf16 v[64:67], v[136:139], a[160:163], v[64:67]
    ds_read_b64_tr_b16 v[156:157], v219 offset:16
    v_mfma_f32_16x16x32_bf16 v[84:87], v[136:139], a[164:167], v[84:87]
    s_waitcnt lgkmcnt(7)
    ds_read_b64_tr_b16 v[158:159], v219 offset:1296
    v_mfma_f32_16x16x32_bf16 v[68:71], v[140:143], a[160:163], v[68:71]
    ds_read_b64_tr_b16 v[160:161], v219 offset:24
    buffer_load_dwordx4 a[232:235], v222, s[48:51], s64 offen sc1
    v_mfma_f32_16x16x32_bf16 v[88:91], v[140:143], a[164:167], v[88:91]
    s_waitcnt lgkmcnt(7)
    ds_read_b64_tr_b16 v[162:163], v219 offset:1304
    v_mfma_f32_16x16x32_bf16 v[72:75], v[144:147], a[160:163], v[72:75]
    ds_read_b64_tr_b16 v[164:165], v219 offset:32
    v_mfma_f32_16x16x32_bf16 v[92:95], v[144:147], a[164:167], v[92:95]
    ds_read_b64_tr_b16 v[166:167], v219 offset:1312
    s_waitcnt vmcnt(16) lgkmcnt(8)
    v_mfma_f32_16x16x32_bf16 v[56:59], v[148:151], a[168:171], v[56:59]
    ds_read_b64_tr_b16 v[128:129], v209 offset:0
    buffer_load_dwordx4 a[236:239], v222, s[48:51], s63 offen sc1
    s_waitcnt vmcnt(16)
    v_mfma_f32_16x16x32_bf16 v[76:79], v[148:151], a[172:175], v[76:79]
    s_waitcnt lgkmcnt(7)
    ds_read_b64_tr_b16 v[130:131], v209 offset:1280
    v_mfma_f32_16x16x32_bf16 v[60:63], v[152:155], a[168:171], v[60:63]
    ds_read_b64_tr_b16 v[132:133], v209 offset:8
    v_mfma_f32_16x16x32_bf16 v[80:83], v[152:155], a[172:175], v[80:83]
    s_waitcnt lgkmcnt(7)
    ds_read_b64_tr_b16 v[134:135], v209 offset:1288
    v_mfma_f32_16x16x32_bf16 v[64:67], v[156:159], a[168:171], v[64:67]
    ds_read_b64_tr_b16 v[136:137], v209 offset:16
    buffer_load_dwordx4 a[240:243], v223, s[48:51], s64 offen sc1
    v_mfma_f32_16x16x32_bf16 v[84:87], v[156:159], a[172:175], v[84:87]
    s_waitcnt lgkmcnt(7)
    ds_read_b64_tr_b16 v[138:139], v209 offset:1296
    v_mfma_f32_16x16x32_bf16 v[68:71], v[160:163], a[168:171], v[68:71]
    ds_read_b64_tr_b16 v[140:141], v209 offset:24
    v_mfma_f32_16x16x32_bf16 v[88:91], v[160:163], a[172:175], v[88:91]
    s_waitcnt lgkmcnt(7)
    ds_read_b64_tr_b16 v[142:143], v209 offset:1304
    v_mfma_f32_16x16x32_bf16 v[72:75], v[164:167], a[168:171], v[72:75]
    ds_read_b64_tr_b16 v[144:145], v209 offset:32
    v_mfma_f32_16x16x32_bf16 v[92:95], v[164:167], a[172:175], v[92:95]
    ds_read_b64_tr_b16 v[146:147], v209 offset:1312
    buffer_load_dwordx4 a[244:247], v223, s[48:51], s63 offen sc1
    s_waitcnt vmcnt(17) lgkmcnt(8)
    v_mfma_f32_16x16x32_bf16 v[56:59], v[128:131], a[180:183], v[56:59]
    ds_read_b64_tr_b16 v[148:149], v212 offset:0
    s_waitcnt vmcnt(16)
    v_mfma_f32_16x16x32_bf16 v[76:79], v[128:131], a[184:187], v[76:79]
    ds_read_b64_tr_b16 v[150:151], v212 offset:1280
    s_waitcnt vmcnt(15)
    v_mfma_f32_16x16x32_bf16 v[96:99], v[128:131], a[212:215], v[96:99]
    s_waitcnt lgkmcnt(8)
    s_add_u32 s64, s23, 7
    s_and_b32 s64, s64, 7
    s_mul_i32 s64, s64, 36864
    s_add_u32 s62, s64, s68
    s_add_u32 s64, s64, s74
    s_add_u32 s63, s64, 4096
    ds_read_b64_tr_b16 v[152:153], v212 offset:8
    buffer_load_dwordx4 a[0:3], v220, s[48:51], s64 offen sc1
    v_mfma_f32_16x16x32_bf16 v[60:63], v[132:135], a[180:183], v[60:63]
    ds_read_b64_tr_b16 v[154:155], v212 offset:1288
    v_mfma_f32_16x16x32_bf16 v[80:83], v[132:135], a[184:187], v[80:83]
    ds_read_b64_tr_b16 v[156:157], v212 offset:16
    v_mfma_f32_16x16x32_bf16 v[100:103], v[132:135], a[212:215], v[100:103]
    s_waitcnt lgkmcnt(9)
    ds_read_b64_tr_b16 v[158:159], v212 offset:1296
    v_mfma_f32_16x16x32_bf16 v[64:67], v[136:139], a[180:183], v[64:67]
    ds_read_b64_tr_b16 v[160:161], v212 offset:24
    buffer_load_dwordx4 a[4:7], v220, s[48:51], s63 offen sc1
    v_mfma_f32_16x16x32_bf16 v[84:87], v[136:139], a[184:187], v[84:87]
    ds_read_b64_tr_b16 v[162:163], v212 offset:1304
    v_mfma_f32_16x16x32_bf16 v[104:107], v[136:139], a[212:215], v[104:107]
    s_waitcnt lgkmcnt(10)
    ds_read_b64_tr_b16 v[164:165], v212 offset:32
    v_mfma_f32_16x16x32_bf16 v[68:71], v[140:143], a[180:183], v[68:71]
    ds_read_b64_tr_b16 v[166:167], v212 offset:1312
    v_mfma_f32_16x16x32_bf16 v[88:91], v[140:143], a[184:187], v[88:91]
    buffer_load_dwordx4 a[32:35], v220, s[48:51], s62 offen sc1
    v_mfma_f32_16x16x32_bf16 v[108:111], v[140:143], a[212:215], v[108:111]
    s_barrier
    s_waitcnt lgkmcnt(10)
    v_mfma_f32_16x16x32_bf16 v[72:75], v[144:147], a[180:183], v[72:75]
    v_mfma_f32_16x16x32_bf16 v[92:95], v[144:147], a[184:187], v[92:95]
    buffer_load_dwordx4 a[8:11], v221, s[48:51], s64 offen sc1
    v_mfma_f32_16x16x32_bf16 v[112:115], v[144:147], a[212:215], v[112:115]
    s_waitcnt vmcnt(18) lgkmcnt(8)
    v_mfma_f32_16x16x32_bf16 v[56:59], v[148:151], a[188:191], v[56:59]
    ds_read_b64_tr_b16 v[128:129], v215 offset:0
    s_waitcnt vmcnt(17)
    v_mfma_f32_16x16x32_bf16 v[76:79], v[148:151], a[192:195], v[76:79]
    s_waitcnt lgkmcnt(7)
    ds_read_b64_tr_b16 v[130:131], v215 offset:1280
    v_mfma_f32_16x16x32_bf16 v[60:63], v[152:155], a[188:191], v[60:63]
    ds_read_b64_tr_b16 v[132:133], v215 offset:8
    buffer_load_dwordx4 a[12:15], v221, s[48:51], s63 offen sc1
    v_mfma_f32_16x16x32_bf16 v[80:83], v[152:155], a[192:195], v[80:83]
    s_waitcnt lgkmcnt(7)
    ds_read_b64_tr_b16 v[134:135], v215 offset:1288
    v_mfma_f32_16x16x32_bf16 v[64:67], v[156:159], a[188:191], v[64:67]
    ds_read_b64_tr_b16 v[136:137], v215 offset:16
    v_mfma_f32_16x16x32_bf16 v[84:87], v[156:159], a[192:195], v[84:87]
    s_waitcnt lgkmcnt(7)
    ds_read_b64_tr_b16 v[138:139], v215 offset:1296
    v_mfma_f32_16x16x32_bf16 v[68:71], v[160:163], a[188:191], v[68:71]
    ds_read_b64_tr_b16 v[140:141], v215 offset:24
    buffer_load_dwordx4 a[16:19], v222, s[48:51], s64 offen sc1
    v_mfma_f32_16x16x32_bf16 v[88:91], v[160:163], a[192:195], v[88:91]
    s_waitcnt lgkmcnt(7)
    ds_read_b64_tr_b16 v[142:143], v215 offset:1304
    v_mfma_f32_16x16x32_bf16 v[72:75], v[164:167], a[188:191], v[72:75]
    ds_read_b64_tr_b16 v[144:145], v215 offset:32
    v_mfma_f32_16x16x32_bf16 v[92:95], v[164:167], a[192:195], v[92:95]
    ds_read_b64_tr_b16 v[146:147], v215 offset:1312
    buffer_load_dwordx4 a[20:23], v222, s[48:51], s63 offen sc1
    s_waitcnt vmcnt(19) lgkmcnt(8)
    v_mfma_f32_16x16x32_bf16 v[56:59], v[128:131], a[196:199], v[56:59]
    ds_read_b64_tr_b16 v[148:149], v218 offset:0
    s_waitcnt vmcnt(18)
    v_mfma_f32_16x16x32_bf16 v[76:79], v[128:131], a[200:203], v[76:79]
    s_waitcnt lgkmcnt(7)
    ds_read_b64_tr_b16 v[150:151], v218 offset:1280
    v_mfma_f32_16x16x32_bf16 v[60:63], v[132:135], a[196:199], v[60:63]
    ds_read_b64_tr_b16 v[152:153], v218 offset:8
    v_mfma_f32_16x16x32_bf16 v[80:83], v[132:135], a[200:203], v[80:83]
    s_waitcnt lgkmcnt(7)
    ds_read_b64_tr_b16 v[154:155], v218 offset:1288
    buffer_load_dwordx4 a[24:27], v223, s[48:51], s64 offen sc1
    v_mfma_f32_16x16x32_bf16 v[64:67], v[136:139], a[196:199], v[64:67]
    ds_read_b64_tr_b16 v[156:157], v218 offset:16
    v_mfma_f32_16x16x32_bf16 v[84:87], v[136:139], a[200:203], v[84:87]
    s_waitcnt lgkmcnt(7)
    ds_read_b64_tr_b16 v[158:159], v218 offset:1296
    v_mfma_f32_16x16x32_bf16 v[68:71], v[140:143], a[196:199], v[68:71]
    ds_read_b64_tr_b16 v[160:161], v218 offset:24
    v_mfma_f32_16x16x32_bf16 v[88:91], v[140:143], a[200:203], v[88:91]
    s_waitcnt lgkmcnt(7)
    ds_read_b64_tr_b16 v[162:163], v218 offset:1304
    buffer_load_dwordx4 a[28:31], v223, s[48:51], s63 offen sc1
    v_mfma_f32_16x16x32_bf16 v[72:75], v[144:147], a[196:199], v[72:75]
    ds_read_b64_tr_b16 v[164:165], v218 offset:32
    v_mfma_f32_16x16x32_bf16 v[92:95], v[144:147], a[200:203], v[92:95]
    ds_read_b64_tr_b16 v[166:167], v218 offset:1312
    s_waitcnt vmcnt(19) lgkmcnt(8)
    v_mfma_f32_16x16x32_bf16 v[56:59], v[148:151], a[204:207], v[56:59]
    ds_read_b64_tr_b16 v[128:129], v209 offset:20480
    s_waitcnt vmcnt(18)
    v_mfma_f32_16x16x32_bf16 v[76:79], v[148:151], a[208:211], v[76:79]
    s_waitcnt lgkmcnt(7)
    ds_read_b64_tr_b16 v[130:131], v209 offset:21760
    v_mfma_f32_16x16x32_bf16 v[60:63], v[152:155], a[204:207], v[60:63]
    ds_read_b64_tr_b16 v[132:133], v209 offset:20488
    v_mfma_f32_16x16x32_bf16 v[80:83], v[152:155], a[208:211], v[80:83]
    s_waitcnt lgkmcnt(7)
    ds_read_b64_tr_b16 v[134:135], v209 offset:21768
    v_mfma_f32_16x16x32_bf16 v[64:67], v[156:159], a[204:207], v[64:67]
    ds_read_b64_tr_b16 v[136:137], v209 offset:20496
    v_mfma_f32_16x16x32_bf16 v[84:87], v[156:159], a[208:211], v[84:87]
    s_waitcnt lgkmcnt(7)
    ds_read_b64_tr_b16 v[138:139], v209 offset:21776
    v_mfma_f32_16x16x32_bf16 v[68:71], v[160:163], a[204:207], v[68:71]
    ds_read_b64_tr_b16 v[140:141], v209 offset:20504
    v_mfma_f32_16x16x32_bf16 v[88:91], v[160:163], a[208:211], v[88:91]
    s_waitcnt lgkmcnt(7)
    ds_read_b64_tr_b16 v[142:143], v209 offset:21784
    v_mfma_f32_16x16x32_bf16 v[72:75], v[164:167], a[204:207], v[72:75]
    ds_read_b64_tr_b16 v[144:145], v209 offset:20512
    v_mfma_f32_16x16x32_bf16 v[92:95], v[164:167], a[208:211], v[92:95]
    ds_read_b64_tr_b16 v[146:147], v209 offset:21792
    s_waitcnt vmcnt(17) lgkmcnt(8)
    v_mfma_f32_16x16x32_bf16 v[56:59], v[128:131], a[216:219], v[56:59]
    ds_read_b64_tr_b16 v[148:149], v212 offset:20480
    s_waitcnt vmcnt(16)
    v_mfma_f32_16x16x32_bf16 v[76:79], v[128:131], a[220:223], v[76:79]
    ds_read_b64_tr_b16 v[150:151], v212 offset:21760
    s_waitcnt vmcnt(15)
    v_mfma_f32_16x16x32_bf16 v[96:99], v[128:131], a[248:251], v[96:99]
    s_waitcnt lgkmcnt(8)
    ds_read_b64_tr_b16 v[152:153], v212 offset:20488
    v_mfma_f32_16x16x32_bf16 v[60:63], v[132:135], a[216:219], v[60:63]
    ds_read_b64_tr_b16 v[154:155], v212 offset:21768
    v_mfma_f32_16x16x32_bf16 v[80:83], v[132:135], a[220:223], v[80:83]
    ds_read_b64_tr_b16 v[156:157], v212 offset:20496
    v_mfma_f32_16x16x32_bf16 v[100:103], v[132:135], a[248:251], v[100:103]
    s_waitcnt lgkmcnt(9)
    ds_read_b64_tr_b16 v[158:159], v212 offset:21776
    v_mfma_f32_16x16x32_bf16 v[64:67], v[136:139], a[216:219], v[64:67]
    ds_read_b64_tr_b16 v[160:161], v212 offset:20504
    v_mfma_f32_16x16x32_bf16 v[84:87], v[136:139], a[220:223], v[84:87]
    ds_read_b64_tr_b16 v[162:163], v212 offset:21784
    v_mfma_f32_16x16x32_bf16 v[104:107], v[136:139], a[248:251], v[104:107]
    s_waitcnt lgkmcnt(10)
    ds_read_b64_tr_b16 v[164:165], v212 offset:20512
    v_mfma_f32_16x16x32_bf16 v[68:71], v[140:143], a[216:219], v[68:71]
    ds_read_b64_tr_b16 v[166:167], v212 offset:21792
    v_mfma_f32_16x16x32_bf16 v[88:91], v[140:143], a[220:223], v[88:91]
    v_mfma_f32_16x16x32_bf16 v[108:111], v[140:143], a[248:251], v[108:111]
    s_waitcnt lgkmcnt(10)
    v_mfma_f32_16x16x32_bf16 v[72:75], v[144:147], a[216:219], v[72:75]
    v_mfma_f32_16x16x32_bf16 v[92:95], v[144:147], a[220:223], v[92:95]
    v_mfma_f32_16x16x32_bf16 v[112:115], v[144:147], a[248:251], v[112:115]
    s_waitcnt vmcnt(14) lgkmcnt(8)
    v_mfma_f32_16x16x32_bf16 v[56:59], v[148:151], a[224:227], v[56:59]
    ds_read_b64_tr_b16 v[128:129], v215 offset:20480
    s_waitcnt vmcnt(13)
    v_mfma_f32_16x16x32_bf16 v[76:79], v[148:151], a[228:231], v[76:79]
    s_waitcnt lgkmcnt(7)
    ds_read_b64_tr_b16 v[130:131], v215 offset:21760
    v_mfma_f32_16x16x32_bf16 v[60:63], v[152:155], a[224:227], v[60:63]
    ds_read_b64_tr_b16 v[132:133], v215 offset:20488
    v_mfma_f32_16x16x32_bf16 v[80:83], v[152:155], a[228:231], v[80:83]
    s_waitcnt lgkmcnt(7)
    ds_read_b64_tr_b16 v[134:135], v215 offset:21768
    v_mfma_f32_16x16x32_bf16 v[64:67], v[156:159], a[224:227], v[64:67]
    ds_read_b64_tr_b16 v[136:137], v215 offset:20496
    v_mfma_f32_16x16x32_bf16 v[84:87], v[156:159], a[228:231], v[84:87]
    s_waitcnt lgkmcnt(7)
    ds_read_b64_tr_b16 v[138:139], v215 offset:21776
    v_mfma_f32_16x16x32_bf16 v[68:71], v[160:163], a[224:227], v[68:71]
    ds_read_b64_tr_b16 v[140:141], v215 offset:20504
    v_mfma_f32_16x16x32_bf16 v[88:91], v[160:163], a[228:231], v[88:91]
    s_waitcnt lgkmcnt(7)
    ds_read_b64_tr_b16 v[142:143], v215 offset:21784
    v_mfma_f32_16x16x32_bf16 v[72:75], v[164:167], a[224:227], v[72:75]
    ds_read_b64_tr_b16 v[144:145], v215 offset:20512
    v_mfma_f32_16x16x32_bf16 v[92:95], v[164:167], a[228:231], v[92:95]
    ds_read_b64_tr_b16 v[146:147], v215 offset:21792
    s_waitcnt vmcnt(12) lgkmcnt(8)
    v_mfma_f32_16x16x32_bf16 v[56:59], v[128:131], a[232:235], v[56:59]
    ds_read_b64_tr_b16 v[148:149], v218 offset:20480
    s_waitcnt vmcnt(11)
    v_mfma_f32_16x16x32_bf16 v[76:79], v[128:131], a[236:239], v[76:79]
    s_waitcnt lgkmcnt(7)
    ds_read_b64_tr_b16 v[150:151], v218 offset:21760
    v_mfma_f32_16x16x32_bf16 v[60:63], v[132:135], a[232:235], v[60:63]
    ds_read_b64_tr_b16 v[152:153], v218 offset:20488
    v_mfma_f32_16x16x32_bf16 v[80:83], v[132:135], a[236:239], v[80:83]
    s_waitcnt lgkmcnt(7)
    ds_read_b64_tr_b16 v[154:155], v218 offset:21768
    v_mfma_f32_16x16x32_bf16 v[64:67], v[136:139], a[232:235], v[64:67]
    ds_read_b64_tr_b16 v[156:157], v218 offset:20496
    v_mfma_f32_16x16x32_bf16 v[84:87], v[136:139], a[236:239], v[84:87]
    s_waitcnt lgkmcnt(7)
    ds_read_b64_tr_b16 v[158:159], v218 offset:21776
    v_mfma_f32_16x16x32_bf16 v[68:71], v[140:143], a[232:235], v[68:71]
    ds_read_b64_tr_b16 v[160:161], v218 offset:20504
    v_mfma_f32_16x16x32_bf16 v[88:91], v[140:143], a[236:239], v[88:91]
    s_waitcnt lgkmcnt(7)
    ds_read_b64_tr_b16 v[162:163], v218 offset:21784
    v_mfma_f32_16x16x32_bf16 v[72:75], v[144:147], a[232:235], v[72:75]
    ds_read_b64_tr_b16 v[164:165], v218 offset:20512
    v_mfma_f32_16x16x32_bf16 v[92:95], v[144:147], a[236:239], v[92:95]
    ds_read_b64_tr_b16 v[166:167], v218 offset:21792
    s_waitcnt vmcnt(10) lgkmcnt(8)
    v_mfma_f32_16x16x32_bf16 v[56:59], v[148:151], a[240:243], v[56:59]
    ds_read_b64_tr_b16 v[128:129], v209 offset:40960
    s_waitcnt vmcnt(9)
    v_mfma_f32_16x16x32_bf16 v[76:79], v[148:151], a[244:247], v[76:79]
    s_waitcnt lgkmcnt(7)
    ds_read_b64_tr_b16 v[130:131], v209 offset:42240
    v_mfma_f32_16x16x32_bf16 v[60:63], v[152:155], a[240:243], v[60:63]
    ds_read_b64_tr_b16 v[132:133], v209 offset:40968
    v_mfma_f32_16x16x32_bf16 v[80:83], v[152:155], a[244:247], v[80:83]
    s_waitcnt lgkmcnt(7)
    ds_read_b64_tr_b16 v[134:135], v209 offset:42248
    v_mfma_f32_16x16x32_bf16 v[64:67], v[156:159], a[240:243], v[64:67]
    ds_read_b64_tr_b16 v[136:137], v209 offset:40976
    v_mfma_f32_16x16x32_bf16 v[84:87], v[156:159], a[244:247], v[84:87]
    s_waitcnt lgkmcnt(7)
    ds_read_b64_tr_b16 v[138:139], v209 offset:42256
    v_mfma_f32_16x16x32_bf16 v[68:71], v[160:163], a[240:243], v[68:71]
    ds_read_b64_tr_b16 v[140:141], v209 offset:40984
    v_mfma_f32_16x16x32_bf16 v[88:91], v[160:163], a[244:247], v[88:91]
    s_waitcnt lgkmcnt(7)
    ds_read_b64_tr_b16 v[142:143], v209 offset:42264
    v_mfma_f32_16x16x32_bf16 v[72:75], v[164:167], a[240:243], v[72:75]
    ds_read_b64_tr_b16 v[144:145], v209 offset:40992
    v_mfma_f32_16x16x32_bf16 v[92:95], v[164:167], a[244:247], v[92:95]
    ds_read_b64_tr_b16 v[146:147], v209 offset:42272
    s_lshl_b32 s60, s20, 3
    s_add_u32 s60, s60, s2
    s_cmp_lt_u32 s60, 8
    s_cbranch_scc0 L_nowb
    buffer_wbl2 sc1
L_nowb:
    s_waitcnt vmcnt(8) lgkmcnt(8)
    v_mfma_f32_16x16x32_bf16 v[56:59], v[128:131], a[0:3], v[56:59]
    ds_read_b64_tr_b16 v[148:149], v212 offset:40960
    s_waitcnt vmcnt(7)
    v_mfma_f32_16x16x32_bf16 v[76:79], v[128:131], a[4:7], v[76:79]
    ds_read_b64_tr_b16 v[150:151], v212 offset:42240
    s_waitcnt vmcnt(6)
    v_mfma_f32_16x16x32_bf16 v[96:99], v[128:131], a[32:35], v[96:99]
    s_waitcnt lgkmcnt(8)
    ds_read_b64_tr_b16 v[152:153], v212 offset:40968
    v_mfma_f32_16x16x32_bf16 v[60:63], v[132:135], a[0:3], v[60:63]
    ds_read_b64_tr_b16 v[154:155], v212 offset:42248
    v_mfma_f32_16x16x32_bf16 v[80:83], v[132:135], a[4:7], v[80:83]
    ds_read_b64_tr_b16 v[156:157], v212 offset:40976
    v_mfma_f32_16x16x32_bf16 v[100:103], v[132:135], a[32:35], v[100:103]
    s_waitcnt lgkmcnt(9)
    ds_read_b64_tr_b16 v[158:159], v212 offset:42256
    v_mfma_f32_16x16x32_bf16 v[64:67], v[136:139], a[0:3], v[64:67]
    ds_read_b64_tr_b16 v[160:161], v212 offset:40984
    v_mfma_f32_16x16x32_bf16 v[84:87], v[136:139], a[4:7], v[84:87]
    ds_read_b64_tr_b16 v[162:163], v212 offset:42264
    v_mfma_f32_16x16x32_bf16 v[104:107], v[136:139], a[32:35], v[104:107]
    s_waitcnt lgkmcnt(10)
    ds_read_b64_tr_b16 v[164:165], v212 offset:40992
    v_mfma_f32_16x16x32_bf16 v[68:71], v[140:143], a[0:3], v[68:71]
    ds_read_b64_tr_b16 v[166:167], v212 offset:42272
    v_mfma_f32_16x16x32_bf16 v[88:91], v[140:143], a[4:7], v[88:91]
    v_mfma_f32_16x16x32_bf16 v[108:111], v[140:143], a[32:35], v[108:111]
    s_waitcnt lgkmcnt(10)
    v_mfma_f32_16x16x32_bf16 v[72:75], v[144:147], a[0:3], v[72:75]
    v_mfma_f32_16x16x32_bf16 v[92:95], v[144:147], a[4:7], v[92:95]
    v_mfma_f32_16x16x32_bf16 v[112:115], v[144:147], a[32:35], v[112:115]
    s_waitcnt vmcnt(5) lgkmcnt(8)
    v_mfma_f32_16x16x32_bf16 v[56:59], v[148:151], a[8:11], v[56:59]
    ds_read_b64_tr_b16 v[128:129], v215 offset:40960
    s_waitcnt vmcnt(4)
    v_mfma_f32_16x16x32_bf16 v[76:79], v[148:151], a[12:15], v[76:79]
    s_waitcnt lgkmcnt(7)
    ds_read_b64_tr_b16 v[130:131], v215 offset:42240
    v_mfma_f32_16x16x32_bf16 v[60:63], v[152:155], a[8:11], v[60:63]
    ds_read_b64_tr_b16 v[132:133], v215 offset:40968
    ds_write_b128 v5, v[96:99] offset:0
    v_mfma_f32_16x16x32_bf16 v[80:83], v[152:155], a[12:15], v[80:83]
    s_waitcnt lgkmcnt(8)
    ds_read_b64_tr_b16 v[134:135], v215 offset:42248
    v_mfma_f32_16x16x32_bf16 v[64:67], v[156:159], a[8:11], v[64:67]
    ds_read_b64_tr_b16 v[136:137], v215 offset:40976
    ds_write_b128 v5, v[100:103] offset:16
    v_mfma_f32_16x16x32_bf16 v[84:87], v[156:159], a[12:15], v[84:87]
    s_waitcnt lgkmcnt(9)
    ds_read_b64_tr_b16 v[138:139], v215 offset:42256
    v_mfma_f32_16x16x32_bf16 v[68:71], v[160:163], a[8:11], v[68:71]
    ds_read_b64_tr_b16 v[140:141], v215 offset:40984
    ds_write_b128 v5, v[104:107] offset:32
    v_mfma_f32_16x16x32_bf16 v[88:91], v[160:163], a[12:15], v[88:91]
    s_waitcnt lgkmcnt(10)
    ds_read_b64_tr_b16 v[142:143], v215 offset:42264
    v_mfma_f32_16x16x32_bf16 v[72:75], v[164:167], a[8:11], v[72:75]
    ds_read_b64_tr_b16 v[144:145], v215 offset:40992
    ds_write_b128 v5, v[108:111] offset:48
    v_mfma_f32_16x16x32_bf16 v[92:95], v[164:167], a[12:15], v[92:95]
    ds_read_b64_tr_b16 v[146:147], v215 offset:42272
    s_waitcnt vmcnt(3) lgkmcnt(12)
    v_mfma_f32_16x16x32_bf16 v[56:59], v[128:131], a[16:19], v[56:59]
    ds_read_b64_tr_b16 v[148:149], v218 offset:40960
    ds_write_b128 v5, v[112:115] offset:64
    s_waitcnt vmcnt(2)
    v_mfma_f32_16x16x32_bf16 v[76:79], v[128:131], a[20:23], v[76:79]
    s_waitcnt lgkmcnt(11)
    ds_read_b64_tr_b16 v[150:151], v218 offset:42240
    v_mfma_f32_16x16x32_bf16 v[60:63], v[132:135], a[16:19], v[60:63]
    ds_read_b64_tr_b16 v[152:153], v218 offset:40968
    v_mfma_f32_16x16x32_bf16 v[80:83], v[132:135], a[20:23], v[80:83]
    s_waitcnt lgkmcnt(10)
    ds_read_b64_tr_b16 v[154:155], v218 offset:42248
    v_mfma_f32_16x16x32_bf16 v[64:67], v[136:139], a[16:19], v[64:67]
    ds_read_b64_tr_b16 v[156:157], v218 offset:40976
    v_mfma_f32_16x16x32_bf16 v[84:87], v[136:139], a[20:23], v[84:87]
    s_waitcnt lgkmcnt(9)
    ds_read_b64_tr_b16 v[158:159], v218 offset:42256
    v_mfma_f32_16x16x32_bf16 v[68:71], v[140:143], a[16:19], v[68:71]
    ds_read_b64_tr_b16 v[160:161], v218 offset:40984
    v_mfma_f32_16x16x32_bf16 v[88:91], v[140:143], a[20:23], v[88:91]
    s_waitcnt lgkmcnt(8)
    ds_read_b64_tr_b16 v[162:163], v218 offset:42264
    v_mfma_f32_16x16x32_bf16 v[72:75], v[144:147], a[16:19], v[72:75]
    ds_read_b64_tr_b16 v[164:165], v218 offset:40992
    v_mfma_f32_16x16x32_bf16 v[92:95], v[144:147], a[20:23], v[92:95]
    s_waitcnt lgkmcnt(0)
    s_barrier
    ds_read_b64_tr_b16 v[166:167], v218 offset:42272
    s_waitcnt vmcnt(1)
    v_mfma_f32_16x16x32_bf16 v[56:59], v[148:151], a[24:27], v[56:59]
    ds_read_b128 v[176:179], v4 offset:0
    s_waitcnt vmcnt(0)
    v_mfma_f32_16x16x32_bf16 v[76:79], v[148:151], a[28:31], v[76:79]
    ds_read_b128 v[180:183], v4 offset:16
    v_mfma_f32_16x16x32_bf16 v[60:63], v[152:155], a[24:27], v[60:63]
    ds_read_b128 v[184:187], v4 offset:5376
    v_mfma_f32_16x16x32_bf16 v[80:83], v[152:155], a[28:31], v[80:83]
    ds_read_b128 v[188:191], v4 offset:5392
    v_mfma_f32_16x16x32_bf16 v[64:67], v[156:159], a[24:27], v[64:67]
    ds_read_b128 v[192:195], v4 offset:10752
    v_mfma_f32_16x16x32_bf16 v[84:87], v[156:159], a[28:31], v[84:87]
    ds_read_b128 v[196:199], v4 offset:10768
    v_mfma_f32_16x16x32_bf16 v[68:71], v[160:163], a[24:27], v[68:71]
    ds_read_b128 v[200:203], v4 offset:16128
    v_mfma_f32_16x16x32_bf16 v[88:91], v[160:163], a[28:31], v[88:91]
    s_waitcnt lgkmcnt(7)
    ds_read_b128 v[204:207], v4 offset:16144
    v_mfma_f32_16x16x32_bf16 v[72:75], v[164:167], a[24:27], v[72:75]
    v_mfma_f32_16x16x32_bf16 v[92:95], v[164:167], a[28:31], v[92:95]
    v_cmp_ne_u32 vcc, 0, v253
    s_cmp_eq_u64 vcc, exec
    s_cbranch_scc1 L_inb_x
    v_and_b32 v3, 12, v249
    s_mov_b32 s69, 0
L_inb:
    buffer_load_dword v253, v3, s[48:51], s19 offen sc1
    s_waitcnt vmcnt(0)
    v_cmp_ne_u32 vcc, 0, v253
    s_cmp_eq_u64 vcc, exec
    s_cbranch_scc1 L_inb_x
    s_add_u32 s69, s69, 1
    s_cmp_lt_u32 s69, 200000
    s_cbranch_scc1 L_inb
L_inb_x:
    s_mul_i32 s61, s21, 4608
    s_sub_u32 s61, s18, s61
    v_lshlrev_b32 v3, 3, v0
    s_mov_b32 s68, 0xfffffffe
    v_cvt_pk_bf16_f32 v128, v56, v57
    v_cvt_pk_bf16_f32 v129, v58, v59
    v_cvt_pk_bf16_f32 v130, v60, v61
    v_cvt_pk_bf16_f32 v131, v62, v63
    v_cvt_pk_bf16_f32 v132, v64, v65
    v_cvt_pk_bf16_f32 v133, v66, v67
    s_add_u32 s63, s21, 3
    s_and_b32 s63, s63, 3
    s_cmp_eq_u32 s63, 3
    s_cselect_b32 s50, 0, 0x10000000
    s_lshl_b32 s63, s63, 9
    v_min_u32 v128, s68, v128
    v_min_u32 v129, s68, v129
    v_min_u32 v130, s68, v130
    v_min_u32 v131, s68, v131
    v_min_u32 v132, s68, v132
    v_min_u32 v133, s68, v133
    s_add_u32 s62, s61, 0
    s_add_u32 s62, s62, s63
    s_add_u32 s63, s63, s62
    buffer_store_dwordx4 v[128:131], v236, s[48:51], s63 offen sc1
    buffer_store_dwordx2 v[132:133], v3, s[48:51], s62 offen offset:3072 sc1
    v_cvt_pk_bf16_f32 v134, v68, v69
    v_cvt_pk_bf16_f32 v135, v70, v71
    v_cvt_pk_bf16_f32 v136, v72, v73
    v_cvt_pk_bf16_f32 v137, v74, v75
    v_cvt_pk_bf16_f32 v138, v76, v77
    v_cvt_pk_bf16_f32 v139, v78, v79
    s_add_u32 s63, s21, 2
    s_and_b32 s63, s63, 3
    s_cmp_eq_u32 s63, 3
    s_cselect_b32 s50, 0, 0x10000000
    s_lshl_b32 s63, s63, 9
    v_min_u32 v134, s68, v134
    v_min_u32 v135, s68, v135
    v_min_u32 v136, s68, v136
    v_min_u32 v137, s68, v137
    v_min_u32 v138, s68, v138
    v_min_u32 v139, s68, v139
    s_add_u32 s62, s61, 4608
    s_add_u32 s62, s62, s63
    s_add_u32 s63, s63, s62
    buffer_store_dwordx4 v[134:137], v236, s[48:51], s63 offen sc1
    buffer_store_dwordx2 v[138:139], v3, s[48:51], s62 offen offset:3072 sc1
    v_cvt_pk_bf16_f32 v140, v80, v81
    v_cvt_pk_bf16_f32 v141, v82, v83
    v_cvt_pk_bf16_f32 v142, v84, v85
    v_cvt_pk_bf16_f32 v143, v86, v87
    v_cvt_pk_bf16_f32 v144, v88, v89
    v_cvt_pk_bf16_f32 v145, v90, v91
    s_add_u32 s63, s21, 1
    s_and_b32 s63, s63, 3
    s_cmp_eq_u32 s63, 3
    s_cselect_b32 s50, 0, 0x10000000
    s_lshl_b32 s63, s63, 9
    v_min_u32 v140, s68, v140
    v_min_u32 v141, s68, v141
    v_min_u32 v142, s68, v142
    v_min_u32 v143, s68, v143
    v_min_u32 v144, s68, v144
    v_min_u32 v145, s68, v145
    s_add_u32 s62, s61, 9216
    s_add_u32 s62, s62, s63
    s_add_u32 s63, s63, s62
    buffer_store_dwordx4 v[140:143], v236, s[48:51], s63 offen sc1
    buffer_store_dwordx2 v[144:145], v3, s[48:51], s62 offen offset:3072 sc1
    s_waitcnt lgkmcnt(5)
    v_pk_add_f32 v[176:177], v[176:177], v[184:185]
    v_pk_add_f32 v[178:179], v[178:179], v[186:187]
    s_waitcnt lgkmcnt(4)
    v_pk_add_f32 v[180:181], v[180:181], v[188:189]
    v_pk_add_f32 v[182:183], v[182:183], v[190:191]
    s_waitcnt lgkmcnt(1)
    v_pk_add_f32 v[192:193], v[192:193], v[200:201]
    v_pk_add_f32 v[194:195], v[194:195], v[202:203]
    s_waitcnt lgkmcnt(0)
    v_pk_add_f32 v[196:197], v[196:197], v[204:205]
    v_pk_add_f32 v[198:199], v[198:199], v[206:207]
    v_pk_add_f32 v[96:97], v[176:177], v[192:193]
    v_pk_add_f32 v[98:99], v[178:179], v[194:195]
    v_pk_add_f32 v[100:101], v[180:181], v[196:197]
    v_pk_add_f32 v[102:103], v[182:183], v[198:199]
    v_cvt_pk_bf16_f32 v146, v92, v93
    v_cvt_pk_bf16_f32 v147, v94, v95
    v_cvt_pk_bf16_f32 v148, v96, v97
    v_cvt_pk_bf16_f32 v149, v98, v99
    v_cvt_pk_bf16_f32 v150, v100, v101
    v_cvt_pk_bf16_f32 v151, v102, v103
    s_add_u32 s63, s21, 0
    s_and_b32 s63, s63, 3
    s_cmp_eq_u32 s63, 3
    s_cselect_b32 s50, 0, 0x10000000
    s_lshl_b32 s63, s63, 9
    v_min_u32 v146, s68, v146
    v_min_u32 v147, s68, v147
    v_min_u32 v148, s68, v148
    v_min_u32 v149, s68, v149
    v_min_u32 v150, s68, v150
    v_min_u32 v151, s68, v151
    s_add_u32 s62, s61, 13824
    s_add_u32 s62, s62, s63
    s_add_u32 s63, s63, s62
    buffer_store_dwordx4 v[146:149], v236, s[48:51], s63 offen sc1
    buffer_store_dwordx2 v[150:151], v3, s[48:51], s62 offen offset:3072 sc1
    s_mov_b32 s50, 0x10000000
    v_mul_u32_u24 v6, 6554, v0
    v_lshrrev_b32 v6, 16, v6
    v_mul_u32_u24 v7, 10, v6
    v_sub_u32 v7, v0, v7
    v_mul_u32_u24 v6, 1280, v6
    v_lshl_add_u32 v6, v7, 4, v6
    v_cmp_gt_u32 vcc, 40, v0
    v_mov_b32 v7, 0x7ff00000
    s_nop 0
    v_cndmask_b32 v6, v7, v6, vcc
    v_mul_u32_u24 v7, 1280, v2
    v_mul_u32_u24 v2, 40, v1
    v_add_u32 v7, v7, v2
    s_mul_i32 s64, s24, 184320
    s_mul_i32 s65, s23, 160
    s_add_u32 s64, s64, s65
    s_mul_i32 s65, s20, 40960
    s_add_u32 s65, s65, s64
    s_add_u32 s66, s65, 20480
    s_add_u32 s64, s64, s72
    s_add_u32 s64, s64, 163840
    s_add_u32 s61, s18, 3072
    s_mov_b32 s69, 0
L_f2:
    buffer_load_dwordx4 v[152:155], v236, s[48:51], s18 offen offset:0 sc1
    buffer_load_dwordx2 v[156:157], v3, s[48:51], s61 offen offset:0 sc1
    buffer_load_dwordx4 v[158:161], v236, s[48:51], s18 offen offset:1024 sc1
    buffer_load_dwordx2 v[162:163], v3, s[48:51], s61 offen offset:512 sc1
    buffer_load_dwordx4 v[164:167], v236, s[48:51], s18 offen offset:2048 sc1
    buffer_load_dwordx2 v[168:169], v3, s[48:51], s61 offen offset:1024 sc1
    s_waitcnt vmcnt(0)
    v_max3_u32 v4, v152, v153, v154
    v_max3_u32 v5, v155, v156, v157
    v_max3_u32 v4, v4, v158, v159
    v_max3_u32 v5, v5, v160, v161
    v_max3_u32 v4, v4, v162, v163
    v_max3_u32 v5, v5, v164, v165
    v_max3_u32 v4, v4, v166, v167
    v_max3_u32 v5, v5, v168, v169
    v_max_u32 v4, v4, v5
    v_cmp_ne_u32 vcc, -1, v4
    s_cmp_eq_u64 vcc, exec
    s_cbranch_scc1 L_f2_x
    s_add_u32 s69, s69, 1
    s_cmp_lt_u32 s69, 200000
    s_cbranch_scc1 L_f2
L_f2_x:
    s_mov_b32 s68, 0xffff0000
    v_lshlrev_b32 v176, 16, v152
    v_and_b32 v177, s68, v152
    v_lshlrev_b32 v178, 16, v153
    v_and_b32 v179, s68, v153
    v_lshlrev_b32 v180, 16, v154
    v_and_b32 v181, s68, v154
    v_lshlrev_b32 v182, 16, v155
    v_and_b32 v183, s68, v155
    v_lshlrev_b32 v184, 16, v156
    v_and_b32 v185, s68, v156
    v_lshlrev_b32 v186, 16, v157
    v_and_b32 v187, s68, v157
    v_lshlrev_b32 v188, 16, v158
    v_and_b32 v189, s68, v158
    v_lshlrev_b32 v190, 16, v159
    v_and_b32 v191, s68, v159
    v_lshlrev_b32 v192, 16, v160
    v_and_b32 v193, s68, v160
    v_lshlrev_b32 v194, 16, v161
    v_and_b32 v195, s68, v161
    v_lshlrev_b32 v196, 16, v162
    v_and_b32 v197, s68, v162
    v_lshlrev_b32 v198, 16, v163
    v_and_b32 v199, s68, v163
    v_lshlrev_b32 v200, 16, v164
    v_and_b32 v201, s68, v164
    v_lshlrev_b32 v202, 16, v165
    v_and_b32 v203, s68, v165
    v_lshlrev_b32 v204, 16, v166
    v_and_b32 v205, s68, v166
    v_lshlrev_b32 v206, 16, v167
    v_and_b32 v207, s68, v167
    v_lshlrev_b32 v208, 16, v168
    v_and_b32 v209, s68, v168
    v_lshlrev_b32 v210, 16, v169
    v_and_b32 v211, s68, v169
    v_pk_add_f32 v[176:177], v[176:177], v[188:189]
    v_pk_add_f32 v[178:179], v[178:179], v[190:191]
    v_pk_add_f32 v[180:181], v[180:181], v[192:193]
    v_pk_add_f32 v[182:183], v[182:183], v[194:195]
    v_pk_add_f32 v[184:185], v[184:185], v[196:197]
    v_pk_add_f32 v[186:187], v[186:187], v[198:199]
    v_pk_add_f32 v[176:177], v[176:177], v[200:201]
    v_pk_add_f32 v[178:179], v[178:179], v[202:203]
    v_pk_add_f32 v[180:181], v[180:181], v[204:205]
    v_pk_add_f32 v[182:183], v[182:183], v[206:207]
    v_pk_add_f32 v[184:185], v[184:185], v[208:209]
    v_pk_add_f32 v[186:187], v[186:187], v[210:211]
    s_cmp_eq_u32 s21, 0
    s_cbranch_scc1 L_fin0
    s_cmp_eq_u32 s21, 1
    s_cbranch_scc1 L_fin1
    s_cmp_eq_u32 s21, 2
    s_cbranch_scc1 L_fin2
    v_pk_add_f32 v[176:177], v[176:177], v[92:93]
    v_pk_add_f32 v[178:179], v[178:179], v[94:95]
    v_pk_add_f32 v[180:181], v[180:181], v[96:97]
    v_pk_add_f32 v[182:183], v[182:183], v[98:99]
    v_pk_add_f32 v[184:185], v[184:185], v[100:101]
    v_pk_add_f32 v[186:187], v[186:187], v[102:103]
    v_cvt_pk_bf16_f32 v10, v176, v177
    v_cvt_pk_bf16_f32 v11, v178, v179
    v_cvt_pk_bf16_f32 v12, v180, v181
    v_cvt_pk_bf16_f32 v13, v182, v183
    v_cvt_pk_bf16_f32 v14, v184, v185
    v_cvt_pk_bf16_f32 v15, v186, v187
    buffer_store_dwordx2 v[10:11], v7, s[52:55], s66 offen offset:32
    buffer_store_dwordx4 v[12:15], v6, s[52:55], s64 offen
    s_branch L_fini
L_fin0:
    v_pk_add_f32 v[176:177], v[176:177], v[56:57]
    v_pk_add_f32 v[178:179], v[178:179], v[58:59]
    v_pk_add_f32 v[180:181], v[180:181], v[60:61]
    v_pk_add_f32 v[182:183], v[182:183], v[62:63]
    v_pk_add_f32 v[184:185], v[184:185], v[64:65]
    v_pk_add_f32 v[186:187], v[186:187], v[66:67]
    v_cvt_pk_bf16_f32 v10, v176, v177
    v_cvt_pk_bf16_f32 v11, v178, v179
    v_cvt_pk_bf16_f32 v12, v180, v181
    v_cvt_pk_bf16_f32 v13, v182, v183
    v_cvt_pk_bf16_f32 v14, v184, v185
    v_cvt_pk_bf16_f32 v15, v186, v187
    buffer_store_dwordx2 v[10:11], v7, s[52:55], s65 offen offset:0
    buffer_store_dwordx2 v[12:13], v7, s[52:55], s65 offen offset:8
    buffer_store_dwordx2 v[14:15], v7, s[52:55], s65 offen offset:16
    s_branch L_fini
L_fin1:
    v_pk_add_f32 v[176:177], v[176:177], v[68:69]
    v_pk_add_f32 v[178:179], v[178:179], v[70:71]
    v_pk_add_f32 v[180:181], v[180:181], v[72:73]
    v_pk_add_f32 v[182:183], v[182:183], v[74:75]
    v_pk_add_f32 v[184:185], v[184:185], v[76:77]
    v_pk_add_f32 v[186:187], v[186:187], v[78:79]
    v_cvt_pk_bf16_f32 v10, v176, v177
    v_cvt_pk_bf16_f32 v11, v178, v179
    v_cvt_pk_bf16_f32 v12, v180, v181
    v_cvt_pk_bf16_f32 v13, v182, v183
    v_cvt_pk_bf16_f32 v14, v184, v185
    v_cvt_pk_bf16_f32 v15, v186, v187
    buffer_store_dwordx2 v[10:11], v7, s[52:55], s65 offen offset:24
    buffer_store_dwordx2 v[12:13], v7, s[52:55], s65 offen offset:32
    buffer_store_dwordx2 v[14:15], v7, s[52:55], s66 offen offset:0
    s_branch L_fini
L_fin2:
    v_pk_add_f32 v[176:177], v[176:177], v[80:81]
    v_pk_add_f32 v[178:179], v[178:179], v[82:83]
    v_pk_add_f32 v[180:181], v[180:181], v[84:85]
    v_pk_add_f32 v[182:183], v[182:183], v[86:87]
    v_pk_add_f32 v[184:185], v[184:185], v[88:89]
    v_pk_add_f32 v[186:187], v[186:187], v[90:91]
    v_cvt_pk_bf16_f32 v10, v176, v177
    v_cvt_pk_bf16_f32 v11, v178, v179
    v_cvt_pk_bf16_f32 v12, v180, v181
    v_cvt_pk_bf16_f32 v13, v182, v183
    v_cvt_pk_bf16_f32 v14, v184, v185
    v_cvt_pk_bf16_f32 v15, v186, v187
    buffer_store_dwordx2 v[10:11], v7, s[52:55], s66 offen offset:8
    buffer_store_dwordx2 v[12:13], v7, s[52:55], s66 offen offset:16
    buffer_store_dwordx2 v[14:15], v7, s[52:55], s66 offen offset:24
L_fini:
L_done:
    s_waitcnt vmcnt(0)
L_end:
    s_endpgm
L_slow0:
    s_nop 15
    v_mov_b32 v173, v171
    v_mov_b32 v240, v172
    s_nop 0
    v_permlane32_swap_b32 v171, v173
    v_permlane32_swap_b32 v172, v240
    v_max_f32 v171, v171, v173
    v_max_f32 v172, v172, v240
    v_mov_b32 v240, v172
    s_nop 1
    v_permlane16_swap_b32 v172, v240
    v_max_f32 v172, v172, v240
    v_max_f32 v171, 0, v171
    v_max_f32 v172, 0, v172
    v_sub_f32 v56, v56, v171
    v_sub_f32 v57, v57, v171
    v_sub_f32 v58, v58, v171
    v_sub_f32 v59, v59, v171
    v_sub_f32 v60, v60, v171
    v_sub_f32 v61, v61, v171
    v_sub_f32 v62, v62, v171
    v_sub_f32 v63, v63, v171
    v_sub_f32 v64, v64, v171
    v_sub_f32 v65, v65, v171
    v_sub_f32 v66, v66, v171
    v_sub_f32 v67, v67, v171
    v_sub_f32 v68, v68, v171
    v_sub_f32 v69, v69, v171
    v_sub_f32 v70, v70, v171
    v_sub_f32 v71, v71, v171
    v_sub_f32 v72, v72, v171
    v_sub_f32 v73, v73, v171
    v_sub_f32 v74, v74, v171
    v_sub_f32 v75, v75, v171
    v_sub_f32 v76, v76, v171
    v_sub_f32 v77, v77, v171
    v_sub_f32 v78, v78, v171
    v_sub_f32 v79, v79, v171
    v_sub_f32 v80, v80, v171
    v_sub_f32 v81, v81, v171
    v_sub_f32 v82, v82, v171
    v_sub_f32 v83, v83, v171
    v_sub_f32 v84, v84, v171
    v_sub_f32 v85, v85, v171
    v_sub_f32 v86, v86, v171
    v_sub_f32 v87, v87, v171
    v_sub_f32 v120, v120, v172
    v_sub_f32 v121, v121, v172
    v_sub_f32 v122, v122, v172
    v_sub_f32 v123, v123, v172
    s_branch L_slowc
L_slow1:
    s_nop 15
    v_mov_b32 v173, v171
    v_mov_b32 v240, v172
    s_nop 0
    v_permlane32_swap_b32 v171, v173
    v_permlane32_swap_b32 v172, v240
    v_max_f32 v171, v171, v173
    v_max_f32 v172, v172, v240
    v_mov_b32 v240, v172
    s_nop 1
    v_permlane16_swap_b32 v172, v240
    v_max_f32 v172, v172, v240
    v_max_f32 v171, 0, v171
    v_max_f32 v172, 0, v172
    v_sub_f32 v88, v88, v171
    v_sub_f32 v89, v89, v171
    v_sub_f32 v90, v90, v171
    v_sub_f32 v91, v91, v171
    v_sub_f32 v92, v92, v171
    v_sub_f32 v93, v93, v171
    v_sub_f32 v94, v94, v171
    v_sub_f32 v95, v95, v171
    v_sub_f32 v96, v96, v171
    v_sub_f32 v97, v97, v171
    v_sub_f32 v98, v98, v171
    v_sub_f32 v99, v99, v171
    v_sub_f32 v100, v100, v171
    v_sub_f32 v101, v101, v171
    v_sub_f32 v102, v102, v171
    v_sub_f32 v103, v103, v171
    v_sub_f32 v104, v104, v171
    v_sub_f32 v105, v105, v171
    v_sub_f32 v106, v106, v171
    v_sub_f32 v107, v107, v171
    v_sub_f32 v108, v108, v171
    v_sub_f32 v109, v109, v171
    v_sub_f32 v110, v110, v171
    v_sub_f32 v111, v111, v171
    v_sub_f32 v112, v112, v171
    v_sub_f32 v113, v113, v171
    v_sub_f32 v114, v114, v171
    v_sub_f32 v115, v115, v171
    v_sub_f32 v116, v116, v171
    v_sub_f32 v117, v117, v171
    v_sub_f32 v118, v118, v171
    v_sub_f32 v119, v119, v171
    v_sub_f32 v124, v124, v172
    v_sub_f32 v125, v125, v172
    v_sub_f32 v126, v126, v172
    v_sub_f32 v127, v127, v172
L_slowc:
    v_sub_f32 v128, v128, v171
    v_sub_f32 v129, v129, v171
    v_sub_f32 v130, v130, v171
    v_sub_f32 v131, v131, v171
    v_sub_f32 v132, v132, v171
    v_sub_f32 v133, v133, v171
    v_sub_f32 v134, v134, v171
    v_sub_f32 v135, v135, v171
    v_sub_f32 v136, v136, v171
    v_sub_f32 v137, v137, v171
    v_sub_f32 v138, v138, v171
    v_sub_f32 v139, v139, v171
    v_sub_f32 v140, v140, v171
    v_sub_f32 v141, v141, v171
    v_sub_f32 v142, v142, v171
    v_sub_f32 v143, v143, v171
    v_sub_f32 v144, v144, v172
    v_sub_f32 v145, v145, v172
    v_sub_f32 v146, v146, v172
    v_sub_f32 v147, v147, v172
    v_exp_f32 v171, -v171
    v_exp_f32 v172, -v172
    v_mul_f32 v166, v166, v171
    v_mul_f32 v167, v167, v171
    v_mul_f32 v170, v170, v172
    v_accvgpr_read_b32 v240, a0
    v_mul_f32 v240, v240, v171
    v_accvgpr_write_b32 a0, v240
    v_accvgpr_read_b32 v241, a1
    v_mul_f32 v241, v241, v171
    v_accvgpr_write_b32 a1, v241
    v_accvgpr_read_b32 v242, a2
    v_mul_f32 v242, v242, v171
    v_accvgpr_write_b32 a2, v242
    v_accvgpr_read_b32 v243, a3
    v_mul_f32 v243, v243, v171
    v_accvgpr_write_b32 a3, v243
    v_accvgpr_read_b32 v240, a4
    v_mul_f32 v240, v240, v171
    v_accvgpr_write_b32 a4, v240
    v_accvgpr_read_b32 v241, a5
    v_mul_f32 v241, v241, v171
    v_accvgpr_write_b32 a5, v241
    v_accvgpr_read_b32 v242, a6
    v_mul_f32 v242, v242, v171
    v_accvgpr_write_b32 a6, v242
    v_accvgpr_read_b32 v243, a7
    v_mul_f32 v243, v243, v171
    v_accvgpr_write_b32 a7, v243
    v_accvgpr_read_b32 v240, a8
    v_mul_f32 v240, v240, v171
    v_accvgpr_write_b32 a8, v240
    v_accvgpr_read_b32 v241, a9
    v_mul_f32 v241, v241, v171
    v_accvgpr_write_b32 a9, v241
    v_accvgpr_read_b32 v242, a10
    v_mul_f32 v242, v242, v171
    v_accvgpr_write_b32 a10, v242
    v_accvgpr_read_b32 v243, a11
    v_mul_f32 v243, v243, v171
    v_accvgpr_write_b32 a11, v243
    v_accvgpr_read_b32 v240, a12
    v_mul_f32 v240, v240, v171
    v_accvgpr_write_b32 a12, v240
    v_accvgpr_read_b32 v241, a13
    v_mul_f32 v241, v241, v171
    v_accvgpr_write_b32 a13, v241
    v_accvgpr_read_b32 v242, a14
    v_mul_f32 v242, v242, v171
    v_accvgpr_write_b32 a14, v242
    v_accvgpr_read_b32 v243, a15
    v_mul_f32 v243, v243, v171
    v_accvgpr_write_b32 a15, v243
    v_accvgpr_read_b32 v240, a16
    v_mul_f32 v240, v240, v171
    v_accvgpr_write_b32 a16, v240
    v_accvgpr_read_b32 v241, a17
    v_mul_f32 v241, v241, v171
    v_accvgpr_write_b32 a17, v241
    v_accvgpr_read_b32 v242, a18
    v_mul_f32 v242, v242, v171
    v_accvgpr_write_b32 a18, v242
    v_accvgpr_read_b32 v243, a19
    v_mul_f32 v243, v243, v171
    v_accvgpr_write_b32 a19, v243
    v_accvgpr_read_b32 v240, a20
    v_mul_f32 v240, v240, v171
    v_accvgpr_write_b32 a20, v240
    v_accvgpr_read_b32 v241, a21
    v_mul_f32 v241, v241, v171
    v_accvgpr_write_b32 a21, v241
    v_accvgpr_read_b32 v242, a22
    v_mul_f32 v242, v242, v171
    v_accvgpr_write_b32 a22, v242
    v_accvgpr_read_b32 v243, a23
    v_mul_f32 v243, v243, v171
    v_accvgpr_write_b32 a23, v243
    v_accvgpr_read_b32 v240, a24
    v_mul_f32 v240, v240, v171
    v_accvgpr_write_b32 a24, v240
    v_accvgpr_read_b32 v241, a25
    v_mul_f32 v241, v241, v171
    v_accvgpr_write_b32 a25, v241
    v_accvgpr_read_b32 v242, a26
    v_mul_f32 v242, v242, v171
    v_accvgpr_write_b32 a26, v242
    v_accvgpr_read_b32 v243, a27
    v_mul_f32 v243, v243, v171
    v_accvgpr_write_b32 a27, v243
    v_accvgpr_read_b32 v240, a28
    v_mul_f32 v240, v240, v171
    v_accvgpr_write_b32 a28, v240
    v_accvgpr_read_b32 v241, a29
    v_mul_f32 v241, v241, v171
    v_accvgpr_write_b32 a29, v241
    v_accvgpr_read_b32 v242, a30
    v_mul_f32 v242, v242, v171
    v_accvgpr_write_b32 a30, v242
    v_accvgpr_read_b32 v243, a31
    v_mul_f32 v243, v243, v171
    v_accvgpr_write_b32 a31, v243
    v_accvgpr_read_b32 v240, a32
    v_mul_f32 v240, v240, v171
    v_accvgpr_write_b32 a32, v240
    v_accvgpr_read_b32 v241, a33
    v_mul_f32 v241, v241, v171
    v_accvgpr_write_b32 a33, v241
    v_accvgpr_read_b32 v242, a34
    v_mul_f32 v242, v242, v171
    v_accvgpr_write_b32 a34, v242
    v_accvgpr_read_b32 v243, a35
    v_mul_f32 v243, v243, v171
    v_accvgpr_write_b32 a35, v243
    v_accvgpr_read_b32 v240, a36
    v_mul_f32 v240, v240, v171
    v_accvgpr_write_b32 a36, v240
    v_accvgpr_read_b32 v241, a37
    v_mul_f32 v241, v241, v171
    v_accvgpr_write_b32 a37, v241
    v_accvgpr_read_b32 v242, a38
    v_mul_f32 v242, v242, v171
    v_accvgpr_write_b32 a38, v242
    v_accvgpr_read_b32 v243, a39
    v_mul_f32 v243, v243, v171
    v_accvgpr_write_b32 a39, v243
    v_accvgpr_read_b32 v240, a40
    v_mul_f32 v240, v240, v171
    v_accvgpr_write_b32 a40, v240
    v_accvgpr_read_b32 v241, a41
    v_mul_f32 v241, v241, v171
    v_accvgpr_write_b32 a41, v241
    v_accvgpr_read_b32 v242, a42
    v_mul_f32 v242, v242, v171
    v_accvgpr_write_b32 a42, v242
    v_accvgpr_read_b32 v243, a43
    v_mul_f32 v243, v243, v171
    v_accvgpr_write_b32 a43, v243
    v_accvgpr_read_b32 v240, a44
    v_mul_f32 v240, v240, v171
    v_accvgpr_write_b32 a44, v240
    v_accvgpr_read_b32 v241, a45
    v_mul_f32 v241, v241, v171
    v_accvgpr_write_b32 a45, v241
    v_accvgpr_read_b32 v242, a46
    v_mul_f32 v242, v242, v171
    v_accvgpr_write_b32 a46, v242
    v_accvgpr_read_b32 v243, a47
    v_mul_f32 v243, v243, v171
    v_accvgpr_write_b32 a47, v243
    v_accvgpr_read_b32 v240, a48
    v_mul_f32 v240, v240, v171
    v_accvgpr_write_b32 a48, v240
    v_accvgpr_read_b32 v241, a49
    v_mul_f32 v241, v241, v171
    v_accvgpr_write_b32 a49, v241
    v_accvgpr_read_b32 v242, a50
    v_mul_f32 v242, v242, v171
    v_accvgpr_write_b32 a50, v242
    v_accvgpr_read_b32 v243, a51
    v_mul_f32 v243, v243, v171
    v_accvgpr_write_b32 a51, v243
    v_accvgpr_read_b32 v240, a52
    v_mul_f32 v240, v240, v171
    v_accvgpr_write_b32 a52, v240
    v_accvgpr_read_b32 v241, a53
    v_mul_f32 v241, v241, v171
    v_accvgpr_write_b32 a53, v241
    v_accvgpr_read_b32 v242, a54
    v_mul_f32 v242, v242, v171
    v_accvgpr_write_b32 a54, v242
    v_accvgpr_read_b32 v243, a55
    v_mul_f32 v243, v243, v171
    v_accvgpr_write_b32 a55, v243
    v_accvgpr_read_b32 v240, a56
    v_mul_f32 v240, v240, v171
    v_accvgpr_write_b32 a56, v240
    v_accvgpr_read_b32 v241, a57
    v_mul_f32 v241, v241, v171
    v_accvgpr_write_b32 a57, v241
    v_accvgpr_read_b32 v242, a58
    v_mul_f32 v242, v242, v171
    v_accvgpr_write_b32 a58, v242
    v_accvgpr_read_b32 v243, a59
    v_mul_f32 v243, v243, v171
    v_accvgpr_write_b32 a59, v243
    v_accvgpr_read_b32 v240, a60
    v_mul_f32 v240, v240, v171
    v_accvgpr_write_b32 a60, v240
    v_accvgpr_read_b32 v241, a61
    v_mul_f32 v241, v241, v171
    v_accvgpr_write_b32 a61, v241
    v_accvgpr_read_b32 v242, a62
    v_mul_f32 v242, v242, v171
    v_accvgpr_write_b32 a62, v242
    v_accvgpr_read_b32 v243, a63
    v_mul_f32 v243, v243, v171
    v_accvgpr_write_b32 a63, v243
    v_accvgpr_read_b32 v240, a64
    v_mul_f32 v240, v240, v172
    v_accvgpr_write_b32 a64, v240
    v_accvgpr_read_b32 v241, a65
    v_mul_f32 v241, v241, v172
    v_accvgpr_write_b32 a65, v241
    v_accvgpr_read_b32 v242, a66
    v_mul_f32 v242, v242, v172
    v_accvgpr_write_b32 a66, v242
    v_accvgpr_read_b32 v243, a67
    v_mul_f32 v243, v243, v172
    v_accvgpr_write_b32 a67, v243
    v_accvgpr_read_b32 v240, a68
    v_mul_f32 v240, v240, v172
    v_accvgpr_write_b32 a68, v240
    v_accvgpr_read_b32 v241, a69
    v_mul_f32 v241, v241, v172
    v_accvgpr_write_b32 a69, v241
    v_accvgpr_read_b32 v242, a70
    v_mul_f32 v242, v242, v172
    v_accvgpr_write_b32 a70, v242
    v_accvgpr_read_b32 v243, a71
    v_mul_f32 v243, v243, v172
    v_accvgpr_write_b32 a71, v243
    v_accvgpr_read_b32 v240, a72
    v_mul_f32 v240, v240, v172
    v_accvgpr_write_b32 a72, v240
    v_accvgpr_read_b32 v241, a73
    v_mul_f32 v241, v241, v172
    v_accvgpr_write_b32 a73, v241
    v_accvgpr_read_b32 v242, a74
    v_mul_f32 v242, v242, v172
    v_accvgpr_write_b32 a74, v242
    v_accvgpr_read_b32 v243, a75
    v_mul_f32 v243, v243, v172
    v_accvgpr_write_b32 a75, v243
    v_accvgpr_read_b32 v240, a76
    v_mul_f32 v240, v240, v172
    v_accvgpr_write_b32 a76, v240
    v_accvgpr_read_b32 v241, a77
    v_mul_f32 v241, v241, v172
    v_accvgpr_write_b32 a77, v241
    v_accvgpr_read_b32 v242, a78
    v_mul_f32 v242, v242, v172
    v_accvgpr_write_b32 a78, v242
    v_accvgpr_read_b32 v243, a79
    v_mul_f32 v243, v243, v172
    v_accvgpr_write_b32 a79, v243
    v_accvgpr_read_b32 v240, a80
    v_mul_f32 v240, v240, v172
    v_accvgpr_write_b32 a80, v240
    v_accvgpr_read_b32 v241, a81
    v_mul_f32 v241, v241, v172
    v_accvgpr_write_b32 a81, v241
    v_accvgpr_read_b32 v242, a82
    v_mul_f32 v242, v242, v172
    v_accvgpr_write_b32 a82, v242
    v_accvgpr_read_b32 v243, a83
    v_mul_f32 v243, v243, v172
    v_accvgpr_write_b32 a83, v243
    v_accvgpr_read_b32 v240, a84
    v_mul_f32 v240, v240, v172
    v_accvgpr_write_b32 a84, v240
    v_accvgpr_read_b32 v241, a85
    v_mul_f32 v241, v241, v172
    v_accvgpr_write_b32 a85, v241
    v_accvgpr_read_b32 v242, a86
    v_mul_f32 v242, v242, v172
    v_accvgpr_write_b32 a86, v242
    v_accvgpr_read_b32 v243, a87
    v_mul_f32 v243, v243, v172
    v_accvgpr_write_b32 a87, v243
    v_accvgpr_read_b32 v240, a88
    v_mul_f32 v240, v240, v172
    v_accvgpr_write_b32 a88, v240
    v_accvgpr_read_b32 v241, a89
    v_mul_f32 v241, v241, v172
    v_accvgpr_write_b32 a89, v241
    v_accvgpr_read_b32 v242, a90
    v_mul_f32 v242, v242, v172
    v_accvgpr_write_b32 a90, v242
    v_accvgpr_read_b32 v243, a91
    v_mul_f32 v243, v243, v172
    v_accvgpr_write_b32 a91, v243
    v_accvgpr_read_b32 v240, a92
    v_mul_f32 v240, v240, v172
    v_accvgpr_write_b32 a92, v240
    v_accvgpr_read_b32 v241, a93
    v_mul_f32 v241, v241, v172
    v_accvgpr_write_b32 a93, v241
    v_accvgpr_read_b32 v242, a94
    v_mul_f32 v242, v242, v172
    v_accvgpr_write_b32 a94, v242
    v_accvgpr_read_b32 v243, a95
    v_mul_f32 v243, v243, v172
    v_accvgpr_write_b32 a95, v243
    s_nop 1
    s_setpc_b64 s[80:81]
L_codeend:
    s_endpgm
.section .rodata,"a"
.p2align 6
.amdhsa_kernel standalone__mha_block_cached__near_ridge_kernel
  .amdhsa_next_free_vgpr 512
  .amdhsa_next_free_sgpr 102
  .amdhsa_accum_offset 256
  .amdhsa_group_segment_fixed_size 0
  .amdhsa_kernarg_size 64
  .amdhsa_user_sgpr_count 2
  .amdhsa_user_sgpr_kernarg_segment_ptr 1
  .amdhsa_system_sgpr_workgroup_id_x 1
  .amdhsa_float_denorm_mode_32 3
  .amdhsa_ieee_mode 0
.end_amdhsa_kernel
```
